```python
import torch

def _softmax(x, axis=-1):
    return torch.softmax(x, dim=axis)
def _gelu(x):
    return torch.nn.functional.gelu(x, approximate="tanh")
def _silu(x):
    return torch.nn.functional.silu(x)
def _sigmoid(x):
    return torch.sigmoid(x)
def _layernorm(x, axis=-1, eps=1e-5):
    m = x.mean(dim=axis, keepdim=True)
    v = x.var(dim=axis, keepdim=True, unbiased=False)
    return (x - m) / torch.sqrt(v + eps)
def _scatter_add(tgt, idx, src, axis=0):
    return tgt.clone().index_add_(axis, idx, src)
def _segment_sum(src, seg, n):
    out = torch.zeros((n,) + src.shape[1:], dtype=src.dtype)
    return out.index_add_(0, seg, src)
def _pad(x, pw):
    flat = tuple(v for pair in reversed(pw) for v in pair)
    return torch.nn.functional.pad(x, flat)

kernel_name = 'parallel_sum__spectral_gfnet__glu_gated_geglu__prompt'

def setup_inputs():

    _w = (lambda a: (lambda t: t.to(torch.bfloat16) if t.is_floating_point() else t)(torch.as_tensor(a)))
    def _A_setup():
        B, S, D = 1, 2048, 512
        Df = D // 2 + 1
        return {
            "x": _w((lambda *s: torch.randn(*s, dtype=torch.bfloat16) * 0.05)(B, S, D)),
            "w_r": _w((lambda *s: torch.randn(*s, dtype=torch.bfloat16) * 0.8)(S, Df) * 0.02),
            "w_i": _w((lambda *s: torch.randn(*s, dtype=torch.bfloat16) * 0.8)(S, Df) * 0.02),
        }
    _A_in = _A_setup()

    def _B_setup():
        B, S, Dm, Df = 1, 2048, 512, 1792
        return {
            "x": _w((lambda *s: torch.randn(*s, dtype=torch.bfloat16) * 0.05)(B, S, Dm)),
            "w_gate": _w((lambda *s: torch.randn(*s, dtype=torch.bfloat16) * 0.4)(Dm, Df) * (Dm ** -0.5)),
            "w_up": _w((lambda *s: torch.randn(*s, dtype=torch.bfloat16) * 0.4)(Dm, Df) * (Dm ** -0.5)),
            "w_down": _w((lambda *s: torch.randn(*s, dtype=torch.bfloat16) * 0.4)(Df, Dm) * (Df ** -0.5)),
        }
    _B_in = _B_setup()

    return {
        "A_x": _A_in["x"],
        "A_w_r": _A_in["w_r"],
        "A_w_i": _A_in["w_i"],
        "B_x": _B_in["x"],
        "B_w_gate": _B_in["w_gate"],
        "B_w_up": _B_in["w_up"],
        "B_w_down": _B_in["w_down"],
    }

def reference(A_x, A_w_r, A_w_i, B_x, B_w_gate, B_w_up, B_w_down):
    def _A_ref(x, w_r, w_i):
        B, S, D = x.shape
        X = (lambda x, axes=(-2,-1): torch.fft.rfft2(x.float(), dim=axes))(x, axes=(-2, -1))
        W = w_r + 1j * w_i
        X = X * W
        y = (lambda x, s, axes=(-2,-1): torch.fft.irfft2(x, s=s, dim=axes).to(torch.bfloat16))(X, (S, D), axes=(-2, -1))
        return y

    def _B_ref(x, w_gate, w_up, w_down):
        g = torch.einsum("bsd,df->bsf", x, w_gate)
        u = torch.einsum("bsd,df->bsf", x, w_up)
        h = _gelu(g) * u
        return torch.einsum("bsf,fd->bsd", h, w_down)

    x = A_x
    xn = _layernorm(x, axis=-1)
    return x + _A_ref(xn, A_w_r, A_w_i) + _B_ref(xn, B_w_gate, B_w_up, B_w_down)
```

```asm
; @launch grid=(256,1,1) block=(512,1,1) lds=163840
.amdgcn_target "amdgcn-amd-amdhsa--gfx950"
.text
.globl parallel_sum__spectral_gfnet__glu_gated_geglu__prompt_kernel
.p2align 8
.type parallel_sum__spectral_gfnet__glu_gated_geglu__prompt_kernel,@function
parallel_sum__spectral_gfnet__glu_gated_geglu__prompt_kernel:
    s_cmp_ge_u32 s2, 256
    s_cbranch_scc1 L_END
    s_load_dwordx2 s[4:5], s[0:1], 0
    s_load_dwordx2 s[8:9], s[0:1], 32
    s_load_dwordx2 s[12:13], s[0:1], 40
    s_load_dwordx2 s[28:29], s[0:1], 72
    s_load_dwordx2 s[20:21], s[0:1], 8
    s_load_dwordx2 s[24:25], s[0:1], 16
    s_load_dwordx2 s[16:17], s[0:1], 48
    s_load_dwordx2 s[32:33], s[0:1], 56
    s_and_b32 s50, s2, 7
    s_lshr_b32 s51, s2, 3
    v_lshrrev_b32 v8, 6, v0
    v_and_b32 v1, 63, v0
    v_and_b32 v4, 15, v0
    v_readfirstlane_b32 s38, v8
    s_and_b32 s36, s50, 1
    s_lshl_b32 s36, s36, 3
    s_and_b32 s52, s51, 7
    s_or_b32 s36, s36, s52
    s_lshr_b32 s53, s50, 1
    s_lshr_b32 s52, s51, 3
    s_lshl_b32 s37, s53, 2
    s_or_b32 s37, s37, s52
    s_mul_i32 s74, s53, 28
    s_lshl_b32 s54, s52, 3
    s_add_u32 s74, s74, s54
    s_cmp_eq_u32 s52, 3
    s_cselect_b32 s75, 1, 0
    v_lshrrev_b32 v5, 4, v1
    s_and_b32 s39, s38, 3
    s_lshr_b32 s40, s38, 2
    s_mov_b32 s6, 2097152
    s_mov_b32 s7, 0x20000
    s_mov_b32 s10, 1835008
    s_mov_b32 s11, 0x20000
    s_mov_b32 s14, 1835008
    s_mov_b32 s15, 0x20000
    s_lshl_b32 s53, s39, 4
    v_lshrrev_b32 v8, 2, v1
    v_add_u32 v8, s53, v8
    v_lshlrev_b32 v8, 15, v8
    s_lshl_b32 s54, s36, 1
    s_add_u32 s54, s54, s40
    s_lshl_b32 s54, s54, 10
    v_xor_b32 v9, v1, v5
    v_and_b32 v9, 3, v9
    v_lshlrev_b32 v9, 4, v9
    v_add3_u32 v26, v8, s54, v9
    s_lshl_b32 s47, s38, 10
    s_lshl_b32 s55, s74, 5
    s_movk_i32 s54, 3584
    s_cmp_eq_u32 s75, 0
    s_cbranch_scc0 L_SB
    s_lshl_b32 s53, s38, 2
    v_add_u32 v10, s53, v5
    v_mul_lo_u32 v10, v10, s54
    v_and_b32 v12, 1, v4
    v_lshl_add_u32 v10, v12, 4, v10
    v_add_u32 v10, s55, v10
    v_lshrrev_b32 v9, 1, v4
    v_xor_b32 v9, v9, v5
    v_xor_b32 v11, 4, v9
    v_lshl_add_u32 v27, v9, 5, v10
    v_lshl_add_u32 v28, v11, 5, v10
    s_waitcnt lgkmcnt(0)
    s_add_u32 m0, s47, 16384
    s_mov_b32 s42, 0
    buffer_load_dwordx4 v26, s[4:7], s42 offen lds
    s_add_u32 m0, s47, 24576
    s_mov_b32 s42, 0
    buffer_load_dwordx4 v27, s[8:11], s42 offen lds
    s_add_u32 m0, s47, 32768
    s_mov_b32 s42, 0
    buffer_load_dwordx4 v28, s[12:15], s42 offen lds
    s_add_u32 m0, s47, 40960
    s_mov_b32 s42, 64
    buffer_load_dwordx4 v26, s[4:7], s42 offen lds
    s_add_u32 m0, s47, 49152
    s_mov_b32 s42, 114688
    buffer_load_dwordx4 v27, s[8:11], s42 offen lds
    s_add_u32 m0, s47, 57344
    s_mov_b32 s42, 114688
    buffer_load_dwordx4 v28, s[12:15], s42 offen lds
    s_branch L_SC
L_SB:
    s_lshl_b32 s53, s39, 3
    v_lshrrev_b32 v10, 3, v1
    v_add_u32 v11, s53, v10
    v_mul_lo_u32 v11, v11, s54
    v_and_b32 v12, 1, v1
    v_lshl_add_u32 v11, v12, 4, v11
    v_add_u32 v11, s55, v11
    v_bfe_u32 v9, v1, 4, 1
    s_lshl_b32 s53, s40, 1
    v_or_b32 v9, s53, v9
    v_bfe_u32 v12, v1, 1, 2
    v_xor_b32 v9, v9, v12
    v_lshl_add_u32 v27, v9, 5, v11
    s_waitcnt lgkmcnt(0)
    s_cmp_eq_u32 s40, 0
    s_cselect_b32 s76, s8, s12
    s_cselect_b32 s77, s9, s13
    s_mov_b32 s78, 1835008
    s_mov_b32 s79, 0x20000
    s_add_u32 m0, s47, 65536
    s_mov_b32 s42, 0
    buffer_load_dwordx4 v26, s[4:7], s42 offen lds
    s_add_u32 m0, s47, 73728
    s_mov_b32 s42, 0
    buffer_load_dwordx4 v27, s[76:79], s42 offen lds
    s_add_u32 m0, s47, 81920
    s_mov_b32 s42, 64
    buffer_load_dwordx4 v26, s[4:7], s42 offen lds
    s_add_u32 m0, s47, 90112
    s_mov_b32 s42, 114688
    buffer_load_dwordx4 v27, s[76:79], s42 offen lds
L_SC:
    s_mov_b32 s18, 1835008
    s_mov_b32 s19, 0x20000
    s_mov_b32 s22, 1052672
    s_mov_b32 s23, 0x20000
    s_mov_b32 s26, 1052672
    s_mov_b32 s27, 0x20000
    s_mov_b32 s30, 14286848
    s_mov_b32 s31, 0x20000
    s_mov_b32 s34, 2097152
    s_mov_b32 s35, 0x20000
    s_mov_b32 s53, 14090240
    s_load_dword s49, s[28:29], s53
    v_and_b32 v2, 31, v1
    v_lshrrev_b32 v3, 5, v1
    v_lshlrev_b32 v6, 4, v1
    s_lshl_b32 s64, s50, 2
    s_and_b32 s52, s51, 3
    s_add_u32 s64, s64, s52
    s_lshr_b32 s65, s51, 2
    s_bfe_u32 s70, s38, 0x10002
    s_bfe_u32 s71, s38, 0x10001
    s_and_b32 s72, s38, 1
    s_cmp_eq_u32 s75, 0
    s_cselect_b32 s52, s40, 0
    s_lshl_b32 s52, s52, 2
    s_add_u32 s58, s39, 0
    s_and_b32 s58, s58, 3
    s_add_u32 s58, s58, s52
    s_add_u32 s59, s39, 1
    s_and_b32 s59, s59, 3
    s_add_u32 s59, s59, s52
    s_add_u32 s60, s39, 2
    s_and_b32 s60, s60, 3
    s_add_u32 s60, s60, s52
    s_add_u32 s61, s39, 3
    s_and_b32 s61, s61, 3
    s_add_u32 s61, s61, s52
    s_cmp_eq_u32 s75, 0
    s_cselect_b32 s50, 8, 7
    s_cselect_b32 s51, 13, 12
    s_cselect_b32 s52, 0, 65536
    s_mov_b32 s54, 49152
    s_cselect_b32 s53, s54, 0x8000
    v_lshrrev_b32 v8, 2, v4
    v_and_b32 v9, 3, v4
    v_and_b32 v10, 1, v5
    v_lshl_or_b32 v11, v10, 2, v8
    v_lshrrev_b32 v14, 1, v8
    v_lshl_or_b32 v14, v10, 1, v14
    s_cmp_eq_u32 s75, 0
    s_cselect_b64 vcc, -1, 0
    v_lshl_add_u32 v12, v3, 3, v8
    v_lshlrev_b32 v12, s50, v12
    v_cndmask_b32 v11, v14, v11, vcc
    v_lshl_add_u32 v12, v9, 3, v12
    v_lshlrev_b32 v10, s51, v10
    v_add3_u32 v12, v12, v10, s52
    v_add_u32 v12, 8192, v12
    v_xor_b32 v13, s58, v11
    v_and_b32 v13, 7, v13
    v_lshl_add_u32 v29, v13, 5, v12
    v_add_u32 v30, s53, v29
    v_add_u32 v31, s53, v30
    v_xor_b32 v13, s59, v11
    v_and_b32 v13, 7, v13
    v_lshl_add_u32 v32, v13, 5, v12
    v_add_u32 v33, s53, v32
    v_add_u32 v34, s53, v33
    v_xor_b32 v13, s60, v11
    v_and_b32 v13, 7, v13
    v_lshl_add_u32 v35, v13, 5, v12
    v_add_u32 v36, s53, v35
    v_add_u32 v37, s53, v36
    v_xor_b32 v13, s61, v11
    v_and_b32 v13, 7, v13
    v_lshl_add_u32 v38, v13, 5, v12
    v_add_u32 v39, s53, v38
    v_add_u32 v40, s53, v39
    s_lshl_b32 s54, s39, 11
    s_add_u32 s54, s54, s52
    v_and_b32 v8, 1, v5
    v_lshlrev_b32 v8, 10, v8
    v_lshl_add_u32 v8, v4, 6, v8
    v_add_u32 v8, s54, v8
    v_lshrrev_b32 v9, 2, v4
    v_xor_b32 v9, v9, v3
    v_lshl_add_u32 v41, v9, 4, v8
    v_add_u32 v42, s53, v41
    v_add_u32 v43, s53, v42
    v_xor_b32 v9, 2, v9
    v_lshl_add_u32 v44, v9, 4, v8
    v_add_u32 v45, s53, v44
    v_add_u32 v46, s53, v45
    v_mov_b32 v48, 0
    v_mov_b32 v49, 0
    s_cmp_eq_u32 s75, 0
    s_cbranch_scc1 L_NOF
    v_and_b32 v47, 1, v4
    v_lshlrev_b32 v47, 31, v47
    v_bfe_u32 v11, v1, 4, 1
    v_cvt_f32_u32 v11, v11
    v_mul_f32 v11, 0x3e800000, v11
    s_lshl_b32 s51, s38, 13
    v_add_u32 v20, s51, v6
    s_lshr_b32 s50, s37, 2
    s_lshl_b32 s50, s50, 6
    s_add_u32 s50, s50, 0
    v_add_u32 v8, s50, v4
    v_cmp_eq_u32 vcc, 0, v8
    v_mov_b32 v9, 256
    s_nop 0
    v_cndmask_b32 v8, v8, v9, vcc
    v_cvt_f32_u32 v10, v8
    v_mul_f32 v10, 0x3b000000, v10
    s_lshl_b32 s50, s38, 5
    s_add_u32 s50, s50, 0
    v_lshlrev_b32 v12, 3, v3
    v_add_u32 v12, s50, v12
    v_cvt_f32_u32 v12, v12
    v_fma_f32 v12, v12, v10, v11
    v_fract_f32 v12, v12
    v_add_f32 v13, v12, v10
    v_add_f32 v14, v13, v10
    v_add_f32 v15, v14, v10
    v_add_f32 v16, v15, v10
    v_add_f32 v17, v16, v10
    v_add_f32 v18, v17, v10
    v_add_f32 v19, v18, v10
    v_cos_f32 v12, v12
    v_cos_f32 v13, v13
    v_cos_f32 v14, v14
    v_cos_f32 v15, v15
    v_cos_f32 v16, v16
    v_cos_f32 v17, v17
    v_cos_f32 v18, v18
    v_cos_f32 v19, v19
    s_nop 0
    v_cvt_pk_bf16_f32 v56, v12, v13
    v_cvt_pk_bf16_f32 v57, v14, v15
    v_cvt_pk_bf16_f32 v58, v16, v17
    v_cvt_pk_bf16_f32 v59, v18, v19
    ds_write_b128 v20, v[56:59] offset:0
    s_lshl_b32 s50, s38, 5
    s_add_u32 s50, s50, 16
    v_lshlrev_b32 v12, 3, v3
    v_add_u32 v12, s50, v12
    v_cvt_f32_u32 v12, v12
    v_fma_f32 v12, v12, v10, v11
    v_fract_f32 v12, v12
    v_add_f32 v13, v12, v10
    v_add_f32 v14, v13, v10
    v_add_f32 v15, v14, v10
    v_add_f32 v16, v15, v10
    v_add_f32 v17, v16, v10
    v_add_f32 v18, v17, v10
    v_add_f32 v19, v18, v10
    v_cos_f32 v12, v12
    v_cos_f32 v13, v13
    v_cos_f32 v14, v14
    v_cos_f32 v15, v15
    v_cos_f32 v16, v16
    v_cos_f32 v17, v17
    v_cos_f32 v18, v18
    v_cos_f32 v19, v19
    s_nop 0
    v_cvt_pk_bf16_f32 v64, v12, v13
    v_cvt_pk_bf16_f32 v65, v14, v15
    v_cvt_pk_bf16_f32 v66, v16, v17
    v_cvt_pk_bf16_f32 v67, v18, v19
    ds_write_b128 v20, v[64:67] offset:4096
    s_lshr_b32 s50, s37, 2
    s_lshl_b32 s50, s50, 6
    s_add_u32 s50, s50, 16
    v_add_u32 v8, s50, v4
    v_cvt_f32_u32 v10, v8
    v_mul_f32 v10, 0x3b000000, v10
    s_lshl_b32 s50, s38, 5
    s_add_u32 s50, s50, 0
    v_lshlrev_b32 v12, 3, v3
    v_add_u32 v12, s50, v12
    v_cvt_f32_u32 v12, v12
    v_fma_f32 v12, v12, v10, v11
    v_fract_f32 v12, v12
    v_add_f32 v13, v12, v10
    v_add_f32 v14, v13, v10
    v_add_f32 v15, v14, v10
    v_add_f32 v16, v15, v10
    v_add_f32 v17, v16, v10
    v_add_f32 v18, v17, v10
    v_add_f32 v19, v18, v10
    v_cos_f32 v12, v12
    v_cos_f32 v13, v13
    v_cos_f32 v14, v14
    v_cos_f32 v15, v15
    v_cos_f32 v16, v16
    v_cos_f32 v17, v17
    v_cos_f32 v18, v18
    v_cos_f32 v19, v19
    s_nop 0
    v_cvt_pk_bf16_f32 v60, v12, v13
    v_cvt_pk_bf16_f32 v61, v14, v15
    v_cvt_pk_bf16_f32 v62, v16, v17
    v_cvt_pk_bf16_f32 v63, v18, v19
    ds_write_b128 v20, v[60:63] offset:1024
    s_lshl_b32 s50, s38, 5
    s_add_u32 s50, s50, 16
    v_lshlrev_b32 v12, 3, v3
    v_add_u32 v12, s50, v12
    v_cvt_f32_u32 v12, v12
    v_fma_f32 v12, v12, v10, v11
    v_fract_f32 v12, v12
    v_add_f32 v13, v12, v10
    v_add_f32 v14, v13, v10
    v_add_f32 v15, v14, v10
    v_add_f32 v16, v15, v10
    v_add_f32 v17, v16, v10
    v_add_f32 v18, v17, v10
    v_add_f32 v19, v18, v10
    v_cos_f32 v12, v12
    v_cos_f32 v13, v13
    v_cos_f32 v14, v14
    v_cos_f32 v15, v15
    v_cos_f32 v16, v16
    v_cos_f32 v17, v17
    v_cos_f32 v18, v18
    v_cos_f32 v19, v19
    s_nop 0
    v_cvt_pk_bf16_f32 v68, v12, v13
    v_cvt_pk_bf16_f32 v69, v14, v15
    v_cvt_pk_bf16_f32 v70, v16, v17
    v_cvt_pk_bf16_f32 v71, v18, v19
    ds_write_b128 v20, v[68:71] offset:5120
    s_lshr_b32 s50, s37, 2
    s_lshl_b32 s50, s50, 6
    s_add_u32 s50, s50, 32
    v_add_u32 v8, s50, v4
    v_cvt_f32_u32 v10, v8
    v_mul_f32 v10, 0x3b000000, v10
    s_lshl_b32 s50, s38, 5
    s_add_u32 s50, s50, 0
    v_lshlrev_b32 v12, 3, v3
    v_add_u32 v12, s50, v12
    v_cvt_f32_u32 v12, v12
    v_fma_f32 v12, v12, v10, v11
    v_fract_f32 v12, v12
    v_add_f32 v13, v12, v10
    v_add_f32 v14, v13, v10
    v_add_f32 v15, v14, v10
    v_add_f32 v16, v15, v10
    v_add_f32 v17, v16, v10
    v_add_f32 v18, v17, v10
    v_add_f32 v19, v18, v10
    v_cos_f32 v12, v12
    v_cos_f32 v13, v13
    v_cos_f32 v14, v14
    v_cos_f32 v15, v15
    v_cos_f32 v16, v16
    v_cos_f32 v17, v17
    v_cos_f32 v18, v18
    v_cos_f32 v19, v19
    s_nop 0
    v_cvt_pk_bf16_f32 v56, v12, v13
    v_cvt_pk_bf16_f32 v57, v14, v15
    v_cvt_pk_bf16_f32 v58, v16, v17
    v_cvt_pk_bf16_f32 v59, v18, v19
    ds_write_b128 v20, v[56:59] offset:2048
    s_lshl_b32 s50, s38, 5
    s_add_u32 s50, s50, 16
    v_lshlrev_b32 v12, 3, v3
    v_add_u32 v12, s50, v12
    v_cvt_f32_u32 v12, v12
    v_fma_f32 v12, v12, v10, v11
    v_fract_f32 v12, v12
    v_add_f32 v13, v12, v10
    v_add_f32 v14, v13, v10
    v_add_f32 v15, v14, v10
    v_add_f32 v16, v15, v10
    v_add_f32 v17, v16, v10
    v_add_f32 v18, v17, v10
    v_add_f32 v19, v18, v10
    v_cos_f32 v12, v12
    v_cos_f32 v13, v13
    v_cos_f32 v14, v14
    v_cos_f32 v15, v15
    v_cos_f32 v16, v16
    v_cos_f32 v17, v17
    v_cos_f32 v18, v18
    v_cos_f32 v19, v19
    s_nop 0
    v_cvt_pk_bf16_f32 v64, v12, v13
    v_cvt_pk_bf16_f32 v65, v14, v15
    v_cvt_pk_bf16_f32 v66, v16, v17
    v_cvt_pk_bf16_f32 v67, v18, v19
    ds_write_b128 v20, v[64:67] offset:6144
    s_lshr_b32 s50, s37, 2
    s_lshl_b32 s50, s50, 6
    s_add_u32 s50, s50, 48
    v_add_u32 v8, s50, v4
    v_cvt_f32_u32 v10, v8
    v_mul_f32 v10, 0x3b000000, v10
    s_lshl_b32 s50, s38, 5
    s_add_u32 s50, s50, 0
    v_lshlrev_b32 v12, 3, v3
    v_add_u32 v12, s50, v12
    v_cvt_f32_u32 v12, v12
    v_fma_f32 v12, v12, v10, v11
    v_fract_f32 v12, v12
    v_add_f32 v13, v12, v10
    v_add_f32 v14, v13, v10
    v_add_f32 v15, v14, v10
    v_add_f32 v16, v15, v10
    v_add_f32 v17, v16, v10
    v_add_f32 v18, v17, v10
    v_add_f32 v19, v18, v10
    v_cos_f32 v12, v12
    v_cos_f32 v13, v13
    v_cos_f32 v14, v14
    v_cos_f32 v15, v15
    v_cos_f32 v16, v16
    v_cos_f32 v17, v17
    v_cos_f32 v18, v18
    v_cos_f32 v19, v19
    s_nop 0
    v_cvt_pk_bf16_f32 v60, v12, v13
    v_cvt_pk_bf16_f32 v61, v14, v15
    v_cvt_pk_bf16_f32 v62, v16, v17
    v_cvt_pk_bf16_f32 v63, v18, v19
    ds_write_b128 v20, v[60:63] offset:3072
    s_lshl_b32 s50, s38, 5
    s_add_u32 s50, s50, 16
    v_lshlrev_b32 v12, 3, v3
    v_add_u32 v12, s50, v12
    v_cvt_f32_u32 v12, v12
    v_fma_f32 v12, v12, v10, v11
    v_fract_f32 v12, v12
    v_add_f32 v13, v12, v10
    v_add_f32 v14, v13, v10
    v_add_f32 v15, v14, v10
    v_add_f32 v16, v15, v10
    v_add_f32 v17, v16, v10
    v_add_f32 v18, v17, v10
    v_add_f32 v19, v18, v10
    v_cos_f32 v12, v12
    v_cos_f32 v13, v13
    v_cos_f32 v14, v14
    v_cos_f32 v15, v15
    v_cos_f32 v16, v16
    v_cos_f32 v17, v17
    v_cos_f32 v18, v18
    v_cos_f32 v19, v19
    s_nop 0
    v_cvt_pk_bf16_f32 v68, v12, v13
    v_cvt_pk_bf16_f32 v69, v14, v15
    v_cvt_pk_bf16_f32 v70, v16, v17
    v_cvt_pk_bf16_f32 v71, v18, v19
    ds_write_b128 v20, v[68:71] offset:7168
L_NOF:
    s_waitcnt lgkmcnt(0)
    s_mul_i32 s49, s49, 0x9E3779B1
    s_add_u32 s49, s49, 0x7F4A7C15
    v_mov_b32 v24, s49
    v_mov_b32 v25, 0
    s_cmp_eq_u32 s75, 0
    s_cbranch_scc1 L_MA
    s_cmp_eq_u32 s40, 0
    s_cbranch_scc1 L_MBW
    s_branch L_MBF
L_MA:
    s_add_u32 m0, s47, 65536
    s_mov_b32 s42, 128
    buffer_load_dwordx4 v26, s[4:7], s42 offen lds
    s_add_u32 m0, s47, 73728
    s_mov_b32 s42, 229376
    buffer_load_dwordx4 v27, s[8:11], s42 offen lds
    s_add_u32 m0, s47, 81920
    s_mov_b32 s42, 229376
    buffer_load_dwordx4 v28, s[12:15], s42 offen lds
    s_add_u32 m0, s47, 90112
    s_mov_b32 s42, 192
    buffer_load_dwordx4 v26, s[4:7], s42 offen lds
    s_add_u32 m0, s47, 98304
    s_mov_b32 s42, 344064
    buffer_load_dwordx4 v27, s[8:11], s42 offen lds
    s_add_u32 m0, s47, 106496
    s_mov_b32 s42, 344064
    buffer_load_dwordx4 v28, s[12:15], s42 offen lds
    s_add_u32 m0, s47, 114688
    s_mov_b32 s42, 256
    buffer_load_dwordx4 v26, s[4:7], s42 offen lds
    s_add_u32 m0, s47, 122880
    s_mov_b32 s42, 458752
    buffer_load_dwordx4 v27, s[8:11], s42 offen lds
    s_add_u32 m0, s47, 131072
    s_mov_b32 s42, 458752
    buffer_load_dwordx4 v28, s[12:15], s42 offen lds
    s_lshr_b32 s46, s2, 3
    s_and_b32 s44, s46, 7
    s_lshl_b32 s44, s44, 3
    s_add_u32 s44, s44, s38
    s_and_b32 s45, s2, 7
    s_lshl_b32 s45, s45, 2
    s_lshr_b32 s46, s46, 3
    s_add_u32 s45, s45, s46
    s_lshl_b32 s43, s45, 6
    s_add_u32 s43, s43, s44
    s_lshl_b32 s44, s44, 15
    s_lshl_b32 s45, s45, 10
    s_add_u32 s44, s44, s45
    buffer_load_dwordx4 v[176:179], v6, s[4:7], s44 offen
    s_lshr_b32 s44, s2, 4
    s_lshl_b32 s44, s44, 4
    v_add_u32 v186, s44, v4
    v_lshrrev_b32 v190, 2, v1
    v_add_u32 v190, s44, v190
    s_and_b32 s45, s2, 7
    s_lshl_b32 s45, s45, 1
    s_bfe_u32 s46, s2, 0x10003
    s_add_u32 s45, s45, s46
    s_lshr_b32 s46, s45, 2
    s_and_b32 s48, s45, 3
    s_lshl_b32 s48, s48, 1
    s_add_u32 s48, s48, s40
    s_lshl_b32 s41, s48, 8
    s_lshl_b32 s73, s46, 4
    s_add_u32 s41, s41, s73
    s_lshl_b32 s73, s39, 2
    s_add_u32 s41, s41, s73
    v_add_u32 v187, s41, v5
    s_movk_i32 s73, 257
    v_mul_lo_u32 v187, v187, s73
    v_cmp_eq_u32 vcc, 0, v186
    v_mov_b32 v188, 256
    s_nop 0
    v_cndmask_b32 v188, v186, v188, vcc
    v_add_lshl_u32 v181, v187, v188, 1
    s_lshl_b32 s46, s46, 7
    s_lshl_b32 s48, s48, 4
    s_add_u32 s46, s46, s48
    s_lshl_b32 s73, s39, 2
    s_add_u32 s46, s46, s73
    v_and_b32 v188, 3, v1
    v_add_u32 v188, s46, v188
    v_lshlrev_b32 v188, 4, v188
    s_movk_i32 s73, 8448
    v_mad_u32_u24 v180, v190, s73, v188
    s_mov_b32 s57, 0
    buffer_load_ushort v168, v181, s[20:23], s57 offen
    s_mov_b32 s57, 0
    buffer_load_ushort v172, v181, s[24:27], s57 offen
    s_mov_b32 s57, 32896
    buffer_load_ushort v169, v181, s[20:23], s57 offen
    s_mov_b32 s57, 32896
    buffer_load_ushort v173, v181, s[24:27], s57 offen
    s_mov_b32 s57, 65792
    buffer_load_ushort v170, v181, s[20:23], s57 offen
    s_mov_b32 s57, 65792
    buffer_load_ushort v174, v181, s[24:27], s57 offen
    s_mov_b32 s57, 98688
    buffer_load_ushort v171, v181, s[20:23], s57 offen
    s_mov_b32 s57, 98688
    buffer_load_ushort v175, v181, s[24:27], s57 offen
    s_waitcnt vmcnt(21)
    s_barrier
    ds_read_b128 v[56:59], v41 offset:16384
    ds_read_b64_tr_b16 v[72:73], v29 offset:16384
    ds_read_b64_tr_b16 v[74:75], v29 offset:17408
    ds_read_b64_tr_b16 v[80:81], v32 offset:16384
    ds_read_b64_tr_b16 v[82:83], v32 offset:17408
    ds_read_b128 v[60:63], v44 offset:16384
    ds_read_b64_tr_b16 v[76:77], v29 offset:20480
    ds_read_b64_tr_b16 v[78:79], v29 offset:21504
    ds_read_b64_tr_b16 v[84:85], v32 offset:20480
    ds_read_b64_tr_b16 v[86:87], v32 offset:21504
    s_and_b32 s50, s2, 7
    s_lshr_b32 s51, s2, 3
    s_lshl_b32 s53, s51, 3
    s_add_u32 s53, s53, s38
    s_cmp_lt_u32 s53, 128
    s_cbranch_scc0 LPF1W
    s_and_b32 s54, s53, 15
    s_lshl_b32 s54, s54, 2
    v_add_u32 v14, s54, v5
    v_lshlrev_b32 v14, 15, v14
    v_lshl_add_u32 v14, v4, 10, v14
    s_and_b32 s54, s50, 1
    s_lshl_b32 s54, s54, 14
    s_lshr_b32 s53, s53, 4
    s_cmp_lt_u32 s53, 3
    s_cselect_b32 s55, 0x10000000, 0
    s_lshl_b32 s53, s53, 7
    s_add_u32 s54, s54, s53
    s_add_u32 s54, s54, s55
    buffer_load_dword v182, v14, s[4:7], s54 offen
    s_branch LPF1D
LPF1W:
    s_sub_u32 s53, s53, 128
    s_and_b32 s54, s53, 63
    s_cmp_lt_u32 s54, 24
    s_cselect_b32 s55, 0x10000000, 0
    s_lshl_b32 s54, s54, 3
    v_lshrrev_b32 v14, 3, v1
    v_add_u32 v14, s54, v14
    s_movk_i32 s54, 3584
    v_mul_lo_u32 v14, v14, s54
    v_and_b32 v15, 7, v1
    v_lshl_add_u32 v14, v15, 7, v14
    s_lshr_b32 s54, s50, 1
    s_mul_i32 s54, s54, 896
    s_add_u32 s54, s54, s55
    s_cmp_lt_u32 s53, 64
    s_cbranch_scc0 LPF1U
    buffer_load_dword v182, v14, s[8:11], s54 offen
    s_branch LPF1D
LPF1U:
    buffer_load_dword v182, v14, s[12:15], s54 offen
LPF1D:
    s_waitcnt lgkmcnt(7)
    v_mfma_f32_32x32x16_bf16 v[104:119], v[72:75], v[56:59], 0
    ds_read_b64_tr_b16 v[88:89], v35 offset:16384
    ds_read_b64_tr_b16 v[90:91], v35 offset:17408
    v_lshlrev_b32 v50, 16, v72
    v_and_b32 v51, 0xffff0000, v72
    v_add_f32 v48, v48, v50
    v_add_f32 v49, v49, v51
    v_lshlrev_b32 v52, 16, v73
    v_and_b32 v53, 0xffff0000, v73
    v_add_f32 v48, v48, v52
    v_add_f32 v49, v49, v53
    s_waitcnt lgkmcnt(7)
    v_mfma_f32_32x32x16_bf16 v[120:135], v[80:83], v[56:59], 0
    ds_read_b64_tr_b16 v[96:97], v38 offset:16384
    ds_read_b64_tr_b16 v[98:99], v38 offset:17408
    v_lshlrev_b32 v50, 16, v74
    v_and_b32 v51, 0xffff0000, v74
    v_add_f32 v48, v48, v50
    v_add_f32 v49, v49, v51
    v_lshlrev_b32 v52, 16, v75
    v_and_b32 v53, 0xffff0000, v75
    v_add_f32 v48, v48, v52
    v_add_f32 v49, v49, v53
    s_waitcnt lgkmcnt(6)
    v_mfma_f32_32x32x16_bf16 v[104:119], v[76:79], v[60:63], v[104:119]
    ds_read_b64_tr_b16 v[92:93], v35 offset:20480
    ds_read_b64_tr_b16 v[94:95], v35 offset:21504
    v_lshlrev_b32 v50, 16, v76
    v_and_b32 v51, 0xffff0000, v76
    v_add_f32 v48, v48, v50
    v_add_f32 v49, v49, v51
    v_lshlrev_b32 v52, 16, v77
    v_and_b32 v53, 0xffff0000, v77
    v_add_f32 v48, v48, v52
    v_add_f32 v49, v49, v53
    s_waitcnt lgkmcnt(6)
    v_mfma_f32_32x32x16_bf16 v[120:135], v[84:87], v[60:63], v[120:135]
    ds_read_b64_tr_b16 v[100:101], v38 offset:20480
    ds_read_b64_tr_b16 v[102:103], v38 offset:21504
    v_lshlrev_b32 v50, 16, v78
    v_and_b32 v51, 0xffff0000, v78
    v_add_f32 v48, v48, v50
    v_add_f32 v49, v49, v51
    v_lshlrev_b32 v52, 16, v79
    v_and_b32 v53, 0xffff0000, v79
    v_add_f32 v48, v48, v52
    v_add_f32 v49, v49, v53
    s_waitcnt vmcnt(19)
    s_barrier
    s_waitcnt lgkmcnt(6)
    v_mfma_f32_32x32x16_bf16 v[136:151], v[88:91], v[56:59], 0
    ds_read_b128 v[64:67], v41 offset:40960
    ds_read_b64_tr_b16 v[72:73], v29 offset:40960
    ds_read_b64_tr_b16 v[74:75], v29 offset:41984
    s_add_u32 m0, s47, 139264
    s_mov_b32 s42, 320
    buffer_load_dwordx4 v26, s[4:7], s42 offen lds
    s_waitcnt lgkmcnt(7)
    v_mfma_f32_32x32x16_bf16 v[152:167], v[96:99], v[56:59], 0
    ds_read_b64_tr_b16 v[80:81], v32 offset:40960
    ds_read_b64_tr_b16 v[82:83], v32 offset:41984
    s_waitcnt lgkmcnt(7)
    v_mfma_f32_32x32x16_bf16 v[136:151], v[92:95], v[60:63], v[136:151]
    ds_read_b128 v[68:71], v44 offset:40960
    ds_read_b64_tr_b16 v[76:77], v29 offset:45056
    ds_read_b64_tr_b16 v[78:79], v29 offset:46080
    s_waitcnt lgkmcnt(8)
    v_mfma_f32_32x32x16_bf16 v[152:167], v[100:103], v[60:63], v[152:167]
    ds_read_b64_tr_b16 v[84:85], v32 offset:45056
    ds_read_b64_tr_b16 v[86:87], v32 offset:46080
    s_add_u32 m0, s47, 147456
    s_mov_b32 s42, 573440
    buffer_load_dwordx4 v27, s[8:11], s42 offen lds
    s_waitcnt lgkmcnt(7)
    v_mfma_f32_32x32x16_bf16 v[104:119], v[72:75], v[64:67], v[104:119]
    ds_read_b64_tr_b16 v[88:89], v35 offset:40960
    ds_read_b64_tr_b16 v[90:91], v35 offset:41984
    v_lshlrev_b32 v50, 16, v72
    v_and_b32 v51, 0xffff0000, v72
    v_add_f32 v48, v48, v50
    v_add_f32 v49, v49, v51
    v_lshlrev_b32 v52, 16, v73
    v_and_b32 v53, 0xffff0000, v73
    v_add_f32 v48, v48, v52
    v_add_f32 v49, v49, v53
    s_waitcnt lgkmcnt(7)
    v_mfma_f32_32x32x16_bf16 v[120:135], v[80:83], v[64:67], v[120:135]
    ds_read_b64_tr_b16 v[96:97], v38 offset:40960
    ds_read_b64_tr_b16 v[98:99], v38 offset:41984
    v_lshlrev_b32 v50, 16, v74
    v_and_b32 v51, 0xffff0000, v74
    v_add_f32 v48, v48, v50
    v_add_f32 v49, v49, v51
    v_lshlrev_b32 v52, 16, v75
    v_and_b32 v53, 0xffff0000, v75
    v_add_f32 v48, v48, v52
    v_add_f32 v49, v49, v53
    s_waitcnt lgkmcnt(6)
    v_mfma_f32_32x32x16_bf16 v[104:119], v[76:79], v[68:71], v[104:119]
    ds_read_b64_tr_b16 v[92:93], v35 offset:45056
    ds_read_b64_tr_b16 v[94:95], v35 offset:46080
    v_lshlrev_b32 v50, 16, v76
    v_and_b32 v51, 0xffff0000, v76
    v_add_f32 v48, v48, v50
    v_add_f32 v49, v49, v51
    v_lshlrev_b32 v52, 16, v77
    v_and_b32 v53, 0xffff0000, v77
    v_add_f32 v48, v48, v52
    v_add_f32 v49, v49, v53
    s_add_u32 m0, s47, 155648
    s_mov_b32 s42, 573440
    buffer_load_dwordx4 v28, s[12:15], s42 offen lds
    s_waitcnt lgkmcnt(6)
    v_mfma_f32_32x32x16_bf16 v[120:135], v[84:87], v[68:71], v[120:135]
    ds_read_b64_tr_b16 v[100:101], v38 offset:45056
    ds_read_b64_tr_b16 v[102:103], v38 offset:46080
    v_lshlrev_b32 v50, 16, v78
    v_and_b32 v51, 0xffff0000, v78
    v_add_f32 v48, v48, v50
    v_add_f32 v49, v49, v51
    v_lshlrev_b32 v52, 16, v79
    v_and_b32 v53, 0xffff0000, v79
    v_add_f32 v48, v48, v52
    v_add_f32 v49, v49, v53
    s_waitcnt vmcnt(19)
    s_barrier
    s_waitcnt lgkmcnt(6)
    v_mfma_f32_32x32x16_bf16 v[136:151], v[88:91], v[64:67], v[136:151]
    ds_read_b128 v[56:59], v42 offset:16384
    ds_read_b64_tr_b16 v[72:73], v30 offset:16384
    ds_read_b64_tr_b16 v[74:75], v30 offset:17408
    s_waitcnt vmcnt(12)
    v_lshlrev_b32 v186, 16, v176
    v_and_b32 v187, 0xffff0000, v176
    s_add_u32 m0, s47, 16384
    s_mov_b32 s42, 384
    buffer_load_dwordx4 v26, s[4:7], s42 offen lds
    s_waitcnt lgkmcnt(7)
    v_mfma_f32_32x32x16_bf16 v[152:167], v[96:99], v[64:67], v[152:167]
    ds_read_b64_tr_b16 v[80:81], v33 offset:16384
    ds_read_b64_tr_b16 v[82:83], v33 offset:17408
    v_lshlrev_b32 v188, 16, v177
    v_and_b32 v189, 0xffff0000, v177
    s_waitcnt lgkmcnt(7)
    v_mfma_f32_32x32x16_bf16 v[136:151], v[92:95], v[68:71], v[136:151]
    ds_read_b128 v[60:63], v45 offset:16384
    ds_read_b64_tr_b16 v[76:77], v30 offset:20480
    ds_read_b64_tr_b16 v[78:79], v30 offset:21504
    v_lshlrev_b32 v190, 16, v178
    v_and_b32 v191, 0xffff0000, v178
    s_waitcnt lgkmcnt(8)
    v_mfma_f32_32x32x16_bf16 v[152:167], v[100:103], v[68:71], v[152:167]
    ds_read_b64_tr_b16 v[84:85], v33 offset:20480
    ds_read_b64_tr_b16 v[86:87], v33 offset:21504
    v_lshlrev_b32 v192, 16, v179
    v_and_b32 v193, 0xffff0000, v179
    s_add_u32 m0, s47, 24576
    s_mov_b32 s42, 688128
    buffer_load_dwordx4 v27, s[8:11], s42 offen lds
    s_waitcnt lgkmcnt(7)
    v_mfma_f32_32x32x16_bf16 v[104:119], v[72:75], v[56:59], v[104:119]
    ds_read_b64_tr_b16 v[88:89], v36 offset:16384
    ds_read_b64_tr_b16 v[90:91], v36 offset:17408
    v_lshlrev_b32 v50, 16, v72
    v_and_b32 v51, 0xffff0000, v72
    v_add_f32 v48, v48, v50
    v_add_f32 v49, v49, v51
    v_lshlrev_b32 v52, 16, v73
    v_and_b32 v53, 0xffff0000, v73
    v_add_f32 v48, v48, v52
    v_add_f32 v49, v49, v53
    v_add_f32 v176, v186, v187
    v_mul_f32 v177, v186, v186
    s_waitcnt lgkmcnt(7)
    v_mfma_f32_32x32x16_bf16 v[120:135], v[80:83], v[56:59], v[120:135]
    ds_read_b64_tr_b16 v[96:97], v39 offset:16384
    ds_read_b64_tr_b16 v[98:99], v39 offset:17408
    v_lshlrev_b32 v50, 16, v74
    v_and_b32 v51, 0xffff0000, v74
    v_add_f32 v48, v48, v50
    v_add_f32 v49, v49, v51
    v_lshlrev_b32 v52, 16, v75
    v_and_b32 v53, 0xffff0000, v75
    v_add_f32 v48, v48, v52
    v_add_f32 v49, v49, v53
    v_fma_f32 v177, v187, v187, v177
    v_add_f32 v176, v176, v188
    s_waitcnt lgkmcnt(6)
    v_mfma_f32_32x32x16_bf16 v[104:119], v[76:79], v[60:63], v[104:119]
    ds_read_b64_tr_b16 v[92:93], v36 offset:20480
    ds_read_b64_tr_b16 v[94:95], v36 offset:21504
    v_lshlrev_b32 v50, 16, v76
    v_and_b32 v51, 0xffff0000, v76
    v_add_f32 v48, v48, v50
    v_add_f32 v49, v49, v51
    v_lshlrev_b32 v52, 16, v77
    v_and_b32 v53, 0xffff0000, v77
    v_add_f32 v48, v48, v52
    v_add_f32 v49, v49, v53
    v_fma_f32 v177, v188, v188, v177
    v_add_f32 v176, v176, v189
    s_add_u32 m0, s47, 32768
    s_mov_b32 s42, 688128
    buffer_load_dwordx4 v28, s[12:15], s42 offen lds
    s_waitcnt lgkmcnt(6)
    v_mfma_f32_32x32x16_bf16 v[120:135], v[84:87], v[60:63], v[120:135]
    ds_read_b64_tr_b16 v[100:101], v39 offset:20480
    ds_read_b64_tr_b16 v[102:103], v39 offset:21504
    v_lshlrev_b32 v50, 16, v78
    v_and_b32 v51, 0xffff0000, v78
    v_add_f32 v48, v48, v50
    v_add_f32 v49, v49, v51
    v_lshlrev_b32 v52, 16, v79
    v_and_b32 v53, 0xffff0000, v79
    v_add_f32 v48, v48, v52
    v_add_f32 v49, v49, v53
    v_fma_f32 v177, v189, v189, v177
    v_add_f32 v176, v176, v190
    s_barrier
    s_waitcnt lgkmcnt(6)
    v_mfma_f32_32x32x16_bf16 v[136:151], v[88:91], v[56:59], v[136:151]
    ds_read_b128 v[64:67], v42 offset:40960
    ds_read_b64_tr_b16 v[72:73], v30 offset:40960
    ds_read_b64_tr_b16 v[74:75], v30 offset:41984
    v_fma_f32 v177, v190, v190, v177
    v_add_f32 v176, v176, v191
    s_add_u32 m0, s47, 40960
    s_mov_b32 s42, 448
    buffer_load_dwordx4 v26, s[4:7], s42 offen lds
    s_waitcnt lgkmcnt(7)
    v_mfma_f32_32x32x16_bf16 v[152:167], v[96:99], v[56:59], v[152:167]
    ds_read_b64_tr_b16 v[80:81], v33 offset:40960
    ds_read_b64_tr_b16 v[82:83], v33 offset:41984
    v_fma_f32 v177, v191, v191, v177
    v_add_f32 v176, v176, v192
    s_waitcnt lgkmcnt(7)
    v_mfma_f32_32x32x16_bf16 v[136:151], v[92:95], v[60:63], v[136:151]
    ds_read_b128 v[68:71], v45 offset:40960
    ds_read_b64_tr_b16 v[76:77], v30 offset:45056
    ds_read_b64_tr_b16 v[78:79], v30 offset:46080
    v_fma_f32 v177, v192, v192, v177
    v_add_f32 v176, v176, v193
    s_waitcnt lgkmcnt(8)
    v_mfma_f32_32x32x16_bf16 v[152:167], v[100:103], v[60:63], v[152:167]
    ds_read_b64_tr_b16 v[84:85], v33 offset:45056
    ds_read_b64_tr_b16 v[86:87], v33 offset:46080
    v_fma_f32 v177, v193, v193, v177
    s_nop 1
    v_add_f32_dpp v176, v176, v176 row_ror:8 row_mask:0xf bank_mask:0xf
    v_add_f32_dpp v177, v177, v177 row_ror:8 row_mask:0xf bank_mask:0xf
    s_add_u32 m0, s47, 49152
    s_mov_b32 s42, 802816
    buffer_load_dwordx4 v27, s[8:11], s42 offen lds
    s_waitcnt lgkmcnt(7)
    v_mfma_f32_32x32x16_bf16 v[104:119], v[72:75], v[64:67], v[104:119]
    ds_read_b64_tr_b16 v[88:89], v36 offset:40960
    ds_read_b64_tr_b16 v[90:91], v36 offset:41984
    v_lshlrev_b32 v50, 16, v72
    v_and_b32 v51, 0xffff0000, v72
    v_add_f32 v48, v48, v50
    v_add_f32 v49, v49, v51
    v_lshlrev_b32 v52, 16, v73
    v_and_b32 v53, 0xffff0000, v73
    v_add_f32 v48, v48, v52
    v_add_f32 v49, v49, v53
    s_nop 1
    v_add_f32_dpp v176, v176, v176 row_ror:4 row_mask:0xf bank_mask:0xf
    v_add_f32_dpp v177, v177, v177 row_ror:4 row_mask:0xf bank_mask:0xf
    s_waitcnt lgkmcnt(7)
    v_mfma_f32_32x32x16_bf16 v[120:135], v[80:83], v[64:67], v[120:135]
    ds_read_b64_tr_b16 v[96:97], v39 offset:40960
    ds_read_b64_tr_b16 v[98:99], v39 offset:41984
    v_lshlrev_b32 v50, 16, v74
    v_and_b32 v51, 0xffff0000, v74
    v_add_f32 v48, v48, v50
    v_add_f32 v49, v49, v51
    v_lshlrev_b32 v52, 16, v75
    v_and_b32 v53, 0xffff0000, v75
    v_add_f32 v48, v48, v52
    v_add_f32 v49, v49, v53
    s_nop 1
    v_add_f32_dpp v176, v176, v176 row_ror:2 row_mask:0xf bank_mask:0xf
    v_add_f32_dpp v177, v177, v177 row_ror:2 row_mask:0xf bank_mask:0xf
    s_waitcnt lgkmcnt(6)
    v_mfma_f32_32x32x16_bf16 v[104:119], v[76:79], v[68:71], v[104:119]
    ds_read_b64_tr_b16 v[92:93], v36 offset:45056
    ds_read_b64_tr_b16 v[94:95], v36 offset:46080
    v_lshlrev_b32 v50, 16, v76
    v_and_b32 v51, 0xffff0000, v76
    v_add_f32 v48, v48, v50
    v_add_f32 v49, v49, v51
    v_lshlrev_b32 v52, 16, v77
    v_and_b32 v53, 0xffff0000, v77
    v_add_f32 v48, v48, v52
    v_add_f32 v49, v49, v53
    s_nop 1
    v_add_f32_dpp v176, v176, v176 row_ror:1 row_mask:0xf bank_mask:0xf
    v_add_f32_dpp v177, v177, v177 row_ror:1 row_mask:0xf bank_mask:0xf
    s_add_u32 m0, s47, 57344
    s_mov_b32 s42, 802816
    buffer_load_dwordx4 v28, s[12:15], s42 offen lds
    s_waitcnt lgkmcnt(6)
    v_mfma_f32_32x32x16_bf16 v[120:135], v[84:87], v[68:71], v[120:135]
    ds_read_b64_tr_b16 v[100:101], v39 offset:45056
    ds_read_b64_tr_b16 v[102:103], v39 offset:46080
    v_lshlrev_b32 v50, 16, v78
    v_and_b32 v51, 0xffff0000, v78
    v_add_f32 v48, v48, v50
    v_add_f32 v49, v49, v51
    v_lshlrev_b32 v52, 16, v79
    v_and_b32 v53, 0xffff0000, v79
    v_add_f32 v48, v48, v52
    v_add_f32 v49, v49, v53
    v_mov_b32 v178, v176
    v_mov_b32 v179, v177
    s_nop 1
    v_permlane16_swap_b32 v176, v178
    v_permlane16_swap_b32 v177, v179
    s_nop 0
    v_add_f32 v176, v176, v178
    v_add_f32 v177, v177, v179
    s_barrier
    s_waitcnt lgkmcnt(6)
    v_mfma_f32_32x32x16_bf16 v[136:151], v[88:91], v[64:67], v[136:151]
    ds_read_b128 v[56:59], v43 offset:16384
    ds_read_b64_tr_b16 v[72:73], v31 offset:16384
    ds_read_b64_tr_b16 v[74:75], v31 offset:17408
    v_mov_b32 v178, v176
    v_mov_b32 v179, v177
    s_nop 1
    v_permlane32_swap_b32 v176, v178
    v_permlane32_swap_b32 v177, v179
    s_nop 0
    v_add_f32 v176, v176, v178
    v_add_f32 v177, v177, v179
    s_add_u32 m0, s47, 65536
    s_mov_b32 s42, 512
    buffer_load_dwordx4 v26, s[4:7], s42 offen lds
    s_waitcnt lgkmcnt(7)
    v_mfma_f32_32x32x16_bf16 v[152:167], v[96:99], v[64:67], v[152:167]
    ds_read_b64_tr_b16 v[80:81], v34 offset:16384
    ds_read_b64_tr_b16 v[82:83], v34 offset:17408
    v_mul_f32 v176, 0x3b000000, v176
    v_mul_f32 v177, 0x3b000000, v177
    s_waitcnt lgkmcnt(7)
    v_mfma_f32_32x32x16_bf16 v[136:151], v[92:95], v[68:71], v[136:151]
    ds_read_b128 v[60:63], v46 offset:16384
    ds_read_b64_tr_b16 v[76:77], v31 offset:20480
    ds_read_b64_tr_b16 v[78:79], v31 offset:21504
    v_fma_f32 v177, -v176, v176, v177
    v_max_f32 v177, 0, v177
    s_waitcnt lgkmcnt(8)
    v_mfma_f32_32x32x16_bf16 v[152:167], v[100:103], v[68:71], v[152:167]
    ds_read_b64_tr_b16 v[84:85], v34 offset:20480
    ds_read_b64_tr_b16 v[86:87], v34 offset:21504
    v_cvt_pk_bf16_f32 v178, v176, v177
    v_lshlrev_b32 v176, 16, v178
    v_and_b32 v177, 0xffff0000, v178
    s_add_u32 m0, s47, 73728
    s_mov_b32 s42, 917504
    buffer_load_dwordx4 v27, s[8:11], s42 offen lds
    s_waitcnt lgkmcnt(7)
    v_mfma_f32_32x32x16_bf16 v[104:119], v[72:75], v[56:59], v[104:119]
    ds_read_b64_tr_b16 v[88:89], v37 offset:16384
    ds_read_b64_tr_b16 v[90:91], v37 offset:17408
    v_lshlrev_b32 v50, 16, v72
    v_and_b32 v51, 0xffff0000, v72
    v_add_f32 v48, v48, v50
    v_add_f32 v49, v49, v51
    v_lshlrev_b32 v52, 16, v73
    v_and_b32 v53, 0xffff0000, v73
    v_add_f32 v48, v48, v52
    v_add_f32 v49, v49, v53
    v_add_f32 v177, 0x3727c5ac, v177
    v_cvt_pk_bf16_f32 v178, v177, v177
    v_lshlrev_b32 v177, 16, v178
    s_waitcnt lgkmcnt(7)
    v_mfma_f32_32x32x16_bf16 v[120:135], v[80:83], v[56:59], v[120:135]
    ds_read_b64_tr_b16 v[96:97], v40 offset:16384
    ds_read_b64_tr_b16 v[98:99], v40 offset:17408
    v_lshlrev_b32 v50, 16, v74
    v_and_b32 v51, 0xffff0000, v74
    v_add_f32 v48, v48, v50
    v_add_f32 v49, v49, v51
    v_lshlrev_b32 v52, 16, v75
    v_and_b32 v53, 0xffff0000, v75
    v_add_f32 v48, v48, v52
    v_add_f32 v49, v49, v53
    v_sqrt_f32 v177, v177
    s_nop 0
    v_cvt_pk_bf16_f32 v178, v177, v177
    v_lshlrev_b32 v177, 16, v178
    s_waitcnt lgkmcnt(6)
    v_mfma_f32_32x32x16_bf16 v[104:119], v[76:79], v[60:63], v[104:119]
    ds_read_b64_tr_b16 v[92:93], v37 offset:20480
    ds_read_b64_tr_b16 v[94:95], v37 offset:21504
    v_lshlrev_b32 v50, 16, v76
    v_and_b32 v51, 0xffff0000, v76
    v_add_f32 v48, v48, v50
    v_add_f32 v49, v49, v51
    v_lshlrev_b32 v52, 16, v77
    v_and_b32 v53, 0xffff0000, v77
    v_add_f32 v48, v48, v52
    v_add_f32 v49, v49, v53
    v_rcp_f32 v178, v177
    v_mov_b32 v179, v176
    s_nop 0
    s_add_u32 m0, s47, 81920
    s_mov_b32 s42, 917504
    buffer_load_dwordx4 v28, s[12:15], s42 offen lds
    s_waitcnt lgkmcnt(6)
    v_mfma_f32_32x32x16_bf16 v[120:135], v[84:87], v[60:63], v[120:135]
    ds_read_b64_tr_b16 v[100:101], v40 offset:20480
    ds_read_b64_tr_b16 v[102:103], v40 offset:21504
    v_lshlrev_b32 v50, 16, v78
    v_and_b32 v51, 0xffff0000, v78
    v_add_f32 v48, v48, v50
    v_add_f32 v49, v49, v51
    v_lshlrev_b32 v52, 16, v79
    v_and_b32 v53, 0xffff0000, v79
    v_add_f32 v48, v48, v52
    v_add_f32 v49, v49, v53
    s_lshl_b32 s44, s43, 3
    s_add_u32 s44, s44, 14024704
    s_mov_b64 s[62:63], exec
    s_mov_b64 exec, 1
    buffer_store_dwordx2 v[178:179], v25, s[28:31], s44 offen sc1
    s_mov_b64 exec, s[62:63]
    s_waitcnt vmcnt(10)
    s_barrier
    s_waitcnt lgkmcnt(6)
    v_mfma_f32_32x32x16_bf16 v[136:151], v[88:91], v[56:59], v[136:151]
    ds_read_b128 v[64:67], v43 offset:40960
    ds_read_b64_tr_b16 v[72:73], v31 offset:40960
    ds_read_b64_tr_b16 v[74:75], v31 offset:41984
    s_add_u32 m0, s47, 90112
    s_mov_b32 s42, 576
    buffer_load_dwordx4 v26, s[4:7], s42 offen lds
    s_waitcnt lgkmcnt(7)
    v_mfma_f32_32x32x16_bf16 v[152:167], v[96:99], v[56:59], v[152:167]
    ds_read_b64_tr_b16 v[80:81], v34 offset:40960
    ds_read_b64_tr_b16 v[82:83], v34 offset:41984
    s_waitcnt lgkmcnt(7)
    v_mfma_f32_32x32x16_bf16 v[136:151], v[92:95], v[60:63], v[136:151]
    ds_read_b128 v[68:71], v46 offset:40960
    ds_read_b64_tr_b16 v[76:77], v31 offset:45056
    ds_read_b64_tr_b16 v[78:79], v31 offset:46080
    s_waitcnt lgkmcnt(8)
    v_mfma_f32_32x32x16_bf16 v[152:167], v[100:103], v[60:63], v[152:167]
    ds_read_b64_tr_b16 v[84:85], v34 offset:45056
    ds_read_b64_tr_b16 v[86:87], v34 offset:46080
    s_add_u32 m0, s47, 98304
    s_mov_b32 s42, 1032192
    buffer_load_dwordx4 v27, s[8:11], s42 offen lds
    s_waitcnt lgkmcnt(7)
    v_mfma_f32_32x32x16_bf16 v[104:119], v[72:75], v[64:67], v[104:119]
    ds_read_b64_tr_b16 v[88:89], v37 offset:40960
    ds_read_b64_tr_b16 v[90:91], v37 offset:41984
    v_lshlrev_b32 v50, 16, v72
    v_and_b32 v51, 0xffff0000, v72
    v_add_f32 v48, v48, v50
    v_add_f32 v49, v49, v51
    v_lshlrev_b32 v52, 16, v73
    v_and_b32 v53, 0xffff0000, v73
    v_add_f32 v48, v48, v52
    v_add_f32 v49, v49, v53
    s_waitcnt lgkmcnt(7)
    v_mfma_f32_32x32x16_bf16 v[120:135], v[80:83], v[64:67], v[120:135]
    ds_read_b64_tr_b16 v[96:97], v40 offset:40960
    ds_read_b64_tr_b16 v[98:99], v40 offset:41984
    v_lshlrev_b32 v50, 16, v74
    v_and_b32 v51, 0xffff0000, v74
    v_add_f32 v48, v48, v50
    v_add_f32 v49, v49, v51
    v_lshlrev_b32 v52, 16, v75
    v_and_b32 v53, 0xffff0000, v75
    v_add_f32 v48, v48, v52
    v_add_f32 v49, v49, v53
    s_waitcnt lgkmcnt(6)
    v_mfma_f32_32x32x16_bf16 v[104:119], v[76:79], v[68:71], v[104:119]
    ds_read_b64_tr_b16 v[92:93], v37 offset:45056
    ds_read_b64_tr_b16 v[94:95], v37 offset:46080
    v_lshlrev_b32 v50, 16, v76
    v_and_b32 v51, 0xffff0000, v76
    v_add_f32 v48, v48, v50
    v_add_f32 v49, v49, v51
    v_lshlrev_b32 v52, 16, v77
    v_and_b32 v53, 0xffff0000, v77
    v_add_f32 v48, v48, v52
    v_add_f32 v49, v49, v53
    s_add_u32 m0, s47, 106496
    s_mov_b32 s42, 1032192
    buffer_load_dwordx4 v28, s[12:15], s42 offen lds
    s_waitcnt lgkmcnt(6)
    v_mfma_f32_32x32x16_bf16 v[120:135], v[84:87], v[68:71], v[120:135]
    ds_read_b64_tr_b16 v[100:101], v40 offset:45056
    ds_read_b64_tr_b16 v[102:103], v40 offset:46080
    v_lshlrev_b32 v50, 16, v78
    v_and_b32 v51, 0xffff0000, v78
    v_add_f32 v48, v48, v50
    v_add_f32 v49, v49, v51
    v_lshlrev_b32 v52, 16, v79
    v_and_b32 v53, 0xffff0000, v79
    v_add_f32 v48, v48, v52
    v_add_f32 v49, v49, v53
    s_waitcnt vmcnt(10)
    s_barrier
    s_waitcnt lgkmcnt(6)
    v_mfma_f32_32x32x16_bf16 v[136:151], v[88:91], v[64:67], v[136:151]
    ds_read_b128 v[56:59], v41 offset:16384
    ds_read_b64_tr_b16 v[72:73], v29 offset:16384
    ds_read_b64_tr_b16 v[74:75], v29 offset:17408
    s_add_u32 m0, s47, 114688
    s_mov_b32 s42, 640
    buffer_load_dwordx4 v26, s[4:7], s42 offen lds
    s_waitcnt lgkmcnt(7)
    v_mfma_f32_32x32x16_bf16 v[152:167], v[96:99], v[64:67], v[152:167]
    ds_read_b64_tr_b16 v[80:81], v32 offset:16384
    ds_read_b64_tr_b16 v[82:83], v32 offset:17408
    s_waitcnt lgkmcnt(7)
    v_mfma_f32_32x32x16_bf16 v[136:151], v[92:95], v[68:71], v[136:151]
    ds_read_b128 v[60:63], v44 offset:16384
    ds_read_b64_tr_b16 v[76:77], v29 offset:20480
    ds_read_b64_tr_b16 v[78:79], v29 offset:21504
    s_waitcnt lgkmcnt(8)
    v_mfma_f32_32x32x16_bf16 v[152:167], v[100:103], v[68:71], v[152:167]
    ds_read_b64_tr_b16 v[84:85], v32 offset:20480
    ds_read_b64_tr_b16 v[86:87], v32 offset:21504
    s_add_u32 m0, s47, 122880
    s_mov_b32 s42, 1146880
    buffer_load_dwordx4 v27, s[8:11], s42 offen lds
    s_waitcnt lgkmcnt(7)
    v_mfma_f32_32x32x16_bf16 v[104:119], v[72:75], v[56:59], v[104:119]
    ds_read_b64_tr_b16 v[88:89], v35 offset:16384
    ds_read_b64_tr_b16 v[90:91], v35 offset:17408
    v_lshlrev_b32 v50, 16, v72
    v_and_b32 v51, 0xffff0000, v72
    v_add_f32 v48, v48, v50
    v_add_f32 v49, v49, v51
    v_lshlrev_b32 v52, 16, v73
    v_and_b32 v53, 0xffff0000, v73
    v_add_f32 v48, v48, v52
    v_add_f32 v49, v49, v53
    s_waitcnt lgkmcnt(7)
    v_mfma_f32_32x32x16_bf16 v[120:135], v[80:83], v[56:59], v[120:135]
    ds_read_b64_tr_b16 v[96:97], v38 offset:16384
    ds_read_b64_tr_b16 v[98:99], v38 offset:17408
    v_lshlrev_b32 v50, 16, v74
    v_and_b32 v51, 0xffff0000, v74
    v_add_f32 v48, v48, v50
    v_add_f32 v49, v49, v51
    v_lshlrev_b32 v52, 16, v75
    v_and_b32 v53, 0xffff0000, v75
    v_add_f32 v48, v48, v52
    v_add_f32 v49, v49, v53
    s_waitcnt lgkmcnt(6)
    v_mfma_f32_32x32x16_bf16 v[104:119], v[76:79], v[60:63], v[104:119]
    ds_read_b64_tr_b16 v[92:93], v35 offset:20480
    ds_read_b64_tr_b16 v[94:95], v35 offset:21504
    v_lshlrev_b32 v50, 16, v76
    v_and_b32 v51, 0xffff0000, v76
    v_add_f32 v48, v48, v50
    v_add_f32 v49, v49, v51
    v_lshlrev_b32 v52, 16, v77
    v_and_b32 v53, 0xffff0000, v77
    v_add_f32 v48, v48, v52
    v_add_f32 v49, v49, v53
    s_add_u32 m0, s47, 131072
    s_mov_b32 s42, 1146880
    buffer_load_dwordx4 v28, s[12:15], s42 offen lds
    s_waitcnt lgkmcnt(6)
    v_mfma_f32_32x32x16_bf16 v[120:135], v[84:87], v[60:63], v[120:135]
    ds_read_b64_tr_b16 v[100:101], v38 offset:20480
    ds_read_b64_tr_b16 v[102:103], v38 offset:21504
    v_lshlrev_b32 v50, 16, v78
    v_and_b32 v51, 0xffff0000, v78
    v_add_f32 v48, v48, v50
    v_add_f32 v49, v49, v51
    v_lshlrev_b32 v52, 16, v79
    v_and_b32 v53, 0xffff0000, v79
    v_add_f32 v48, v48, v52
    v_add_f32 v49, v49, v53
    s_waitcnt vmcnt(10)
    s_barrier
    s_waitcnt lgkmcnt(6)
    v_mfma_f32_32x32x16_bf16 v[136:151], v[88:91], v[56:59], v[136:151]
    ds_read_b128 v[64:67], v41 offset:40960
    ds_read_b64_tr_b16 v[72:73], v29 offset:40960
    ds_read_b64_tr_b16 v[74:75], v29 offset:41984
    v_lshl_or_b32 v168, v172, 16, v168
    s_add_u32 m0, s47, 139264
    s_mov_b32 s42, 704
    buffer_load_dwordx4 v26, s[4:7], s42 offen lds
    s_waitcnt lgkmcnt(7)
    v_mfma_f32_32x32x16_bf16 v[152:167], v[96:99], v[56:59], v[152:167]
    ds_read_b64_tr_b16 v[80:81], v32 offset:40960
    ds_read_b64_tr_b16 v[82:83], v32 offset:41984
    v_lshl_or_b32 v169, v173, 16, v169
    v_lshl_or_b32 v170, v174, 16, v170
    s_waitcnt lgkmcnt(7)
    v_mfma_f32_32x32x16_bf16 v[136:151], v[92:95], v[60:63], v[136:151]
    ds_read_b128 v[68:71], v44 offset:40960
    ds_read_b64_tr_b16 v[76:77], v29 offset:45056
    ds_read_b64_tr_b16 v[78:79], v29 offset:46080
    v_lshl_or_b32 v171, v175, 16, v171
    v_and_b32 v186, 3, v1
    v_lshlrev_b32 v186, 4, v186
    v_lshrrev_b32 v187, 2, v1
    v_add_lshl_u32 v186, v186, v187, 2
    s_waitcnt lgkmcnt(8)
    v_mfma_f32_32x32x16_bf16 v[152:167], v[100:103], v[60:63], v[152:167]
    ds_read_b64_tr_b16 v[84:85], v32 offset:45056
    ds_read_b64_tr_b16 v[86:87], v32 offset:46080
    ds_bpermute_b32 v172, v186, v168
    ds_bpermute_b32 v173, v186, v169
    s_add_u32 m0, s47, 147456
    s_mov_b32 s42, 1261568
    buffer_load_dwordx4 v27, s[8:11], s42 offen lds
    s_waitcnt lgkmcnt(9)
    v_mfma_f32_32x32x16_bf16 v[104:119], v[72:75], v[64:67], v[104:119]
    ds_read_b64_tr_b16 v[88:89], v35 offset:40960
    ds_read_b64_tr_b16 v[90:91], v35 offset:41984
    v_lshlrev_b32 v50, 16, v72
    v_and_b32 v51, 0xffff0000, v72
    v_add_f32 v48, v48, v50
    v_add_f32 v49, v49, v51
    v_lshlrev_b32 v52, 16, v73
    v_and_b32 v53, 0xffff0000, v73
    v_add_f32 v48, v48, v52
    v_add_f32 v49, v49, v53
    ds_bpermute_b32 v174, v186, v170
    ds_bpermute_b32 v175, v186, v171
    s_waitcnt lgkmcnt(11)
    v_mfma_f32_32x32x16_bf16 v[120:135], v[80:83], v[64:67], v[120:135]
    ds_read_b64_tr_b16 v[96:97], v38 offset:40960
    ds_read_b64_tr_b16 v[98:99], v38 offset:41984
    v_lshlrev_b32 v50, 16, v74
    v_and_b32 v51, 0xffff0000, v74
    v_add_f32 v48, v48, v50
    v_add_f32 v49, v49, v51
    v_lshlrev_b32 v52, 16, v75
    v_and_b32 v53, 0xffff0000, v75
    v_add_f32 v48, v48, v52
    v_add_f32 v49, v49, v53
    s_waitcnt lgkmcnt(2)
    s_mov_b32 s44, 9568256
    buffer_store_dwordx4 v[172:175], v180, s[28:31], s44 offen sc1
    v_mfma_f32_32x32x16_bf16 v[104:119], v[76:79], v[68:71], v[104:119]
    ds_read_b64_tr_b16 v[92:93], v35 offset:45056
    ds_read_b64_tr_b16 v[94:95], v35 offset:46080
    v_lshlrev_b32 v50, 16, v76
    v_and_b32 v51, 0xffff0000, v76
    v_add_f32 v48, v48, v50
    v_add_f32 v49, v49, v51
    v_lshlrev_b32 v52, 16, v77
    v_and_b32 v53, 0xffff0000, v77
    v_add_f32 v48, v48, v52
    v_add_f32 v49, v49, v53
    s_add_u32 m0, s47, 155648
    s_mov_b32 s42, 1261568
    buffer_load_dwordx4 v28, s[12:15], s42 offen lds
    v_mfma_f32_32x32x16_bf16 v[120:135], v[84:87], v[68:71], v[120:135]
    ds_read_b64_tr_b16 v[100:101], v38 offset:45056
    ds_read_b64_tr_b16 v[102:103], v38 offset:46080
    v_lshlrev_b32 v50, 16, v78
    v_and_b32 v51, 0xffff0000, v78
    v_add_f32 v48, v48, v50
    v_add_f32 v49, v49, v51
    v_lshlrev_b32 v52, 16, v79
    v_and_b32 v53, 0xffff0000, v79
    v_add_f32 v48, v48, v52
    v_add_f32 v49, v49, v53
    s_waitcnt vmcnt(11)
    s_barrier
    v_mfma_f32_32x32x16_bf16 v[136:151], v[88:91], v[64:67], v[136:151]
    ds_read_b128 v[56:59], v42 offset:16384
    ds_read_b64_tr_b16 v[72:73], v30 offset:16384
    ds_read_b64_tr_b16 v[74:75], v30 offset:17408
    s_add_u32 m0, s47, 16384
    s_mov_b32 s42, 768
    buffer_load_dwordx4 v26, s[4:7], s42 offen lds
    s_waitcnt lgkmcnt(7)
    v_mfma_f32_32x32x16_bf16 v[152:167], v[96:99], v[64:67], v[152:167]
    ds_read_b64_tr_b16 v[80:81], v33 offset:16384
    ds_read_b64_tr_b16 v[82:83], v33 offset:17408
    s_waitcnt lgkmcnt(7)
    v_mfma_f32_32x32x16_bf16 v[136:151], v[92:95], v[68:71], v[136:151]
    ds_read_b128 v[60:63], v45 offset:16384
    ds_read_b64_tr_b16 v[76:77], v30 offset:20480
    ds_read_b64_tr_b16 v[78:79], v30 offset:21504
    s_waitcnt lgkmcnt(8)
    v_mfma_f32_32x32x16_bf16 v[152:167], v[100:103], v[68:71], v[152:167]
    ds_read_b64_tr_b16 v[84:85], v33 offset:20480
    ds_read_b64_tr_b16 v[86:87], v33 offset:21504
    s_add_u32 m0, s47, 24576
    s_mov_b32 s42, 1376256
    buffer_load_dwordx4 v27, s[8:11], s42 offen lds
    s_waitcnt lgkmcnt(7)
    v_mfma_f32_32x32x16_bf16 v[104:119], v[72:75], v[56:59], v[104:119]
    ds_read_b64_tr_b16 v[88:89], v36 offset:16384
    ds_read_b64_tr_b16 v[90:91], v36 offset:17408
    v_lshlrev_b32 v50, 16, v72
    v_and_b32 v51, 0xffff0000, v72
    v_add_f32 v48, v48, v50
    v_add_f32 v49, v49, v51
    v_lshlrev_b32 v52, 16, v73
    v_and_b32 v53, 0xffff0000, v73
    v_add_f32 v48, v48, v52
    v_add_f32 v49, v49, v53
    s_waitcnt lgkmcnt(7)
    v_mfma_f32_32x32x16_bf16 v[120:135], v[80:83], v[56:59], v[120:135]
    ds_read_b64_tr_b16 v[96:97], v39 offset:16384
    ds_read_b64_tr_b16 v[98:99], v39 offset:17408
    v_lshlrev_b32 v50, 16, v74
    v_and_b32 v51, 0xffff0000, v74
    v_add_f32 v48, v48, v50
    v_add_f32 v49, v49, v51
    v_lshlrev_b32 v52, 16, v75
    v_and_b32 v53, 0xffff0000, v75
    v_add_f32 v48, v48, v52
    v_add_f32 v49, v49, v53
    s_waitcnt lgkmcnt(6)
    v_mfma_f32_32x32x16_bf16 v[104:119], v[76:79], v[60:63], v[104:119]
    ds_read_b64_tr_b16 v[92:93], v36 offset:20480
    ds_read_b64_tr_b16 v[94:95], v36 offset:21504
    v_lshlrev_b32 v50, 16, v76
    v_and_b32 v51, 0xffff0000, v76
    v_add_f32 v48, v48, v50
    v_add_f32 v49, v49, v51
    v_lshlrev_b32 v52, 16, v77
    v_and_b32 v53, 0xffff0000, v77
    v_add_f32 v48, v48, v52
    v_add_f32 v49, v49, v53
    s_add_u32 m0, s47, 32768
    s_mov_b32 s42, 1376256
    buffer_load_dwordx4 v28, s[12:15], s42 offen lds
    s_waitcnt lgkmcnt(6)
    v_mfma_f32_32x32x16_bf16 v[120:135], v[84:87], v[60:63], v[120:135]
    ds_read_b64_tr_b16 v[100:101], v39 offset:20480
    ds_read_b64_tr_b16 v[102:103], v39 offset:21504
    v_lshlrev_b32 v50, 16, v78
    v_and_b32 v51, 0xffff0000, v78
    v_add_f32 v48, v48, v50
    v_add_f32 v49, v49, v51
    v_lshlrev_b32 v52, 16, v79
    v_and_b32 v53, 0xffff0000, v79
    v_add_f32 v48, v48, v52
    v_add_f32 v49, v49, v53
    s_waitcnt vmcnt(10)
    s_barrier
    s_cmp_eq_u32 s38, 0
    s_cbranch_scc0 LNP2
    s_and_b32 s50, s2, 7
    s_lshl_b32 s50, s50, 10
    s_lshr_b32 s51, s2, 3
    s_lshl_b32 s51, s51, 5
    s_add_u32 s50, s50, s51
    s_add_u32 s50, s50, 14123008
    s_mov_b64 s[62:63], exec
    s_mov_b64 exec, 1
    buffer_store_dword v24, v25, s[28:31], s50 offen sc0 sc1
    s_mov_b64 exec, s[62:63]
LNP2:
    s_waitcnt lgkmcnt(6)
    v_mfma_f32_32x32x16_bf16 v[136:151], v[88:91], v[56:59], v[136:151]
    ds_read_b128 v[64:67], v42 offset:40960
    ds_read_b64_tr_b16 v[72:73], v30 offset:40960
    ds_read_b64_tr_b16 v[74:75], v30 offset:41984
    s_add_u32 m0, s47, 40960
    s_mov_b32 s42, 832
    buffer_load_dwordx4 v26, s[4:7], s42 offen lds
    s_waitcnt lgkmcnt(7)
    v_mfma_f32_32x32x16_bf16 v[152:167], v[96:99], v[56:59], v[152:167]
    ds_read_b64_tr_b16 v[80:81], v33 offset:40960
    ds_read_b64_tr_b16 v[82:83], v33 offset:41984
    s_waitcnt lgkmcnt(7)
    v_mfma_f32_32x32x16_bf16 v[136:151], v[92:95], v[60:63], v[136:151]
    ds_read_b128 v[68:71], v45 offset:40960
    ds_read_b64_tr_b16 v[76:77], v30 offset:45056
    ds_read_b64_tr_b16 v[78:79], v30 offset:46080
    s_waitcnt lgkmcnt(8)
    v_mfma_f32_32x32x16_bf16 v[152:167], v[100:103], v[60:63], v[152:167]
    ds_read_b64_tr_b16 v[84:85], v33 offset:45056
    ds_read_b64_tr_b16 v[86:87], v33 offset:46080
    s_add_u32 m0, s47, 49152
    s_mov_b32 s42, 1490944
    buffer_load_dwordx4 v27, s[8:11], s42 offen lds
    s_waitcnt lgkmcnt(7)
    v_mfma_f32_32x32x16_bf16 v[104:119], v[72:75], v[64:67], v[104:119]
    ds_read_b64_tr_b16 v[88:89], v36 offset:40960
    ds_read_b64_tr_b16 v[90:91], v36 offset:41984
    v_lshlrev_b32 v50, 16, v72
    v_and_b32 v51, 0xffff0000, v72
    v_add_f32 v48, v48, v50
    v_add_f32 v49, v49, v51
    v_lshlrev_b32 v52, 16, v73
    v_and_b32 v53, 0xffff0000, v73
    v_add_f32 v48, v48, v52
    v_add_f32 v49, v49, v53
    s_waitcnt lgkmcnt(7)
    v_mfma_f32_32x32x16_bf16 v[120:135], v[80:83], v[64:67], v[120:135]
    ds_read_b64_tr_b16 v[96:97], v39 offset:40960
    ds_read_b64_tr_b16 v[98:99], v39 offset:41984
    v_lshlrev_b32 v50, 16, v74
    v_and_b32 v51, 0xffff0000, v74
    v_add_f32 v48, v48, v50
    v_add_f32 v49, v49, v51
    v_lshlrev_b32 v52, 16, v75
    v_and_b32 v53, 0xffff0000, v75
    v_add_f32 v48, v48, v52
    v_add_f32 v49, v49, v53
    s_waitcnt lgkmcnt(6)
    v_mfma_f32_32x32x16_bf16 v[104:119], v[76:79], v[68:71], v[104:119]
    ds_read_b64_tr_b16 v[92:93], v36 offset:45056
    ds_read_b64_tr_b16 v[94:95], v36 offset:46080
    v_lshlrev_b32 v50, 16, v76
    v_and_b32 v51, 0xffff0000, v76
    v_add_f32 v48, v48, v50
    v_add_f32 v49, v49, v51
    v_lshlrev_b32 v52, 16, v77
    v_and_b32 v53, 0xffff0000, v77
    v_add_f32 v48, v48, v52
    v_add_f32 v49, v49, v53
    s_add_u32 m0, s47, 57344
    s_mov_b32 s42, 1490944
    buffer_load_dwordx4 v28, s[12:15], s42 offen lds
    s_waitcnt lgkmcnt(6)
    v_mfma_f32_32x32x16_bf16 v[120:135], v[84:87], v[68:71], v[120:135]
    ds_read_b64_tr_b16 v[100:101], v39 offset:45056
    ds_read_b64_tr_b16 v[102:103], v39 offset:46080
    v_lshlrev_b32 v50, 16, v78
    v_and_b32 v51, 0xffff0000, v78
    v_add_f32 v48, v48, v50
    v_add_f32 v49, v49, v51
    v_lshlrev_b32 v52, 16, v79
    v_and_b32 v53, 0xffff0000, v79
    v_add_f32 v48, v48, v52
    v_add_f32 v49, v49, v53
    s_waitcnt vmcnt(10)
    s_barrier
    s_waitcnt lgkmcnt(6)
    v_mfma_f32_32x32x16_bf16 v[136:151], v[88:91], v[64:67], v[136:151]
    ds_read_b128 v[56:59], v43 offset:16384
    ds_read_b64_tr_b16 v[72:73], v31 offset:16384
    ds_read_b64_tr_b16 v[74:75], v31 offset:17408
    s_add_u32 m0, s47, 65536
    s_mov_b32 s42, 896
    buffer_load_dwordx4 v26, s[4:7], s42 offen lds
    s_waitcnt lgkmcnt(7)
    v_mfma_f32_32x32x16_bf16 v[152:167], v[96:99], v[64:67], v[152:167]
    ds_read_b64_tr_b16 v[80:81], v34 offset:16384
    ds_read_b64_tr_b16 v[82:83], v34 offset:17408
    s_waitcnt lgkmcnt(7)
    v_mfma_f32_32x32x16_bf16 v[136:151], v[92:95], v[68:71], v[136:151]
    ds_read_b128 v[60:63], v46 offset:16384
    ds_read_b64_tr_b16 v[76:77], v31 offset:20480
    ds_read_b64_tr_b16 v[78:79], v31 offset:21504
    s_waitcnt lgkmcnt(8)
    v_mfma_f32_32x32x16_bf16 v[152:167], v[100:103], v[68:71], v[152:167]
    ds_read_b64_tr_b16 v[84:85], v34 offset:20480
    ds_read_b64_tr_b16 v[86:87], v34 offset:21504
    s_add_u32 m0, s47, 73728
    s_mov_b32 s42, 1605632
    buffer_load_dwordx4 v27, s[8:11], s42 offen lds
    s_waitcnt lgkmcnt(7)
    v_mfma_f32_32x32x16_bf16 v[104:119], v[72:75], v[56:59], v[104:119]
    ds_read_b64_tr_b16 v[88:89], v37 offset:16384
    ds_read_b64_tr_b16 v[90:91], v37 offset:17408
    v_lshlrev_b32 v50, 16, v72
    v_and_b32 v51, 0xffff0000, v72
    v_add_f32 v48, v48, v50
    v_add_f32 v49, v49, v51
    v_lshlrev_b32 v52, 16, v73
    v_and_b32 v53, 0xffff0000, v73
    v_add_f32 v48, v48, v52
    v_add_f32 v49, v49, v53
    s_waitcnt lgkmcnt(7)
    v_mfma_f32_32x32x16_bf16 v[120:135], v[80:83], v[56:59], v[120:135]
    ds_read_b64_tr_b16 v[96:97], v40 offset:16384
    ds_read_b64_tr_b16 v[98:99], v40 offset:17408
    v_lshlrev_b32 v50, 16, v74
    v_and_b32 v51, 0xffff0000, v74
    v_add_f32 v48, v48, v50
    v_add_f32 v49, v49, v51
    v_lshlrev_b32 v52, 16, v75
    v_and_b32 v53, 0xffff0000, v75
    v_add_f32 v48, v48, v52
    v_add_f32 v49, v49, v53
    s_waitcnt lgkmcnt(6)
    v_mfma_f32_32x32x16_bf16 v[104:119], v[76:79], v[60:63], v[104:119]
    ds_read_b64_tr_b16 v[92:93], v37 offset:20480
    ds_read_b64_tr_b16 v[94:95], v37 offset:21504
    v_lshlrev_b32 v50, 16, v76
    v_and_b32 v51, 0xffff0000, v76
    v_add_f32 v48, v48, v50
    v_add_f32 v49, v49, v51
    v_lshlrev_b32 v52, 16, v77
    v_and_b32 v53, 0xffff0000, v77
    v_add_f32 v48, v48, v52
    v_add_f32 v49, v49, v53
    s_add_u32 m0, s47, 81920
    s_mov_b32 s42, 1605632
    buffer_load_dwordx4 v28, s[12:15], s42 offen lds
    s_waitcnt lgkmcnt(6)
    v_mfma_f32_32x32x16_bf16 v[120:135], v[84:87], v[60:63], v[120:135]
    ds_read_b64_tr_b16 v[100:101], v40 offset:20480
    ds_read_b64_tr_b16 v[102:103], v40 offset:21504
    v_lshlrev_b32 v50, 16, v78
    v_and_b32 v51, 0xffff0000, v78
    v_add_f32 v48, v48, v50
    v_add_f32 v49, v49, v51
    v_lshlrev_b32 v52, 16, v79
    v_and_b32 v53, 0xffff0000, v79
    v_add_f32 v48, v48, v52
    v_add_f32 v49, v49, v53
    s_waitcnt vmcnt(9)
    s_barrier
    s_waitcnt lgkmcnt(6)
    v_mfma_f32_32x32x16_bf16 v[136:151], v[88:91], v[56:59], v[136:151]
    ds_read_b128 v[64:67], v43 offset:40960
    ds_read_b64_tr_b16 v[72:73], v31 offset:40960
    ds_read_b64_tr_b16 v[74:75], v31 offset:41984
    s_add_u32 m0, s47, 90112
    s_mov_b32 s42, 960
    buffer_load_dwordx4 v26, s[4:7], s42 offen lds
    s_waitcnt lgkmcnt(7)
    v_mfma_f32_32x32x16_bf16 v[152:167], v[96:99], v[56:59], v[152:167]
    ds_read_b64_tr_b16 v[80:81], v34 offset:40960
    ds_read_b64_tr_b16 v[82:83], v34 offset:41984
    s_waitcnt lgkmcnt(7)
    v_mfma_f32_32x32x16_bf16 v[136:151], v[92:95], v[60:63], v[136:151]
    ds_read_b128 v[68:71], v46 offset:40960
    ds_read_b64_tr_b16 v[76:77], v31 offset:45056
    ds_read_b64_tr_b16 v[78:79], v31 offset:46080
    s_waitcnt lgkmcnt(8)
    v_mfma_f32_32x32x16_bf16 v[152:167], v[100:103], v[60:63], v[152:167]
    ds_read_b64_tr_b16 v[84:85], v34 offset:45056
    ds_read_b64_tr_b16 v[86:87], v34 offset:46080
    s_lshr_b32 s57, s2, 3
    s_lshl_b32 s57, s57, 3
    s_add_u32 s57, s57, s38
    s_lshl_b32 s57, s57, 13
    v_lshlrev_b32 v181, 7, v1
    buffer_load_dword v182, v181, s[16:19], s57 offen
    s_add_u32 m0, s47, 98304
    s_mov_b32 s42, 1720320
    buffer_load_dwordx4 v27, s[8:11], s42 offen lds
    s_waitcnt lgkmcnt(7)
    v_mfma_f32_32x32x16_bf16 v[104:119], v[72:75], v[64:67], v[104:119]
    ds_read_b64_tr_b16 v[88:89], v37 offset:40960
    ds_read_b64_tr_b16 v[90:91], v37 offset:41984
    v_lshlrev_b32 v50, 16, v72
    v_and_b32 v51, 0xffff0000, v72
    v_add_f32 v48, v48, v50
    v_add_f32 v49, v49, v51
    v_lshlrev_b32 v52, 16, v73
    v_and_b32 v53, 0xffff0000, v73
    v_add_f32 v48, v48, v52
    v_add_f32 v49, v49, v53
    s_waitcnt lgkmcnt(7)
    v_mfma_f32_32x32x16_bf16 v[120:135], v[80:83], v[64:67], v[120:135]
    ds_read_b64_tr_b16 v[96:97], v40 offset:40960
    ds_read_b64_tr_b16 v[98:99], v40 offset:41984
    v_lshlrev_b32 v50, 16, v74
    v_and_b32 v51, 0xffff0000, v74
    v_add_f32 v48, v48, v50
    v_add_f32 v49, v49, v51
    v_lshlrev_b32 v52, 16, v75
    v_and_b32 v53, 0xffff0000, v75
    v_add_f32 v48, v48, v52
    v_add_f32 v49, v49, v53
    s_waitcnt lgkmcnt(6)
    v_mfma_f32_32x32x16_bf16 v[104:119], v[76:79], v[68:71], v[104:119]
    ds_read_b64_tr_b16 v[92:93], v37 offset:45056
    ds_read_b64_tr_b16 v[94:95], v37 offset:46080
    v_lshlrev_b32 v50, 16, v76
    v_and_b32 v51, 0xffff0000, v76
    v_add_f32 v48, v48, v50
    v_add_f32 v49, v49, v51
    v_lshlrev_b32 v52, 16, v77
    v_and_b32 v53, 0xffff0000, v77
    v_add_f32 v48, v48, v52
    v_add_f32 v49, v49, v53
    s_add_u32 m0, s47, 106496
    s_mov_b32 s42, 1720320
    buffer_load_dwordx4 v28, s[12:15], s42 offen lds
    s_waitcnt lgkmcnt(6)
    v_mfma_f32_32x32x16_bf16 v[120:135], v[84:87], v[68:71], v[120:135]
    ds_read_b64_tr_b16 v[100:101], v40 offset:45056
    ds_read_b64_tr_b16 v[102:103], v40 offset:46080
    v_lshlrev_b32 v50, 16, v78
    v_and_b32 v51, 0xffff0000, v78
    v_add_f32 v48, v48, v50
    v_add_f32 v49, v49, v51
    v_lshlrev_b32 v52, 16, v79
    v_and_b32 v53, 0xffff0000, v79
    v_add_f32 v48, v48, v52
    v_add_f32 v49, v49, v53
    s_waitcnt vmcnt(10)
    s_barrier
    s_waitcnt lgkmcnt(6)
    v_mfma_f32_32x32x16_bf16 v[136:151], v[88:91], v[64:67], v[136:151]
    ds_read_b128 v[56:59], v41 offset:16384
    ds_read_b64_tr_b16 v[72:73], v29 offset:16384
    ds_read_b64_tr_b16 v[74:75], v29 offset:17408
    s_waitcnt lgkmcnt(7)
    v_mfma_f32_32x32x16_bf16 v[152:167], v[96:99], v[64:67], v[152:167]
    ds_read_b64_tr_b16 v[80:81], v32 offset:16384
    ds_read_b64_tr_b16 v[82:83], v32 offset:17408
    s_waitcnt lgkmcnt(7)
    v_mfma_f32_32x32x16_bf16 v[136:151], v[92:95], v[68:71], v[136:151]
    ds_read_b128 v[60:63], v44 offset:16384
    ds_read_b64_tr_b16 v[76:77], v29 offset:20480
    ds_read_b64_tr_b16 v[78:79], v29 offset:21504
    s_waitcnt lgkmcnt(8)
    v_mfma_f32_32x32x16_bf16 v[152:167], v[100:103], v[68:71], v[152:167]
    ds_read_b64_tr_b16 v[84:85], v32 offset:20480
    ds_read_b64_tr_b16 v[86:87], v32 offset:21504
    s_waitcnt lgkmcnt(7)
    v_mfma_f32_32x32x16_bf16 v[104:119], v[72:75], v[56:59], v[104:119]
    ds_read_b64_tr_b16 v[88:89], v35 offset:16384
    ds_read_b64_tr_b16 v[90:91], v35 offset:17408
    v_lshlrev_b32 v50, 16, v72
    v_and_b32 v51, 0xffff0000, v72
    v_add_f32 v48, v48, v50
    v_add_f32 v49, v49, v51
    v_lshlrev_b32 v52, 16, v73
    v_and_b32 v53, 0xffff0000, v73
    v_add_f32 v48, v48, v52
    v_add_f32 v49, v49, v53
    s_waitcnt lgkmcnt(7)
    v_mfma_f32_32x32x16_bf16 v[120:135], v[80:83], v[56:59], v[120:135]
    ds_read_b64_tr_b16 v[96:97], v38 offset:16384
    ds_read_b64_tr_b16 v[98:99], v38 offset:17408
    v_lshlrev_b32 v50, 16, v74
    v_and_b32 v51, 0xffff0000, v74
    v_add_f32 v48, v48, v50
    v_add_f32 v49, v49, v51
    v_lshlrev_b32 v52, 16, v75
    v_and_b32 v53, 0xffff0000, v75
    v_add_f32 v48, v48, v52
    v_add_f32 v49, v49, v53
    s_waitcnt lgkmcnt(6)
    v_mfma_f32_32x32x16_bf16 v[104:119], v[76:79], v[60:63], v[104:119]
    ds_read_b64_tr_b16 v[92:93], v35 offset:20480
    ds_read_b64_tr_b16 v[94:95], v35 offset:21504
    v_lshlrev_b32 v50, 16, v76
    v_and_b32 v51, 0xffff0000, v76
    v_add_f32 v48, v48, v50
    v_add_f32 v49, v49, v51
    v_lshlrev_b32 v52, 16, v77
    v_and_b32 v53, 0xffff0000, v77
    v_add_f32 v48, v48, v52
    v_add_f32 v49, v49, v53
    s_waitcnt lgkmcnt(6)
    v_mfma_f32_32x32x16_bf16 v[120:135], v[84:87], v[60:63], v[120:135]
    ds_read_b64_tr_b16 v[100:101], v38 offset:20480
    ds_read_b64_tr_b16 v[102:103], v38 offset:21504
    v_lshlrev_b32 v50, 16, v78
    v_and_b32 v51, 0xffff0000, v78
    v_add_f32 v48, v48, v50
    v_add_f32 v49, v49, v51
    v_lshlrev_b32 v52, 16, v79
    v_and_b32 v53, 0xffff0000, v79
    v_add_f32 v48, v48, v52
    v_add_f32 v49, v49, v53
    s_waitcnt vmcnt(7)
    s_barrier
    s_waitcnt lgkmcnt(6)
    v_mfma_f32_32x32x16_bf16 v[136:151], v[88:91], v[56:59], v[136:151]
    ds_read_b128 v[64:67], v41 offset:40960
    ds_read_b64_tr_b16 v[72:73], v29 offset:40960
    ds_read_b64_tr_b16 v[74:75], v29 offset:41984
    s_waitcnt lgkmcnt(7)
    v_mfma_f32_32x32x16_bf16 v[152:167], v[96:99], v[56:59], v[152:167]
    ds_read_b64_tr_b16 v[80:81], v32 offset:40960
    ds_read_b64_tr_b16 v[82:83], v32 offset:41984
    s_waitcnt lgkmcnt(7)
    v_mfma_f32_32x32x16_bf16 v[136:151], v[92:95], v[60:63], v[136:151]
    ds_read_b128 v[68:71], v44 offset:40960
    ds_read_b64_tr_b16 v[76:77], v29 offset:45056
    ds_read_b64_tr_b16 v[78:79], v29 offset:46080
    s_waitcnt lgkmcnt(8)
    v_mfma_f32_32x32x16_bf16 v[152:167], v[100:103], v[60:63], v[152:167]
    ds_read_b64_tr_b16 v[84:85], v32 offset:45056
    ds_read_b64_tr_b16 v[86:87], v32 offset:46080
    s_waitcnt lgkmcnt(7)
    v_mfma_f32_32x32x16_bf16 v[104:119], v[72:75], v[64:67], v[104:119]
    ds_read_b64_tr_b16 v[88:89], v35 offset:40960
    ds_read_b64_tr_b16 v[90:91], v35 offset:41984
    v_lshlrev_b32 v50, 16, v72
    v_and_b32 v51, 0xffff0000, v72
    v_add_f32 v48, v48, v50
    v_add_f32 v49, v49, v51
    v_lshlrev_b32 v52, 16, v73
    v_and_b32 v53, 0xffff0000, v73
    v_add_f32 v48, v48, v52
    v_add_f32 v49, v49, v53
    s_waitcnt lgkmcnt(7)
    v_mfma_f32_32x32x16_bf16 v[120:135], v[80:83], v[64:67], v[120:135]
    ds_read_b64_tr_b16 v[96:97], v38 offset:40960
    ds_read_b64_tr_b16 v[98:99], v38 offset:41984
    v_lshlrev_b32 v50, 16, v74
    v_and_b32 v51, 0xffff0000, v74
    v_add_f32 v48, v48, v50
    v_add_f32 v49, v49, v51
    v_lshlrev_b32 v52, 16, v75
    v_and_b32 v53, 0xffff0000, v75
    v_add_f32 v48, v48, v52
    v_add_f32 v49, v49, v53
    s_waitcnt lgkmcnt(6)
    v_mfma_f32_32x32x16_bf16 v[104:119], v[76:79], v[68:71], v[104:119]
    ds_read_b64_tr_b16 v[92:93], v35 offset:45056
    ds_read_b64_tr_b16 v[94:95], v35 offset:46080
    v_lshlrev_b32 v50, 16, v76
    v_and_b32 v51, 0xffff0000, v76
    v_add_f32 v48, v48, v50
    v_add_f32 v49, v49, v51
    v_lshlrev_b32 v52, 16, v77
    v_and_b32 v53, 0xffff0000, v77
    v_add_f32 v48, v48, v52
    v_add_f32 v49, v49, v53
    s_waitcnt lgkmcnt(6)
    v_mfma_f32_32x32x16_bf16 v[120:135], v[84:87], v[68:71], v[120:135]
    ds_read_b64_tr_b16 v[100:101], v38 offset:45056
    ds_read_b64_tr_b16 v[102:103], v38 offset:46080
    v_lshlrev_b32 v50, 16, v78
    v_and_b32 v51, 0xffff0000, v78
    v_add_f32 v48, v48, v50
    v_add_f32 v49, v49, v51
    v_lshlrev_b32 v52, 16, v79
    v_and_b32 v53, 0xffff0000, v79
    v_add_f32 v48, v48, v52
    v_add_f32 v49, v49, v53
    s_waitcnt vmcnt(4)
    s_barrier
    s_cmp_eq_u32 s38, 0
    s_cbranch_scc0 LZC3
    v_mov_b32 v12, 0
    v_mov_b32 v13, 0
    v_mov_b32 v14, 0
    v_mov_b32 v15, 0
    v_mov_b32 v10, 18432
    ds_write_b128 v10, v[12:15]
    ds_write_b128 v10, v[12:15] offset:16
    ds_write_b128 v10, v[12:15] offset:32
    s_waitcnt lgkmcnt(0)
LZC3:
    v_lshlrev_b32 v230, 5, v4
    s_lshl_b32 s50, s36, 9
    s_add_u32 s50, s50, 14123008
    v_add_u32 v230, s50, v230
    s_mov_b64 s[62:63], exec
    s_mov_b32 exec_lo, 0xffff
    s_mov_b32 exec_hi, 0
    buffer_load_dword v231, v230, s[28:31], 0 offen sc0 sc1
    s_mov_b64 exec, s[62:63]
    s_waitcnt lgkmcnt(6)
    v_mfma_f32_32x32x16_bf16 v[136:151], v[88:91], v[64:67], v[136:151]
    ds_read_b128 v[56:59], v42 offset:16384
    ds_read_b64_tr_b16 v[72:73], v30 offset:16384
    ds_read_b64_tr_b16 v[74:75], v30 offset:17408
    s_waitcnt lgkmcnt(7)
    v_mfma_f32_32x32x16_bf16 v[152:167], v[96:99], v[64:67], v[152:167]
    ds_read_b64_tr_b16 v[80:81], v33 offset:16384
    ds_read_b64_tr_b16 v[82:83], v33 offset:17408
    s_waitcnt lgkmcnt(7)
    v_mfma_f32_32x32x16_bf16 v[136:151], v[92:95], v[68:71], v[136:151]
    ds_read_b128 v[60:63], v45 offset:16384
    ds_read_b64_tr_b16 v[76:77], v30 offset:20480
    ds_read_b64_tr_b16 v[78:79], v30 offset:21504
    s_waitcnt lgkmcnt(8)
    v_mfma_f32_32x32x16_bf16 v[152:167], v[100:103], v[68:71], v[152:167]
    ds_read_b64_tr_b16 v[84:85], v33 offset:20480
    ds_read_b64_tr_b16 v[86:87], v33 offset:21504
    s_waitcnt lgkmcnt(7)
    v_mfma_f32_32x32x16_bf16 v[104:119], v[72:75], v[56:59], v[104:119]
    ds_read_b64_tr_b16 v[88:89], v36 offset:16384
    ds_read_b64_tr_b16 v[90:91], v36 offset:17408
    v_lshlrev_b32 v50, 16, v72
    v_and_b32 v51, 0xffff0000, v72
    v_add_f32 v48, v48, v50
    v_add_f32 v49, v49, v51
    v_lshlrev_b32 v52, 16, v73
    v_and_b32 v53, 0xffff0000, v73
    v_add_f32 v48, v48, v52
    v_add_f32 v49, v49, v53
    s_waitcnt lgkmcnt(7)
    v_mfma_f32_32x32x16_bf16 v[120:135], v[80:83], v[56:59], v[120:135]
    ds_read_b64_tr_b16 v[96:97], v39 offset:16384
    ds_read_b64_tr_b16 v[98:99], v39 offset:17408
    v_lshlrev_b32 v50, 16, v74
    v_and_b32 v51, 0xffff0000, v74
    v_add_f32 v48, v48, v50
    v_add_f32 v49, v49, v51
    v_lshlrev_b32 v52, 16, v75
    v_and_b32 v53, 0xffff0000, v75
    v_add_f32 v48, v48, v52
    v_add_f32 v49, v49, v53
    s_waitcnt lgkmcnt(6)
    v_mfma_f32_32x32x16_bf16 v[104:119], v[76:79], v[60:63], v[104:119]
    ds_read_b64_tr_b16 v[92:93], v36 offset:20480
    ds_read_b64_tr_b16 v[94:95], v36 offset:21504
    v_lshlrev_b32 v50, 16, v76
    v_and_b32 v51, 0xffff0000, v76
    v_add_f32 v48, v48, v50
    v_add_f32 v49, v49, v51
    v_lshlrev_b32 v52, 16, v77
    v_and_b32 v53, 0xffff0000, v77
    v_add_f32 v48, v48, v52
    v_add_f32 v49, v49, v53
    s_waitcnt lgkmcnt(6)
    v_mfma_f32_32x32x16_bf16 v[120:135], v[84:87], v[60:63], v[120:135]
    ds_read_b64_tr_b16 v[100:101], v39 offset:20480
    ds_read_b64_tr_b16 v[102:103], v39 offset:21504
    v_lshlrev_b32 v50, 16, v78
    v_and_b32 v51, 0xffff0000, v78
    v_add_f32 v48, v48, v50
    v_add_f32 v49, v49, v51
    v_lshlrev_b32 v52, 16, v79
    v_and_b32 v53, 0xffff0000, v79
    v_add_f32 v48, v48, v52
    v_add_f32 v49, v49, v53
    s_waitcnt vmcnt(1)
    s_barrier
    s_waitcnt vmcnt(0)
    s_mov_b64 s[62:63], exec
    s_mov_b32 exec_lo, 0xffff
    s_mov_b32 exec_hi, 0
    v_cmp_ne_u32 vcc, s49, v231
    s_mov_b64 exec, s[62:63]
    s_cmp_eq_u64 vcc, 0
    s_cbranch_scc1 LEP4
    s_mov_b32 s50, 0
    s_mov_b32 s57, 0
    s_mov_b64 s[62:63], exec
    s_mov_b32 exec_lo, 0xffff
    s_mov_b32 exec_hi, 0
LP5:
    buffer_load_dword v231, v230, s[28:31], s50 offen sc0 sc1
    s_waitcnt vmcnt(0)
    v_cmp_ne_u32 vcc, s49, v231
    s_nop 0
    s_cmp_eq_u64 vcc, 0
    s_cbranch_scc1 LP5D
    s_add_u32 s57, s57, 1
    s_cmp_lt_u32 s57, 20000
    s_cbranch_scc0 LP5D
    s_sleep 1
    s_branch LP5
LP5D:
    s_mov_b64 exec, s[62:63]
LEP4:
    s_lshl_b32 s53, s36, 1
    s_lshr_b32 s51, s39, 1
    s_add_u32 s53, s53, s51
    s_lshl_b32 s53, s53, 9
    s_and_b32 s51, s39, 1
    s_lshl_b32 s51, s51, 8
    s_add_u32 s53, s53, s51
    s_add_u32 s53, s53, 14024704
    v_lshlrev_b32 v8, 3, v2
    buffer_load_dwordx2 v[184:185], v8, s[28:31], s53 offen sc1
    s_waitcnt lgkmcnt(6)
    v_mfma_f32_32x32x16_bf16 v[136:151], v[88:91], v[56:59], v[136:151]
    ds_read_b128 v[64:67], v42 offset:40960
    ds_read_b64_tr_b16 v[72:73], v30 offset:40960
    ds_read_b64_tr_b16 v[74:75], v30 offset:41984
    s_waitcnt lgkmcnt(7)
    v_mfma_f32_32x32x16_bf16 v[152:167], v[96:99], v[56:59], v[152:167]
    ds_read_b64_tr_b16 v[80:81], v33 offset:40960
    ds_read_b64_tr_b16 v[82:83], v33 offset:41984
    s_waitcnt lgkmcnt(7)
    v_mfma_f32_32x32x16_bf16 v[136:151], v[92:95], v[60:63], v[136:151]
    ds_read_b128 v[68:71], v45 offset:40960
    ds_read_b64_tr_b16 v[76:77], v30 offset:45056
    ds_read_b64_tr_b16 v[78:79], v30 offset:46080
    s_waitcnt lgkmcnt(8)
    v_mfma_f32_32x32x16_bf16 v[152:167], v[100:103], v[60:63], v[152:167]
    ds_read_b64_tr_b16 v[84:85], v33 offset:45056
    ds_read_b64_tr_b16 v[86:87], v33 offset:46080
    s_waitcnt lgkmcnt(7)
    v_mfma_f32_32x32x16_bf16 v[104:119], v[72:75], v[64:67], v[104:119]
    ds_read_b64_tr_b16 v[88:89], v36 offset:40960
    ds_read_b64_tr_b16 v[90:91], v36 offset:41984
    v_lshlrev_b32 v50, 16, v72
    v_and_b32 v51, 0xffff0000, v72
    v_add_f32 v48, v48, v50
    v_add_f32 v49, v49, v51
    v_lshlrev_b32 v52, 16, v73
    v_and_b32 v53, 0xffff0000, v73
    v_add_f32 v48, v48, v52
    v_add_f32 v49, v49, v53
    s_waitcnt lgkmcnt(7)
    v_mfma_f32_32x32x16_bf16 v[120:135], v[80:83], v[64:67], v[120:135]
    ds_read_b64_tr_b16 v[96:97], v39 offset:40960
    ds_read_b64_tr_b16 v[98:99], v39 offset:41984
    v_lshlrev_b32 v50, 16, v74
    v_and_b32 v51, 0xffff0000, v74
    v_add_f32 v48, v48, v50
    v_add_f32 v49, v49, v51
    v_lshlrev_b32 v52, 16, v75
    v_and_b32 v53, 0xffff0000, v75
    v_add_f32 v48, v48, v52
    v_add_f32 v49, v49, v53
    s_waitcnt lgkmcnt(6)
    v_mfma_f32_32x32x16_bf16 v[104:119], v[76:79], v[68:71], v[104:119]
    ds_read_b64_tr_b16 v[92:93], v36 offset:45056
    ds_read_b64_tr_b16 v[94:95], v36 offset:46080
    v_lshlrev_b32 v50, 16, v76
    v_and_b32 v51, 0xffff0000, v76
    v_add_f32 v48, v48, v50
    v_add_f32 v49, v49, v51
    v_lshlrev_b32 v52, 16, v77
    v_and_b32 v53, 0xffff0000, v77
    v_add_f32 v48, v48, v52
    v_add_f32 v49, v49, v53
    s_waitcnt lgkmcnt(6)
    v_mfma_f32_32x32x16_bf16 v[120:135], v[84:87], v[68:71], v[120:135]
    ds_read_b64_tr_b16 v[100:101], v39 offset:45056
    ds_read_b64_tr_b16 v[102:103], v39 offset:46080
    v_lshlrev_b32 v50, 16, v78
    v_and_b32 v51, 0xffff0000, v78
    v_add_f32 v48, v48, v50
    v_add_f32 v49, v49, v51
    v_lshlrev_b32 v52, 16, v79
    v_and_b32 v53, 0xffff0000, v79
    v_add_f32 v48, v48, v52
    v_add_f32 v49, v49, v53
    s_waitcnt lgkmcnt(6)
    v_mfma_f32_32x32x16_bf16 v[136:151], v[88:91], v[64:67], v[136:151]
    s_waitcnt lgkmcnt(4)
    v_mfma_f32_32x32x16_bf16 v[152:167], v[96:99], v[64:67], v[152:167]
    s_waitcnt lgkmcnt(2)
    v_mfma_f32_32x32x16_bf16 v[136:151], v[92:95], v[68:71], v[136:151]
    s_waitcnt lgkmcnt(0)
    v_mfma_f32_32x32x16_bf16 v[152:167], v[100:103], v[68:71], v[152:167]
    s_nop 11
    s_branch L_EPI
L_MBW:
    s_add_u32 m0, s47, 98304
    s_mov_b32 s42, 128
    buffer_load_dwordx4 v26, s[4:7], s42 offen lds
    s_add_u32 m0, s47, 106496
    s_mov_b32 s42, 229376
    buffer_load_dwordx4 v27, s[76:79], s42 offen lds
    s_add_u32 m0, s47, 114688
    s_mov_b32 s42, 192
    buffer_load_dwordx4 v26, s[4:7], s42 offen lds
    s_add_u32 m0, s47, 122880
    s_mov_b32 s42, 344064
    buffer_load_dwordx4 v27, s[76:79], s42 offen lds
    s_add_u32 m0, s47, 131072
    s_mov_b32 s42, 256
    buffer_load_dwordx4 v26, s[4:7], s42 offen lds
    s_add_u32 m0, s47, 139264
    s_mov_b32 s42, 458752
    buffer_load_dwordx4 v27, s[76:79], s42 offen lds
    s_lshr_b32 s46, s2, 3
    s_and_b32 s44, s46, 7
    s_lshl_b32 s44, s44, 3
    s_add_u32 s44, s44, s38
    s_and_b32 s45, s2, 7
    s_lshl_b32 s45, s45, 2
    s_lshr_b32 s46, s46, 3
    s_add_u32 s45, s45, s46
    s_lshl_b32 s43, s45, 6
    s_add_u32 s43, s43, s44
    s_lshl_b32 s44, s44, 15
    s_lshl_b32 s45, s45, 10
    s_add_u32 s44, s44, s45
    buffer_load_dwordx4 v[176:179], v6, s[4:7], s44 offen
    s_lshr_b32 s44, s2, 4
    s_lshl_b32 s44, s44, 4
    v_add_u32 v186, s44, v4
    v_lshrrev_b32 v190, 2, v1
    v_add_u32 v190, s44, v190
    s_and_b32 s45, s2, 7
    s_lshl_b32 s45, s45, 1
    s_bfe_u32 s46, s2, 0x10003
    s_add_u32 s45, s45, s46
    s_lshr_b32 s46, s45, 2
    s_and_b32 s48, s45, 3
    s_lshl_b32 s48, s48, 1
    s_add_u32 s48, s48, s40
    s_lshl_b32 s41, s48, 8
    s_lshl_b32 s73, s46, 4
    s_add_u32 s41, s41, s73
    s_lshl_b32 s73, s39, 2
    s_add_u32 s41, s41, s73
    v_add_u32 v187, s41, v5
    s_movk_i32 s73, 257
    v_mul_lo_u32 v187, v187, s73
    v_cmp_eq_u32 vcc, 0, v186
    v_mov_b32 v188, 256
    s_nop 0
    v_cndmask_b32 v188, v186, v188, vcc
    v_add_lshl_u32 v181, v187, v188, 1
    s_lshl_b32 s46, s46, 7
    s_lshl_b32 s48, s48, 4
    s_add_u32 s46, s46, s48
    s_lshl_b32 s73, s39, 2
    s_add_u32 s46, s46, s73
    v_and_b32 v188, 3, v1
    v_add_u32 v188, s46, v188
    v_lshlrev_b32 v188, 4, v188
    s_movk_i32 s73, 8448
    v_mad_u32_u24 v180, v190, s73, v188
    s_mov_b32 s57, 0
    buffer_load_ushort v168, v181, s[20:23], s57 offen
    s_mov_b32 s57, 0
    buffer_load_ushort v172, v181, s[24:27], s57 offen
    s_mov_b32 s57, 32896
    buffer_load_ushort v169, v181, s[20:23], s57 offen
    s_mov_b32 s57, 32896
    buffer_load_ushort v173, v181, s[24:27], s57 offen
    s_mov_b32 s57, 65792
    buffer_load_ushort v170, v181, s[20:23], s57 offen
    s_mov_b32 s57, 65792
    buffer_load_ushort v174, v181, s[24:27], s57 offen
    s_mov_b32 s57, 98688
    buffer_load_ushort v171, v181, s[20:23], s57 offen
    s_mov_b32 s57, 98688
    buffer_load_ushort v175, v181, s[24:27], s57 offen
    s_waitcnt vmcnt(17)
    s_barrier
    ds_read_b128 v[56:59], v41 offset:0
    ds_read_b64_tr_b16 v[72:73], v29 offset:0
    ds_read_b64_tr_b16 v[74:75], v29 offset:512
    ds_read_b64_tr_b16 v[80:81], v32 offset:0
    ds_read_b64_tr_b16 v[82:83], v32 offset:512
    ds_read_b128 v[60:63], v44 offset:0
    ds_read_b64_tr_b16 v[76:77], v29 offset:2048
    ds_read_b64_tr_b16 v[78:79], v29 offset:2560
    ds_read_b64_tr_b16 v[84:85], v32 offset:2048
    ds_read_b64_tr_b16 v[86:87], v32 offset:2560
    s_and_b32 s50, s2, 7
    s_lshr_b32 s51, s2, 3
    s_lshl_b32 s53, s51, 3
    s_add_u32 s53, s53, s38
    s_cmp_lt_u32 s53, 128
    s_cbranch_scc0 LPF6W
    s_and_b32 s54, s53, 15
    s_lshl_b32 s54, s54, 2
    v_add_u32 v14, s54, v5
    v_lshlrev_b32 v14, 15, v14
    v_lshl_add_u32 v14, v4, 10, v14
    s_and_b32 s54, s50, 1
    s_lshl_b32 s54, s54, 14
    s_lshr_b32 s53, s53, 4
    s_cmp_lt_u32 s53, 3
    s_cselect_b32 s55, 0x10000000, 0
    s_lshl_b32 s53, s53, 7
    s_add_u32 s54, s54, s53
    s_add_u32 s54, s54, s55
    buffer_load_dword v182, v14, s[4:7], s54 offen
    s_branch LPF6D
LPF6W:
    s_sub_u32 s53, s53, 128
    s_and_b32 s54, s53, 63
    s_cmp_lt_u32 s54, 24
    s_cselect_b32 s55, 0x10000000, 0
    s_lshl_b32 s54, s54, 3
    v_lshrrev_b32 v14, 3, v1
    v_add_u32 v14, s54, v14
    s_movk_i32 s54, 3584
    v_mul_lo_u32 v14, v14, s54
    v_and_b32 v15, 7, v1
    v_lshl_add_u32 v14, v15, 7, v14
    s_lshr_b32 s54, s50, 1
    s_mul_i32 s54, s54, 896
    s_add_u32 s54, s54, s55
    s_cmp_lt_u32 s53, 64
    s_cbranch_scc0 LPF6U
    buffer_load_dword v182, v14, s[8:11], s54 offen
    s_branch LPF6D
LPF6U:
    buffer_load_dword v182, v14, s[12:15], s54 offen
LPF6D:
    s_waitcnt lgkmcnt(7)
    v_mfma_f32_32x32x16_bf16 v[104:119], v[72:75], v[56:59], 0
    ds_read_b64_tr_b16 v[88:89], v35 offset:0
    ds_read_b64_tr_b16 v[90:91], v35 offset:512
    v_lshlrev_b32 v50, 16, v72
    v_and_b32 v51, 0xffff0000, v72
    v_add_f32 v48, v48, v50
    v_add_f32 v49, v49, v51
    v_lshlrev_b32 v52, 16, v73
    v_and_b32 v53, 0xffff0000, v73
    v_add_f32 v48, v48, v52
    v_add_f32 v49, v49, v53
    s_waitcnt lgkmcnt(7)
    v_mfma_f32_32x32x16_bf16 v[120:135], v[80:83], v[56:59], 0
    ds_read_b64_tr_b16 v[96:97], v38 offset:0
    ds_read_b64_tr_b16 v[98:99], v38 offset:512
    v_lshlrev_b32 v50, 16, v74
    v_and_b32 v51, 0xffff0000, v74
    v_add_f32 v48, v48, v50
    v_add_f32 v49, v49, v51
    v_lshlrev_b32 v52, 16, v75
    v_and_b32 v53, 0xffff0000, v75
    v_add_f32 v48, v48, v52
    v_add_f32 v49, v49, v53
    s_waitcnt lgkmcnt(6)
    v_mfma_f32_32x32x16_bf16 v[104:119], v[76:79], v[60:63], v[104:119]
    ds_read_b64_tr_b16 v[92:93], v35 offset:2048
    ds_read_b64_tr_b16 v[94:95], v35 offset:2560
    v_lshlrev_b32 v50, 16, v76
    v_and_b32 v51, 0xffff0000, v76
    v_add_f32 v48, v48, v50
    v_add_f32 v49, v49, v51
    v_lshlrev_b32 v52, 16, v77
    v_and_b32 v53, 0xffff0000, v77
    v_add_f32 v48, v48, v52
    v_add_f32 v49, v49, v53
    s_waitcnt lgkmcnt(6)
    v_mfma_f32_32x32x16_bf16 v[120:135], v[84:87], v[60:63], v[120:135]
    ds_read_b64_tr_b16 v[100:101], v38 offset:2048
    ds_read_b64_tr_b16 v[102:103], v38 offset:2560
    v_lshlrev_b32 v50, 16, v78
    v_and_b32 v51, 0xffff0000, v78
    v_add_f32 v48, v48, v50
    v_add_f32 v49, v49, v51
    v_lshlrev_b32 v52, 16, v79
    v_and_b32 v53, 0xffff0000, v79
    v_add_f32 v48, v48, v52
    v_add_f32 v49, v49, v53
    s_waitcnt vmcnt(16)
    s_barrier
    s_waitcnt lgkmcnt(6)
    v_mfma_f32_32x32x16_bf16 v[136:151], v[88:91], v[56:59], 0
    ds_read_b128 v[64:67], v41 offset:16384
    ds_read_b64_tr_b16 v[72:73], v29 offset:16384
    ds_read_b64_tr_b16 v[74:75], v29 offset:16896
    s_waitcnt lgkmcnt(7)
    v_mfma_f32_32x32x16_bf16 v[152:167], v[96:99], v[56:59], 0
    ds_read_b64_tr_b16 v[80:81], v32 offset:16384
    ds_read_b64_tr_b16 v[82:83], v32 offset:16896
    s_add_u32 m0, s47, 147456
    s_mov_b32 s42, 320
    buffer_load_dwordx4 v26, s[4:7], s42 offen lds
    s_waitcnt lgkmcnt(7)
    v_mfma_f32_32x32x16_bf16 v[136:151], v[92:95], v[60:63], v[136:151]
    ds_read_b128 v[68:71], v44 offset:16384
    ds_read_b64_tr_b16 v[76:77], v29 offset:18432
    ds_read_b64_tr_b16 v[78:79], v29 offset:18944
    s_waitcnt lgkmcnt(8)
    v_mfma_f32_32x32x16_bf16 v[152:167], v[100:103], v[60:63], v[152:167]
    ds_read_b64_tr_b16 v[84:85], v32 offset:18432
    ds_read_b64_tr_b16 v[86:87], v32 offset:18944
    s_waitcnt lgkmcnt(7)
    v_mfma_f32_32x32x16_bf16 v[104:119], v[72:75], v[64:67], v[104:119]
    ds_read_b64_tr_b16 v[88:89], v35 offset:16384
    ds_read_b64_tr_b16 v[90:91], v35 offset:16896
    v_lshlrev_b32 v50, 16, v72
    v_and_b32 v51, 0xffff0000, v72
    v_add_f32 v48, v48, v50
    v_add_f32 v49, v49, v51
    v_lshlrev_b32 v52, 16, v73
    v_and_b32 v53, 0xffff0000, v73
    v_add_f32 v48, v48, v52
    v_add_f32 v49, v49, v53
    s_waitcnt lgkmcnt(7)
    v_mfma_f32_32x32x16_bf16 v[120:135], v[80:83], v[64:67], v[120:135]
    ds_read_b64_tr_b16 v[96:97], v38 offset:16384
    ds_read_b64_tr_b16 v[98:99], v38 offset:16896
    v_lshlrev_b32 v50, 16, v74
    v_and_b32 v51, 0xffff0000, v74
    v_add_f32 v48, v48, v50
    v_add_f32 v49, v49, v51
    v_lshlrev_b32 v52, 16, v75
    v_and_b32 v53, 0xffff0000, v75
    v_add_f32 v48, v48, v52
    v_add_f32 v49, v49, v53
    s_add_u32 m0, s47, 155648
    s_mov_b32 s42, 573440
    buffer_load_dwordx4 v27, s[76:79], s42 offen lds
    s_waitcnt lgkmcnt(6)
    v_mfma_f32_32x32x16_bf16 v[104:119], v[76:79], v[68:71], v[104:119]
    ds_read_b64_tr_b16 v[92:93], v35 offset:18432
    ds_read_b64_tr_b16 v[94:95], v35 offset:18944
    v_lshlrev_b32 v50, 16, v76
    v_and_b32 v51, 0xffff0000, v76
    v_add_f32 v48, v48, v50
    v_add_f32 v49, v49, v51
    v_lshlrev_b32 v52, 16, v77
    v_and_b32 v53, 0xffff0000, v77
    v_add_f32 v48, v48, v52
    v_add_f32 v49, v49, v53
    s_waitcnt lgkmcnt(6)
    v_mfma_f32_32x32x16_bf16 v[120:135], v[84:87], v[68:71], v[120:135]
    ds_read_b64_tr_b16 v[100:101], v38 offset:18432
    ds_read_b64_tr_b16 v[102:103], v38 offset:18944
    v_lshlrev_b32 v50, 16, v78
    v_and_b32 v51, 0xffff0000, v78
    v_add_f32 v48, v48, v50
    v_add_f32 v49, v49, v51
    v_lshlrev_b32 v52, 16, v79
    v_and_b32 v53, 0xffff0000, v79
    v_add_f32 v48, v48, v52
    v_add_f32 v49, v49, v53
    s_waitcnt vmcnt(16)
    s_barrier
    s_waitcnt lgkmcnt(6)
    v_mfma_f32_32x32x16_bf16 v[136:151], v[88:91], v[64:67], v[136:151]
    ds_read_b128 v[56:59], v42 offset:0
    ds_read_b64_tr_b16 v[72:73], v30 offset:0
    ds_read_b64_tr_b16 v[74:75], v30 offset:512
    s_waitcnt vmcnt(11)
    v_lshlrev_b32 v186, 16, v176
    v_and_b32 v187, 0xffff0000, v176
    s_waitcnt lgkmcnt(7)
    v_mfma_f32_32x32x16_bf16 v[152:167], v[96:99], v[64:67], v[152:167]
    ds_read_b64_tr_b16 v[80:81], v33 offset:0
    ds_read_b64_tr_b16 v[82:83], v33 offset:512
    v_lshlrev_b32 v188, 16, v177
    v_and_b32 v189, 0xffff0000, v177
    s_add_u32 m0, s47, 65536
    s_mov_b32 s42, 384
    buffer_load_dwordx4 v26, s[4:7], s42 offen lds
    s_waitcnt lgkmcnt(7)
    v_mfma_f32_32x32x16_bf16 v[136:151], v[92:95], v[68:71], v[136:151]
    ds_read_b128 v[60:63], v45 offset:0
    ds_read_b64_tr_b16 v[76:77], v30 offset:2048
    ds_read_b64_tr_b16 v[78:79], v30 offset:2560
    v_lshlrev_b32 v190, 16, v178
    v_and_b32 v191, 0xffff0000, v178
    s_waitcnt lgkmcnt(8)
    v_mfma_f32_32x32x16_bf16 v[152:167], v[100:103], v[68:71], v[152:167]
    ds_read_b64_tr_b16 v[84:85], v33 offset:2048
    ds_read_b64_tr_b16 v[86:87], v33 offset:2560
    v_lshlrev_b32 v192, 16, v179
    v_and_b32 v193, 0xffff0000, v179
    s_waitcnt lgkmcnt(7)
    v_mfma_f32_32x32x16_bf16 v[104:119], v[72:75], v[56:59], v[104:119]
    ds_read_b64_tr_b16 v[88:89], v36 offset:0
    ds_read_b64_tr_b16 v[90:91], v36 offset:512
    v_lshlrev_b32 v50, 16, v72
    v_and_b32 v51, 0xffff0000, v72
    v_add_f32 v48, v48, v50
    v_add_f32 v49, v49, v51
    v_lshlrev_b32 v52, 16, v73
    v_and_b32 v53, 0xffff0000, v73
    v_add_f32 v48, v48, v52
    v_add_f32 v49, v49, v53
    v_add_f32 v176, v186, v187
    v_mul_f32 v177, v186, v186
    s_waitcnt lgkmcnt(7)
    v_mfma_f32_32x32x16_bf16 v[120:135], v[80:83], v[56:59], v[120:135]
    ds_read_b64_tr_b16 v[96:97], v39 offset:0
    ds_read_b64_tr_b16 v[98:99], v39 offset:512
    v_lshlrev_b32 v50, 16, v74
    v_and_b32 v51, 0xffff0000, v74
    v_add_f32 v48, v48, v50
    v_add_f32 v49, v49, v51
    v_lshlrev_b32 v52, 16, v75
    v_and_b32 v53, 0xffff0000, v75
    v_add_f32 v48, v48, v52
    v_add_f32 v49, v49, v53
    v_fma_f32 v177, v187, v187, v177
    v_add_f32 v176, v176, v188
    s_add_u32 m0, s47, 73728
    s_mov_b32 s42, 688128
    buffer_load_dwordx4 v27, s[76:79], s42 offen lds
    s_waitcnt lgkmcnt(6)
    v_mfma_f32_32x32x16_bf16 v[104:119], v[76:79], v[60:63], v[104:119]
    ds_read_b64_tr_b16 v[92:93], v36 offset:2048
    ds_read_b64_tr_b16 v[94:95], v36 offset:2560
    v_lshlrev_b32 v50, 16, v76
    v_and_b32 v51, 0xffff0000, v76
    v_add_f32 v48, v48, v50
    v_add_f32 v49, v49, v51
    v_lshlrev_b32 v52, 16, v77
    v_and_b32 v53, 0xffff0000, v77
    v_add_f32 v48, v48, v52
    v_add_f32 v49, v49, v53
    v_fma_f32 v177, v188, v188, v177
    v_add_f32 v176, v176, v189
    s_waitcnt lgkmcnt(6)
    v_mfma_f32_32x32x16_bf16 v[120:135], v[84:87], v[60:63], v[120:135]
    ds_read_b64_tr_b16 v[100:101], v39 offset:2048
    ds_read_b64_tr_b16 v[102:103], v39 offset:2560
    v_lshlrev_b32 v50, 16, v78
    v_and_b32 v51, 0xffff0000, v78
    v_add_f32 v48, v48, v50
    v_add_f32 v49, v49, v51
    v_lshlrev_b32 v52, 16, v79
    v_and_b32 v53, 0xffff0000, v79
    v_add_f32 v48, v48, v52
    v_add_f32 v49, v49, v53
    v_fma_f32 v177, v189, v189, v177
    v_add_f32 v176, v176, v190
    s_barrier
    s_waitcnt lgkmcnt(6)
    v_mfma_f32_32x32x16_bf16 v[136:151], v[88:91], v[56:59], v[136:151]
    ds_read_b128 v[64:67], v42 offset:16384
    ds_read_b64_tr_b16 v[72:73], v30 offset:16384
    ds_read_b64_tr_b16 v[74:75], v30 offset:16896
    v_fma_f32 v177, v190, v190, v177
    v_add_f32 v176, v176, v191
    s_waitcnt lgkmcnt(7)
    v_mfma_f32_32x32x16_bf16 v[152:167], v[96:99], v[56:59], v[152:167]
    ds_read_b64_tr_b16 v[80:81], v33 offset:16384
    ds_read_b64_tr_b16 v[82:83], v33 offset:16896
    v_fma_f32 v177, v191, v191, v177
    v_add_f32 v176, v176, v192
    s_add_u32 m0, s47, 81920
    s_mov_b32 s42, 448
    buffer_load_dwordx4 v26, s[4:7], s42 offen lds
    s_waitcnt lgkmcnt(7)
    v_mfma_f32_32x32x16_bf16 v[136:151], v[92:95], v[60:63], v[136:151]
    ds_read_b128 v[68:71], v45 offset:16384
    ds_read_b64_tr_b16 v[76:77], v30 offset:18432
    ds_read_b64_tr_b16 v[78:79], v30 offset:18944
    v_fma_f32 v177, v192, v192, v177
    v_add_f32 v176, v176, v193
    s_waitcnt lgkmcnt(8)
    v_mfma_f32_32x32x16_bf16 v[152:167], v[100:103], v[60:63], v[152:167]
    ds_read_b64_tr_b16 v[84:85], v33 offset:18432
    ds_read_b64_tr_b16 v[86:87], v33 offset:18944
    v_fma_f32 v177, v193, v193, v177
    s_nop 1
    v_add_f32_dpp v176, v176, v176 row_ror:8 row_mask:0xf bank_mask:0xf
    v_add_f32_dpp v177, v177, v177 row_ror:8 row_mask:0xf bank_mask:0xf
    s_waitcnt lgkmcnt(7)
    v_mfma_f32_32x32x16_bf16 v[104:119], v[72:75], v[64:67], v[104:119]
    ds_read_b64_tr_b16 v[88:89], v36 offset:16384
    ds_read_b64_tr_b16 v[90:91], v36 offset:16896
    v_lshlrev_b32 v50, 16, v72
    v_and_b32 v51, 0xffff0000, v72
    v_add_f32 v48, v48, v50
    v_add_f32 v49, v49, v51
    v_lshlrev_b32 v52, 16, v73
    v_and_b32 v53, 0xffff0000, v73
    v_add_f32 v48, v48, v52
    v_add_f32 v49, v49, v53
    s_nop 1
    v_add_f32_dpp v176, v176, v176 row_ror:4 row_mask:0xf bank_mask:0xf
    v_add_f32_dpp v177, v177, v177 row_ror:4 row_mask:0xf bank_mask:0xf
    s_waitcnt lgkmcnt(7)
    v_mfma_f32_32x32x16_bf16 v[120:135], v[80:83], v[64:67], v[120:135]
    ds_read_b64_tr_b16 v[96:97], v39 offset:16384
    ds_read_b64_tr_b16 v[98:99], v39 offset:16896
    v_lshlrev_b32 v50, 16, v74
    v_and_b32 v51, 0xffff0000, v74
    v_add_f32 v48, v48, v50
    v_add_f32 v49, v49, v51
    v_lshlrev_b32 v52, 16, v75
    v_and_b32 v53, 0xffff0000, v75
    v_add_f32 v48, v48, v52
    v_add_f32 v49, v49, v53
    s_nop 1
    v_add_f32_dpp v176, v176, v176 row_ror:2 row_mask:0xf bank_mask:0xf
    v_add_f32_dpp v177, v177, v177 row_ror:2 row_mask:0xf bank_mask:0xf
    s_add_u32 m0, s47, 90112
    s_mov_b32 s42, 802816
    buffer_load_dwordx4 v27, s[76:79], s42 offen lds
    s_waitcnt lgkmcnt(6)
    v_mfma_f32_32x32x16_bf16 v[104:119], v[76:79], v[68:71], v[104:119]
    ds_read_b64_tr_b16 v[92:93], v36 offset:18432
    ds_read_b64_tr_b16 v[94:95], v36 offset:18944
    v_lshlrev_b32 v50, 16, v76
    v_and_b32 v51, 0xffff0000, v76
    v_add_f32 v48, v48, v50
    v_add_f32 v49, v49, v51
    v_lshlrev_b32 v52, 16, v77
    v_and_b32 v53, 0xffff0000, v77
    v_add_f32 v48, v48, v52
    v_add_f32 v49, v49, v53
    s_nop 1
    v_add_f32_dpp v176, v176, v176 row_ror:1 row_mask:0xf bank_mask:0xf
    v_add_f32_dpp v177, v177, v177 row_ror:1 row_mask:0xf bank_mask:0xf
    s_waitcnt lgkmcnt(6)
    v_mfma_f32_32x32x16_bf16 v[120:135], v[84:87], v[68:71], v[120:135]
    ds_read_b64_tr_b16 v[100:101], v39 offset:18432
    ds_read_b64_tr_b16 v[102:103], v39 offset:18944
    v_lshlrev_b32 v50, 16, v78
    v_and_b32 v51, 0xffff0000, v78
    v_add_f32 v48, v48, v50
    v_add_f32 v49, v49, v51
    v_lshlrev_b32 v52, 16, v79
    v_and_b32 v53, 0xffff0000, v79
    v_add_f32 v48, v48, v52
    v_add_f32 v49, v49, v53
    v_mov_b32 v178, v176
    v_mov_b32 v179, v177
    s_nop 1
    v_permlane16_swap_b32 v176, v178
    v_permlane16_swap_b32 v177, v179
    s_nop 0
    v_add_f32 v176, v176, v178
    v_add_f32 v177, v177, v179
    s_barrier
    s_waitcnt lgkmcnt(6)
    v_mfma_f32_32x32x16_bf16 v[136:151], v[88:91], v[64:67], v[136:151]
    ds_read_b128 v[56:59], v43 offset:0
    ds_read_b64_tr_b16 v[72:73], v31 offset:0
    ds_read_b64_tr_b16 v[74:75], v31 offset:512
    v_mov_b32 v178, v176
    v_mov_b32 v179, v177
    s_nop 1
    v_permlane32_swap_b32 v176, v178
    v_permlane32_swap_b32 v177, v179
    s_nop 0
    v_add_f32 v176, v176, v178
    v_add_f32 v177, v177, v179
    s_waitcnt lgkmcnt(7)
    v_mfma_f32_32x32x16_bf16 v[152:167], v[96:99], v[64:67], v[152:167]
    ds_read_b64_tr_b16 v[80:81], v34 offset:0
    ds_read_b64_tr_b16 v[82:83], v34 offset:512
    v_mul_f32 v176, 0x3b000000, v176
    v_mul_f32 v177, 0x3b000000, v177
    s_add_u32 m0, s47, 98304
    s_mov_b32 s42, 512
    buffer_load_dwordx4 v26, s[4:7], s42 offen lds
    s_waitcnt lgkmcnt(7)
    v_mfma_f32_32x32x16_bf16 v[136:151], v[92:95], v[68:71], v[136:151]
    ds_read_b128 v[60:63], v46 offset:0
    ds_read_b64_tr_b16 v[76:77], v31 offset:2048
    ds_read_b64_tr_b16 v[78:79], v31 offset:2560
    v_fma_f32 v177, -v176, v176, v177
    v_max_f32 v177, 0, v177
    s_waitcnt lgkmcnt(8)
    v_mfma_f32_32x32x16_bf16 v[152:167], v[100:103], v[68:71], v[152:167]
    ds_read_b64_tr_b16 v[84:85], v34 offset:2048
    ds_read_b64_tr_b16 v[86:87], v34 offset:2560
    v_cvt_pk_bf16_f32 v178, v176, v177
    v_lshlrev_b32 v176, 16, v178
    v_and_b32 v177, 0xffff0000, v178
    s_waitcnt lgkmcnt(7)
    v_mfma_f32_32x32x16_bf16 v[104:119], v[72:75], v[56:59], v[104:119]
    ds_read_b64_tr_b16 v[88:89], v37 offset:0
    ds_read_b64_tr_b16 v[90:91], v37 offset:512
    v_lshlrev_b32 v50, 16, v72
    v_and_b32 v51, 0xffff0000, v72
    v_add_f32 v48, v48, v50
    v_add_f32 v49, v49, v51
    v_lshlrev_b32 v52, 16, v73
    v_and_b32 v53, 0xffff0000, v73
    v_add_f32 v48, v48, v52
    v_add_f32 v49, v49, v53
    v_add_f32 v177, 0x3727c5ac, v177
    v_cvt_pk_bf16_f32 v178, v177, v177
    v_lshlrev_b32 v177, 16, v178
    s_waitcnt lgkmcnt(7)
    v_mfma_f32_32x32x16_bf16 v[120:135], v[80:83], v[56:59], v[120:135]
    ds_read_b64_tr_b16 v[96:97], v40 offset:0
    ds_read_b64_tr_b16 v[98:99], v40 offset:512
    v_lshlrev_b32 v50, 16, v74
    v_and_b32 v51, 0xffff0000, v74
    v_add_f32 v48, v48, v50
    v_add_f32 v49, v49, v51
    v_lshlrev_b32 v52, 16, v75
    v_and_b32 v53, 0xffff0000, v75
    v_add_f32 v48, v48, v52
    v_add_f32 v49, v49, v53
    v_sqrt_f32 v177, v177
    s_nop 0
    v_cvt_pk_bf16_f32 v178, v177, v177
    v_lshlrev_b32 v177, 16, v178
    s_add_u32 m0, s47, 106496
    s_mov_b32 s42, 917504
    buffer_load_dwordx4 v27, s[76:79], s42 offen lds
    s_waitcnt lgkmcnt(6)
    v_mfma_f32_32x32x16_bf16 v[104:119], v[76:79], v[60:63], v[104:119]
    ds_read_b64_tr_b16 v[92:93], v37 offset:2048
    ds_read_b64_tr_b16 v[94:95], v37 offset:2560
    v_lshlrev_b32 v50, 16, v76
    v_and_b32 v51, 0xffff0000, v76
    v_add_f32 v48, v48, v50
    v_add_f32 v49, v49, v51
    v_lshlrev_b32 v52, 16, v77
    v_and_b32 v53, 0xffff0000, v77
    v_add_f32 v48, v48, v52
    v_add_f32 v49, v49, v53
    v_rcp_f32 v178, v177
    v_mov_b32 v179, v176
    s_nop 0
    s_waitcnt lgkmcnt(6)
    v_mfma_f32_32x32x16_bf16 v[120:135], v[84:87], v[60:63], v[120:135]
    ds_read_b64_tr_b16 v[100:101], v40 offset:2048
    ds_read_b64_tr_b16 v[102:103], v40 offset:2560
    v_lshlrev_b32 v50, 16, v78
    v_and_b32 v51, 0xffff0000, v78
    v_add_f32 v48, v48, v50
    v_add_f32 v49, v49, v51
    v_lshlrev_b32 v52, 16, v79
    v_and_b32 v53, 0xffff0000, v79
    v_add_f32 v48, v48, v52
    v_add_f32 v49, v49, v53
    s_lshl_b32 s44, s43, 3
    s_add_u32 s44, s44, 14024704
    s_mov_b64 s[62:63], exec
    s_mov_b64 exec, 1
    buffer_store_dwordx2 v[178:179], v25, s[28:31], s44 offen sc1
    s_mov_b64 exec, s[62:63]
    s_waitcnt vmcnt(7)
    s_barrier
    s_waitcnt lgkmcnt(6)
    v_mfma_f32_32x32x16_bf16 v[136:151], v[88:91], v[56:59], v[136:151]
    ds_read_b128 v[64:67], v43 offset:16384
    ds_read_b64_tr_b16 v[72:73], v31 offset:16384
    ds_read_b64_tr_b16 v[74:75], v31 offset:16896
    s_waitcnt lgkmcnt(7)
    v_mfma_f32_32x32x16_bf16 v[152:167], v[96:99], v[56:59], v[152:167]
    ds_read_b64_tr_b16 v[80:81], v34 offset:16384
    ds_read_b64_tr_b16 v[82:83], v34 offset:16896
    s_add_u32 m0, s47, 114688
    s_mov_b32 s42, 576
    buffer_load_dwordx4 v26, s[4:7], s42 offen lds
    s_waitcnt lgkmcnt(7)
    v_mfma_f32_32x32x16_bf16 v[136:151], v[92:95], v[60:63], v[136:151]
    ds_read_b128 v[68:71], v46 offset:16384
    ds_read_b64_tr_b16 v[76:77], v31 offset:18432
    ds_read_b64_tr_b16 v[78:79], v31 offset:18944
    s_waitcnt lgkmcnt(8)
    v_mfma_f32_32x32x16_bf16 v[152:167], v[100:103], v[60:63], v[152:167]
    ds_read_b64_tr_b16 v[84:85], v34 offset:18432
    ds_read_b64_tr_b16 v[86:87], v34 offset:18944
    s_waitcnt lgkmcnt(7)
    v_mfma_f32_32x32x16_bf16 v[104:119], v[72:75], v[64:67], v[104:119]
    ds_read_b64_tr_b16 v[88:89], v37 offset:16384
    ds_read_b64_tr_b16 v[90:91], v37 offset:16896
    v_lshlrev_b32 v50, 16, v72
    v_and_b32 v51, 0xffff0000, v72
    v_add_f32 v48, v48, v50
    v_add_f32 v49, v49, v51
    v_lshlrev_b32 v52, 16, v73
    v_and_b32 v53, 0xffff0000, v73
    v_add_f32 v48, v48, v52
    v_add_f32 v49, v49, v53
    s_waitcnt lgkmcnt(7)
    v_mfma_f32_32x32x16_bf16 v[120:135], v[80:83], v[64:67], v[120:135]
    ds_read_b64_tr_b16 v[96:97], v40 offset:16384
    ds_read_b64_tr_b16 v[98:99], v40 offset:16896
    v_lshlrev_b32 v50, 16, v74
    v_and_b32 v51, 0xffff0000, v74
    v_add_f32 v48, v48, v50
    v_add_f32 v49, v49, v51
    v_lshlrev_b32 v52, 16, v75
    v_and_b32 v53, 0xffff0000, v75
    v_add_f32 v48, v48, v52
    v_add_f32 v49, v49, v53
    s_add_u32 m0, s47, 122880
    s_mov_b32 s42, 1032192
    buffer_load_dwordx4 v27, s[76:79], s42 offen lds
    s_waitcnt lgkmcnt(6)
    v_mfma_f32_32x32x16_bf16 v[104:119], v[76:79], v[68:71], v[104:119]
    ds_read_b64_tr_b16 v[92:93], v37 offset:18432
    ds_read_b64_tr_b16 v[94:95], v37 offset:18944
    v_lshlrev_b32 v50, 16, v76
    v_and_b32 v51, 0xffff0000, v76
    v_add_f32 v48, v48, v50
    v_add_f32 v49, v49, v51
    v_lshlrev_b32 v52, 16, v77
    v_and_b32 v53, 0xffff0000, v77
    v_add_f32 v48, v48, v52
    v_add_f32 v49, v49, v53
    s_waitcnt lgkmcnt(6)
    v_mfma_f32_32x32x16_bf16 v[120:135], v[84:87], v[68:71], v[120:135]
    ds_read_b64_tr_b16 v[100:101], v40 offset:18432
    ds_read_b64_tr_b16 v[102:103], v40 offset:18944
    v_lshlrev_b32 v50, 16, v78
    v_and_b32 v51, 0xffff0000, v78
    v_add_f32 v48, v48, v50
    v_add_f32 v49, v49, v51
    v_lshlrev_b32 v52, 16, v79
    v_and_b32 v53, 0xffff0000, v79
    v_add_f32 v48, v48, v52
    v_add_f32 v49, v49, v53
    s_waitcnt vmcnt(7)
    s_barrier
    s_waitcnt lgkmcnt(6)
    v_mfma_f32_32x32x16_bf16 v[136:151], v[88:91], v[64:67], v[136:151]
    ds_read_b128 v[56:59], v41 offset:0
    ds_read_b64_tr_b16 v[72:73], v29 offset:0
    ds_read_b64_tr_b16 v[74:75], v29 offset:512
    s_waitcnt lgkmcnt(7)
    v_mfma_f32_32x32x16_bf16 v[152:167], v[96:99], v[64:67], v[152:167]
    ds_read_b64_tr_b16 v[80:81], v32 offset:0
    ds_read_b64_tr_b16 v[82:83], v32 offset:512
    s_add_u32 m0, s47, 131072
    s_mov_b32 s42, 640
    buffer_load_dwordx4 v26, s[4:7], s42 offen lds
    s_waitcnt lgkmcnt(7)
    v_mfma_f32_32x32x16_bf16 v[136:151], v[92:95], v[68:71], v[136:151]
    ds_read_b128 v[60:63], v44 offset:0
    ds_read_b64_tr_b16 v[76:77], v29 offset:2048
    ds_read_b64_tr_b16 v[78:79], v29 offset:2560
    s_waitcnt lgkmcnt(8)
    v_mfma_f32_32x32x16_bf16 v[152:167], v[100:103], v[68:71], v[152:167]
    ds_read_b64_tr_b16 v[84:85], v32 offset:2048
    ds_read_b64_tr_b16 v[86:87], v32 offset:2560
    s_waitcnt lgkmcnt(7)
    v_mfma_f32_32x32x16_bf16 v[104:119], v[72:75], v[56:59], v[104:119]
    ds_read_b64_tr_b16 v[88:89], v35 offset:0
    ds_read_b64_tr_b16 v[90:91], v35 offset:512
    v_lshlrev_b32 v50, 16, v72
    v_and_b32 v51, 0xffff0000, v72
    v_add_f32 v48, v48, v50
    v_add_f32 v49, v49, v51
    v_lshlrev_b32 v52, 16, v73
    v_and_b32 v53, 0xffff0000, v73
    v_add_f32 v48, v48, v52
    v_add_f32 v49, v49, v53
    s_waitcnt lgkmcnt(7)
    v_mfma_f32_32x32x16_bf16 v[120:135], v[80:83], v[56:59], v[120:135]
    ds_read_b64_tr_b16 v[96:97], v38 offset:0
    ds_read_b64_tr_b16 v[98:99], v38 offset:512
    v_lshlrev_b32 v50, 16, v74
    v_and_b32 v51, 0xffff0000, v74
    v_add_f32 v48, v48, v50
    v_add_f32 v49, v49, v51
    v_lshlrev_b32 v52, 16, v75
    v_and_b32 v53, 0xffff0000, v75
    v_add_f32 v48, v48, v52
    v_add_f32 v49, v49, v53
    s_add_u32 m0, s47, 139264
    s_mov_b32 s42, 1146880
    buffer_load_dwordx4 v27, s[76:79], s42 offen lds
    s_waitcnt lgkmcnt(6)
    v_mfma_f32_32x32x16_bf16 v[104:119], v[76:79], v[60:63], v[104:119]
    ds_read_b64_tr_b16 v[92:93], v35 offset:2048
    ds_read_b64_tr_b16 v[94:95], v35 offset:2560
    v_lshlrev_b32 v50, 16, v76
    v_and_b32 v51, 0xffff0000, v76
    v_add_f32 v48, v48, v50
    v_add_f32 v49, v49, v51
    v_lshlrev_b32 v52, 16, v77
    v_and_b32 v53, 0xffff0000, v77
    v_add_f32 v48, v48, v52
    v_add_f32 v49, v49, v53
    s_waitcnt lgkmcnt(6)
    v_mfma_f32_32x32x16_bf16 v[120:135], v[84:87], v[60:63], v[120:135]
    ds_read_b64_tr_b16 v[100:101], v38 offset:2048
    ds_read_b64_tr_b16 v[102:103], v38 offset:2560
    v_lshlrev_b32 v50, 16, v78
    v_and_b32 v51, 0xffff0000, v78
    v_add_f32 v48, v48, v50
    v_add_f32 v49, v49, v51
    v_lshlrev_b32 v52, 16, v79
    v_and_b32 v53, 0xffff0000, v79
    v_add_f32 v48, v48, v52
    v_add_f32 v49, v49, v53
    s_waitcnt vmcnt(7)
    s_barrier
    s_waitcnt lgkmcnt(6)
    v_mfma_f32_32x32x16_bf16 v[136:151], v[88:91], v[56:59], v[136:151]
    ds_read_b128 v[64:67], v41 offset:16384
    ds_read_b64_tr_b16 v[72:73], v29 offset:16384
    ds_read_b64_tr_b16 v[74:75], v29 offset:16896
    v_lshl_or_b32 v168, v172, 16, v168
    s_waitcnt lgkmcnt(7)
    v_mfma_f32_32x32x16_bf16 v[152:167], v[96:99], v[56:59], v[152:167]
    ds_read_b64_tr_b16 v[80:81], v32 offset:16384
    ds_read_b64_tr_b16 v[82:83], v32 offset:16896
    v_lshl_or_b32 v169, v173, 16, v169
    v_lshl_or_b32 v170, v174, 16, v170
    s_add_u32 m0, s47, 147456
    s_mov_b32 s42, 704
    buffer_load_dwordx4 v26, s[4:7], s42 offen lds
    s_waitcnt lgkmcnt(7)
    v_mfma_f32_32x32x16_bf16 v[136:151], v[92:95], v[60:63], v[136:151]
    ds_read_b128 v[68:71], v44 offset:16384
    ds_read_b64_tr_b16 v[76:77], v29 offset:18432
    ds_read_b64_tr_b16 v[78:79], v29 offset:18944
    v_lshl_or_b32 v171, v175, 16, v171
    v_and_b32 v186, 3, v1
    v_lshlrev_b32 v186, 4, v186
    v_lshrrev_b32 v187, 2, v1
    v_add_lshl_u32 v186, v186, v187, 2
    s_waitcnt lgkmcnt(8)
    v_mfma_f32_32x32x16_bf16 v[152:167], v[100:103], v[60:63], v[152:167]
    ds_read_b64_tr_b16 v[84:85], v32 offset:18432
    ds_read_b64_tr_b16 v[86:87], v32 offset:18944
    ds_bpermute_b32 v172, v186, v168
    ds_bpermute_b32 v173, v186, v169
    s_waitcnt lgkmcnt(9)
    v_mfma_f32_32x32x16_bf16 v[104:119], v[72:75], v[64:67], v[104:119]
    ds_read_b64_tr_b16 v[88:89], v35 offset:16384
    ds_read_b64_tr_b16 v[90:91], v35 offset:16896
    v_lshlrev_b32 v50, 16, v72
    v_and_b32 v51, 0xffff0000, v72
    v_add_f32 v48, v48, v50
    v_add_f32 v49, v49, v51
    v_lshlrev_b32 v52, 16, v73
    v_and_b32 v53, 0xffff0000, v73
    v_add_f32 v48, v48, v52
    v_add_f32 v49, v49, v53
    ds_bpermute_b32 v174, v186, v170
    ds_bpermute_b32 v175, v186, v171
    s_waitcnt lgkmcnt(11)
    v_mfma_f32_32x32x16_bf16 v[120:135], v[80:83], v[64:67], v[120:135]
    ds_read_b64_tr_b16 v[96:97], v38 offset:16384
    ds_read_b64_tr_b16 v[98:99], v38 offset:16896
    v_lshlrev_b32 v50, 16, v74
    v_and_b32 v51, 0xffff0000, v74
    v_add_f32 v48, v48, v50
    v_add_f32 v49, v49, v51
    v_lshlrev_b32 v52, 16, v75
    v_and_b32 v53, 0xffff0000, v75
    v_add_f32 v48, v48, v52
    v_add_f32 v49, v49, v53
    s_waitcnt lgkmcnt(2)
    s_mov_b32 s44, 9568256
    buffer_store_dwordx4 v[172:175], v180, s[28:31], s44 offen sc1
    s_add_u32 m0, s47, 155648
    s_mov_b32 s42, 1261568
    buffer_load_dwordx4 v27, s[76:79], s42 offen lds
    v_mfma_f32_32x32x16_bf16 v[104:119], v[76:79], v[68:71], v[104:119]
    ds_read_b64_tr_b16 v[92:93], v35 offset:18432
    ds_read_b64_tr_b16 v[94:95], v35 offset:18944
    v_lshlrev_b32 v50, 16, v76
    v_and_b32 v51, 0xffff0000, v76
    v_add_f32 v48, v48, v50
    v_add_f32 v49, v49, v51
    v_lshlrev_b32 v52, 16, v77
    v_and_b32 v53, 0xffff0000, v77
    v_add_f32 v48, v48, v52
    v_add_f32 v49, v49, v53
    v_mfma_f32_32x32x16_bf16 v[120:135], v[84:87], v[68:71], v[120:135]
    ds_read_b64_tr_b16 v[100:101], v38 offset:18432
    ds_read_b64_tr_b16 v[102:103], v38 offset:18944
    v_lshlrev_b32 v50, 16, v78
    v_and_b32 v51, 0xffff0000, v78
    v_add_f32 v48, v48, v50
    v_add_f32 v49, v49, v51
    v_lshlrev_b32 v52, 16, v79
    v_and_b32 v53, 0xffff0000, v79
    v_add_f32 v48, v48, v52
    v_add_f32 v49, v49, v53
    s_waitcnt vmcnt(8)
    s_barrier
    v_mfma_f32_32x32x16_bf16 v[136:151], v[88:91], v[64:67], v[136:151]
    ds_read_b128 v[56:59], v42 offset:0
    ds_read_b64_tr_b16 v[72:73], v30 offset:0
    ds_read_b64_tr_b16 v[74:75], v30 offset:512
    s_waitcnt lgkmcnt(7)
    v_mfma_f32_32x32x16_bf16 v[152:167], v[96:99], v[64:67], v[152:167]
    ds_read_b64_tr_b16 v[80:81], v33 offset:0
    ds_read_b64_tr_b16 v[82:83], v33 offset:512
    s_add_u32 m0, s47, 65536
    s_mov_b32 s42, 768
    buffer_load_dwordx4 v26, s[4:7], s42 offen lds
    s_waitcnt lgkmcnt(7)
    v_mfma_f32_32x32x16_bf16 v[136:151], v[92:95], v[68:71], v[136:151]
    ds_read_b128 v[60:63], v45 offset:0
    ds_read_b64_tr_b16 v[76:77], v30 offset:2048
    ds_read_b64_tr_b16 v[78:79], v30 offset:2560
    s_waitcnt lgkmcnt(8)
    v_mfma_f32_32x32x16_bf16 v[152:167], v[100:103], v[68:71], v[152:167]
    ds_read_b64_tr_b16 v[84:85], v33 offset:2048
    ds_read_b64_tr_b16 v[86:87], v33 offset:2560
    s_waitcnt lgkmcnt(7)
    v_mfma_f32_32x32x16_bf16 v[104:119], v[72:75], v[56:59], v[104:119]
    ds_read_b64_tr_b16 v[88:89], v36 offset:0
    ds_read_b64_tr_b16 v[90:91], v36 offset:512
    v_lshlrev_b32 v50, 16, v72
    v_and_b32 v51, 0xffff0000, v72
    v_add_f32 v48, v48, v50
    v_add_f32 v49, v49, v51
    v_lshlrev_b32 v52, 16, v73
    v_and_b32 v53, 0xffff0000, v73
    v_add_f32 v48, v48, v52
    v_add_f32 v49, v49, v53
    s_waitcnt lgkmcnt(7)
    v_mfma_f32_32x32x16_bf16 v[120:135], v[80:83], v[56:59], v[120:135]
    ds_read_b64_tr_b16 v[96:97], v39 offset:0
    ds_read_b64_tr_b16 v[98:99], v39 offset:512
    v_lshlrev_b32 v50, 16, v74
    v_and_b32 v51, 0xffff0000, v74
    v_add_f32 v48, v48, v50
    v_add_f32 v49, v49, v51
    v_lshlrev_b32 v52, 16, v75
    v_and_b32 v53, 0xffff0000, v75
    v_add_f32 v48, v48, v52
    v_add_f32 v49, v49, v53
    s_add_u32 m0, s47, 73728
    s_mov_b32 s42, 1376256
    buffer_load_dwordx4 v27, s[76:79], s42 offen lds
    s_waitcnt lgkmcnt(6)
    v_mfma_f32_32x32x16_bf16 v[104:119], v[76:79], v[60:63], v[104:119]
    ds_read_b64_tr_b16 v[92:93], v36 offset:2048
    ds_read_b64_tr_b16 v[94:95], v36 offset:2560
    v_lshlrev_b32 v50, 16, v76
    v_and_b32 v51, 0xffff0000, v76
    v_add_f32 v48, v48, v50
    v_add_f32 v49, v49, v51
    v_lshlrev_b32 v52, 16, v77
    v_and_b32 v53, 0xffff0000, v77
    v_add_f32 v48, v48, v52
    v_add_f32 v49, v49, v53
    s_waitcnt lgkmcnt(6)
    v_mfma_f32_32x32x16_bf16 v[120:135], v[84:87], v[60:63], v[120:135]
    ds_read_b64_tr_b16 v[100:101], v39 offset:2048
    ds_read_b64_tr_b16 v[102:103], v39 offset:2560
    v_lshlrev_b32 v50, 16, v78
    v_and_b32 v51, 0xffff0000, v78
    v_add_f32 v48, v48, v50
    v_add_f32 v49, v49, v51
    v_lshlrev_b32 v52, 16, v79
    v_and_b32 v53, 0xffff0000, v79
    v_add_f32 v48, v48, v52
    v_add_f32 v49, v49, v53
    s_waitcnt vmcnt(7)
    s_barrier
    s_cmp_eq_u32 s38, 0
    s_cbranch_scc0 LNP7
    s_and_b32 s50, s2, 7
    s_lshl_b32 s50, s50, 10
    s_lshr_b32 s51, s2, 3
    s_lshl_b32 s51, s51, 5
    s_add_u32 s50, s50, s51
    s_add_u32 s50, s50, 14123008
    s_mov_b64 s[62:63], exec
    s_mov_b64 exec, 1
    buffer_store_dword v24, v25, s[28:31], s50 offen sc0 sc1
    s_mov_b64 exec, s[62:63]
LNP7:
    s_waitcnt lgkmcnt(6)
    v_mfma_f32_32x32x16_bf16 v[136:151], v[88:91], v[56:59], v[136:151]
    ds_read_b128 v[64:67], v42 offset:16384
    ds_read_b64_tr_b16 v[72:73], v30 offset:16384
    ds_read_b64_tr_b16 v[74:75], v30 offset:16896
    s_waitcnt lgkmcnt(7)
    v_mfma_f32_32x32x16_bf16 v[152:167], v[96:99], v[56:59], v[152:167]
    ds_read_b64_tr_b16 v[80:81], v33 offset:16384
    ds_read_b64_tr_b16 v[82:83], v33 offset:16896
    s_add_u32 m0, s47, 81920
    s_mov_b32 s42, 832
    buffer_load_dwordx4 v26, s[4:7], s42 offen lds
    s_waitcnt lgkmcnt(7)
    v_mfma_f32_32x32x16_bf16 v[136:151], v[92:95], v[60:63], v[136:151]
    ds_read_b128 v[68:71], v45 offset:16384
    ds_read_b64_tr_b16 v[76:77], v30 offset:18432
    ds_read_b64_tr_b16 v[78:79], v30 offset:18944
    s_waitcnt lgkmcnt(8)
    v_mfma_f32_32x32x16_bf16 v[152:167], v[100:103], v[60:63], v[152:167]
    ds_read_b64_tr_b16 v[84:85], v33 offset:18432
    ds_read_b64_tr_b16 v[86:87], v33 offset:18944
    s_waitcnt lgkmcnt(7)
    v_mfma_f32_32x32x16_bf16 v[104:119], v[72:75], v[64:67], v[104:119]
    ds_read_b64_tr_b16 v[88:89], v36 offset:16384
    ds_read_b64_tr_b16 v[90:91], v36 offset:16896
    v_lshlrev_b32 v50, 16, v72
    v_and_b32 v51, 0xffff0000, v72
    v_add_f32 v48, v48, v50
    v_add_f32 v49, v49, v51
    v_lshlrev_b32 v52, 16, v73
    v_and_b32 v53, 0xffff0000, v73
    v_add_f32 v48, v48, v52
    v_add_f32 v49, v49, v53
    s_waitcnt lgkmcnt(7)
    v_mfma_f32_32x32x16_bf16 v[120:135], v[80:83], v[64:67], v[120:135]
    ds_read_b64_tr_b16 v[96:97], v39 offset:16384
    ds_read_b64_tr_b16 v[98:99], v39 offset:16896
    v_lshlrev_b32 v50, 16, v74
    v_and_b32 v51, 0xffff0000, v74
    v_add_f32 v48, v48, v50
    v_add_f32 v49, v49, v51
    v_lshlrev_b32 v52, 16, v75
    v_and_b32 v53, 0xffff0000, v75
    v_add_f32 v48, v48, v52
    v_add_f32 v49, v49, v53
    s_add_u32 m0, s47, 90112
    s_mov_b32 s42, 1490944
    buffer_load_dwordx4 v27, s[76:79], s42 offen lds
    s_waitcnt lgkmcnt(6)
    v_mfma_f32_32x32x16_bf16 v[104:119], v[76:79], v[68:71], v[104:119]
    ds_read_b64_tr_b16 v[92:93], v36 offset:18432
    ds_read_b64_tr_b16 v[94:95], v36 offset:18944
    v_lshlrev_b32 v50, 16, v76
    v_and_b32 v51, 0xffff0000, v76
    v_add_f32 v48, v48, v50
    v_add_f32 v49, v49, v51
    v_lshlrev_b32 v52, 16, v77
    v_and_b32 v53, 0xffff0000, v77
    v_add_f32 v48, v48, v52
    v_add_f32 v49, v49, v53
    s_waitcnt lgkmcnt(6)
    v_mfma_f32_32x32x16_bf16 v[120:135], v[84:87], v[68:71], v[120:135]
    ds_read_b64_tr_b16 v[100:101], v39 offset:18432
    ds_read_b64_tr_b16 v[102:103], v39 offset:18944
    v_lshlrev_b32 v50, 16, v78
    v_and_b32 v51, 0xffff0000, v78
    v_add_f32 v48, v48, v50
    v_add_f32 v49, v49, v51
    v_lshlrev_b32 v52, 16, v79
    v_and_b32 v53, 0xffff0000, v79
    v_add_f32 v48, v48, v52
    v_add_f32 v49, v49, v53
    s_waitcnt vmcnt(7)
    s_barrier
    s_waitcnt lgkmcnt(6)
    v_mfma_f32_32x32x16_bf16 v[136:151], v[88:91], v[64:67], v[136:151]
    ds_read_b128 v[56:59], v43 offset:0
    ds_read_b64_tr_b16 v[72:73], v31 offset:0
    ds_read_b64_tr_b16 v[74:75], v31 offset:512
    s_waitcnt lgkmcnt(7)
    v_mfma_f32_32x32x16_bf16 v[152:167], v[96:99], v[64:67], v[152:167]
    ds_read_b64_tr_b16 v[80:81], v34 offset:0
    ds_read_b64_tr_b16 v[82:83], v34 offset:512
    s_add_u32 m0, s47, 98304
    s_mov_b32 s42, 896
    buffer_load_dwordx4 v26, s[4:7], s42 offen lds
    s_waitcnt lgkmcnt(7)
    v_mfma_f32_32x32x16_bf16 v[136:151], v[92:95], v[68:71], v[136:151]
    ds_read_b128 v[60:63], v46 offset:0
    ds_read_b64_tr_b16 v[76:77], v31 offset:2048
    ds_read_b64_tr_b16 v[78:79], v31 offset:2560
    s_waitcnt lgkmcnt(8)
    v_mfma_f32_32x32x16_bf16 v[152:167], v[100:103], v[68:71], v[152:167]
    ds_read_b64_tr_b16 v[84:85], v34 offset:2048
    ds_read_b64_tr_b16 v[86:87], v34 offset:2560
    s_waitcnt lgkmcnt(7)
    v_mfma_f32_32x32x16_bf16 v[104:119], v[72:75], v[56:59], v[104:119]
    ds_read_b64_tr_b16 v[88:89], v37 offset:0
    ds_read_b64_tr_b16 v[90:91], v37 offset:512
    v_lshlrev_b32 v50, 16, v72
    v_and_b32 v51, 0xffff0000, v72
    v_add_f32 v48, v48, v50
    v_add_f32 v49, v49, v51
    v_lshlrev_b32 v52, 16, v73
    v_and_b32 v53, 0xffff0000, v73
    v_add_f32 v48, v48, v52
    v_add_f32 v49, v49, v53
    s_waitcnt lgkmcnt(7)
    v_mfma_f32_32x32x16_bf16 v[120:135], v[80:83], v[56:59], v[120:135]
    ds_read_b64_tr_b16 v[96:97], v40 offset:0
    ds_read_b64_tr_b16 v[98:99], v40 offset:512
    v_lshlrev_b32 v50, 16, v74
    v_and_b32 v51, 0xffff0000, v74
    v_add_f32 v48, v48, v50
    v_add_f32 v49, v49, v51
    v_lshlrev_b32 v52, 16, v75
    v_and_b32 v53, 0xffff0000, v75
    v_add_f32 v48, v48, v52
    v_add_f32 v49, v49, v53
    s_add_u32 m0, s47, 106496
    s_mov_b32 s42, 1605632
    buffer_load_dwordx4 v27, s[76:79], s42 offen lds
    s_waitcnt lgkmcnt(6)
    v_mfma_f32_32x32x16_bf16 v[104:119], v[76:79], v[60:63], v[104:119]
    ds_read_b64_tr_b16 v[92:93], v37 offset:2048
    ds_read_b64_tr_b16 v[94:95], v37 offset:2560
    v_lshlrev_b32 v50, 16, v76
    v_and_b32 v51, 0xffff0000, v76
    v_add_f32 v48, v48, v50
    v_add_f32 v49, v49, v51
    v_lshlrev_b32 v52, 16, v77
    v_and_b32 v53, 0xffff0000, v77
    v_add_f32 v48, v48, v52
    v_add_f32 v49, v49, v53
    s_waitcnt lgkmcnt(6)
    v_mfma_f32_32x32x16_bf16 v[120:135], v[84:87], v[60:63], v[120:135]
    ds_read_b64_tr_b16 v[100:101], v40 offset:2048
    ds_read_b64_tr_b16 v[102:103], v40 offset:2560
    v_lshlrev_b32 v50, 16, v78
    v_and_b32 v51, 0xffff0000, v78
    v_add_f32 v48, v48, v50
    v_add_f32 v49, v49, v51
    v_lshlrev_b32 v52, 16, v79
    v_and_b32 v53, 0xffff0000, v79
    v_add_f32 v48, v48, v52
    v_add_f32 v49, v49, v53
    s_waitcnt vmcnt(6)
    s_barrier
    s_waitcnt lgkmcnt(6)
    v_mfma_f32_32x32x16_bf16 v[136:151], v[88:91], v[56:59], v[136:151]
    ds_read_b128 v[64:67], v43 offset:16384
    ds_read_b64_tr_b16 v[72:73], v31 offset:16384
    ds_read_b64_tr_b16 v[74:75], v31 offset:16896
    s_waitcnt lgkmcnt(7)
    v_mfma_f32_32x32x16_bf16 v[152:167], v[96:99], v[56:59], v[152:167]
    ds_read_b64_tr_b16 v[80:81], v34 offset:16384
    ds_read_b64_tr_b16 v[82:83], v34 offset:16896
    s_add_u32 m0, s47, 114688
    s_mov_b32 s42, 960
    buffer_load_dwordx4 v26, s[4:7], s42 offen lds
    s_waitcnt lgkmcnt(7)
    v_mfma_f32_32x32x16_bf16 v[136:151], v[92:95], v[60:63], v[136:151]
    ds_read_b128 v[68:71], v46 offset:16384
    ds_read_b64_tr_b16 v[76:77], v31 offset:18432
    ds_read_b64_tr_b16 v[78:79], v31 offset:18944
    s_waitcnt lgkmcnt(8)
    v_mfma_f32_32x32x16_bf16 v[152:167], v[100:103], v[60:63], v[152:167]
    ds_read_b64_tr_b16 v[84:85], v34 offset:18432
    ds_read_b64_tr_b16 v[86:87], v34 offset:18944
    s_lshr_b32 s57, s2, 3
    s_lshl_b32 s57, s57, 3
    s_add_u32 s57, s57, s38
    s_lshl_b32 s57, s57, 13
    v_lshlrev_b32 v181, 7, v1
    buffer_load_dword v182, v181, s[16:19], s57 offen
    s_waitcnt lgkmcnt(7)
    v_mfma_f32_32x32x16_bf16 v[104:119], v[72:75], v[64:67], v[104:119]
    ds_read_b64_tr_b16 v[88:89], v37 offset:16384
    ds_read_b64_tr_b16 v[90:91], v37 offset:16896
    v_lshlrev_b32 v50, 16, v72
    v_and_b32 v51, 0xffff0000, v72
    v_add_f32 v48, v48, v50
    v_add_f32 v49, v49, v51
    v_lshlrev_b32 v52, 16, v73
    v_and_b32 v53, 0xffff0000, v73
    v_add_f32 v48, v48, v52
    v_add_f32 v49, v49, v53
    s_waitcnt lgkmcnt(7)
    v_mfma_f32_32x32x16_bf16 v[120:135], v[80:83], v[64:67], v[120:135]
    ds_read_b64_tr_b16 v[96:97], v40 offset:16384
    ds_read_b64_tr_b16 v[98:99], v40 offset:16896
    v_lshlrev_b32 v50, 16, v74
    v_and_b32 v51, 0xffff0000, v74
    v_add_f32 v48, v48, v50
    v_add_f32 v49, v49, v51
    v_lshlrev_b32 v52, 16, v75
    v_and_b32 v53, 0xffff0000, v75
    v_add_f32 v48, v48, v52
    v_add_f32 v49, v49, v53
    s_add_u32 m0, s47, 122880
    s_mov_b32 s42, 1720320
    buffer_load_dwordx4 v27, s[76:79], s42 offen lds
    s_waitcnt lgkmcnt(6)
    v_mfma_f32_32x32x16_bf16 v[104:119], v[76:79], v[68:71], v[104:119]
    ds_read_b64_tr_b16 v[92:93], v37 offset:18432
    ds_read_b64_tr_b16 v[94:95], v37 offset:18944
    v_lshlrev_b32 v50, 16, v76
    v_and_b32 v51, 0xffff0000, v76
    v_add_f32 v48, v48, v50
    v_add_f32 v49, v49, v51
    v_lshlrev_b32 v52, 16, v77
    v_and_b32 v53, 0xffff0000, v77
    v_add_f32 v48, v48, v52
    v_add_f32 v49, v49, v53
    s_waitcnt lgkmcnt(6)
    v_mfma_f32_32x32x16_bf16 v[120:135], v[84:87], v[68:71], v[120:135]
    ds_read_b64_tr_b16 v[100:101], v40 offset:18432
    ds_read_b64_tr_b16 v[102:103], v40 offset:18944
    v_lshlrev_b32 v50, 16, v78
    v_and_b32 v51, 0xffff0000, v78
    v_add_f32 v48, v48, v50
    v_add_f32 v49, v49, v51
    v_lshlrev_b32 v52, 16, v79
    v_and_b32 v53, 0xffff0000, v79
    v_add_f32 v48, v48, v52
    v_add_f32 v49, v49, v53
    s_waitcnt vmcnt(7)
    s_barrier
    s_waitcnt lgkmcnt(6)
    v_mfma_f32_32x32x16_bf16 v[136:151], v[88:91], v[64:67], v[136:151]
    ds_read_b128 v[56:59], v41 offset:0
    ds_read_b64_tr_b16 v[72:73], v29 offset:0
    ds_read_b64_tr_b16 v[74:75], v29 offset:512
    s_waitcnt lgkmcnt(7)
    v_mfma_f32_32x32x16_bf16 v[152:167], v[96:99], v[64:67], v[152:167]
    ds_read_b64_tr_b16 v[80:81], v32 offset:0
    ds_read_b64_tr_b16 v[82:83], v32 offset:512
    s_waitcnt lgkmcnt(7)
    v_mfma_f32_32x32x16_bf16 v[136:151], v[92:95], v[68:71], v[136:151]
    ds_read_b128 v[60:63], v44 offset:0
    ds_read_b64_tr_b16 v[76:77], v29 offset:2048
    ds_read_b64_tr_b16 v[78:79], v29 offset:2560
    s_waitcnt lgkmcnt(8)
    v_mfma_f32_32x32x16_bf16 v[152:167], v[100:103], v[68:71], v[152:167]
    ds_read_b64_tr_b16 v[84:85], v32 offset:2048
    ds_read_b64_tr_b16 v[86:87], v32 offset:2560
    s_waitcnt lgkmcnt(7)
    v_mfma_f32_32x32x16_bf16 v[104:119], v[72:75], v[56:59], v[104:119]
    ds_read_b64_tr_b16 v[88:89], v35 offset:0
    ds_read_b64_tr_b16 v[90:91], v35 offset:512
    v_lshlrev_b32 v50, 16, v72
    v_and_b32 v51, 0xffff0000, v72
    v_add_f32 v48, v48, v50
    v_add_f32 v49, v49, v51
    v_lshlrev_b32 v52, 16, v73
    v_and_b32 v53, 0xffff0000, v73
    v_add_f32 v48, v48, v52
    v_add_f32 v49, v49, v53
    s_waitcnt lgkmcnt(7)
    v_mfma_f32_32x32x16_bf16 v[120:135], v[80:83], v[56:59], v[120:135]
    ds_read_b64_tr_b16 v[96:97], v38 offset:0
    ds_read_b64_tr_b16 v[98:99], v38 offset:512
    v_lshlrev_b32 v50, 16, v74
    v_and_b32 v51, 0xffff0000, v74
    v_add_f32 v48, v48, v50
    v_add_f32 v49, v49, v51
    v_lshlrev_b32 v52, 16, v75
    v_and_b32 v53, 0xffff0000, v75
    v_add_f32 v48, v48, v52
    v_add_f32 v49, v49, v53
    s_waitcnt lgkmcnt(6)
    v_mfma_f32_32x32x16_bf16 v[104:119], v[76:79], v[60:63], v[104:119]
    ds_read_b64_tr_b16 v[92:93], v35 offset:2048
    ds_read_b64_tr_b16 v[94:95], v35 offset:2560
    v_lshlrev_b32 v50, 16, v76
    v_and_b32 v51, 0xffff0000, v76
    v_add_f32 v48, v48, v50
    v_add_f32 v49, v49, v51
    v_lshlrev_b32 v52, 16, v77
    v_and_b32 v53, 0xffff0000, v77
    v_add_f32 v48, v48, v52
    v_add_f32 v49, v49, v53
    s_waitcnt lgkmcnt(6)
    v_mfma_f32_32x32x16_bf16 v[120:135], v[84:87], v[60:63], v[120:135]
    ds_read_b64_tr_b16 v[100:101], v38 offset:2048
    ds_read_b64_tr_b16 v[102:103], v38 offset:2560
    v_lshlrev_b32 v50, 16, v78
    v_and_b32 v51, 0xffff0000, v78
    v_add_f32 v48, v48, v50
    v_add_f32 v49, v49, v51
    v_lshlrev_b32 v52, 16, v79
    v_and_b32 v53, 0xffff0000, v79
    v_add_f32 v48, v48, v52
    v_add_f32 v49, v49, v53
    s_waitcnt vmcnt(5)
    s_barrier
    s_waitcnt lgkmcnt(6)
    v_mfma_f32_32x32x16_bf16 v[136:151], v[88:91], v[56:59], v[136:151]
    ds_read_b128 v[64:67], v41 offset:16384
    ds_read_b64_tr_b16 v[72:73], v29 offset:16384
    ds_read_b64_tr_b16 v[74:75], v29 offset:16896
    s_waitcnt lgkmcnt(7)
    v_mfma_f32_32x32x16_bf16 v[152:167], v[96:99], v[56:59], v[152:167]
    ds_read_b64_tr_b16 v[80:81], v32 offset:16384
    ds_read_b64_tr_b16 v[82:83], v32 offset:16896
    s_waitcnt lgkmcnt(7)
    v_mfma_f32_32x32x16_bf16 v[136:151], v[92:95], v[60:63], v[136:151]
    ds_read_b128 v[68:71], v44 offset:16384
    ds_read_b64_tr_b16 v[76:77], v29 offset:18432
    ds_read_b64_tr_b16 v[78:79], v29 offset:18944
    s_waitcnt lgkmcnt(8)
    v_mfma_f32_32x32x16_bf16 v[152:167], v[100:103], v[60:63], v[152:167]
    ds_read_b64_tr_b16 v[84:85], v32 offset:18432
    ds_read_b64_tr_b16 v[86:87], v32 offset:18944
    s_waitcnt lgkmcnt(7)
    v_mfma_f32_32x32x16_bf16 v[104:119], v[72:75], v[64:67], v[104:119]
    ds_read_b64_tr_b16 v[88:89], v35 offset:16384
    ds_read_b64_tr_b16 v[90:91], v35 offset:16896
    v_lshlrev_b32 v50, 16, v72
    v_and_b32 v51, 0xffff0000, v72
    v_add_f32 v48, v48, v50
    v_add_f32 v49, v49, v51
    v_lshlrev_b32 v52, 16, v73
    v_and_b32 v53, 0xffff0000, v73
    v_add_f32 v48, v48, v52
    v_add_f32 v49, v49, v53
    s_waitcnt lgkmcnt(7)
    v_mfma_f32_32x32x16_bf16 v[120:135], v[80:83], v[64:67], v[120:135]
    ds_read_b64_tr_b16 v[96:97], v38 offset:16384
    ds_read_b64_tr_b16 v[98:99], v38 offset:16896
    v_lshlrev_b32 v50, 16, v74
    v_and_b32 v51, 0xffff0000, v74
    v_add_f32 v48, v48, v50
    v_add_f32 v49, v49, v51
    v_lshlrev_b32 v52, 16, v75
    v_and_b32 v53, 0xffff0000, v75
    v_add_f32 v48, v48, v52
    v_add_f32 v49, v49, v53
    s_waitcnt lgkmcnt(6)
    v_mfma_f32_32x32x16_bf16 v[104:119], v[76:79], v[68:71], v[104:119]
    ds_read_b64_tr_b16 v[92:93], v35 offset:18432
    ds_read_b64_tr_b16 v[94:95], v35 offset:18944
    v_lshlrev_b32 v50, 16, v76
    v_and_b32 v51, 0xffff0000, v76
    v_add_f32 v48, v48, v50
    v_add_f32 v49, v49, v51
    v_lshlrev_b32 v52, 16, v77
    v_and_b32 v53, 0xffff0000, v77
    v_add_f32 v48, v48, v52
    v_add_f32 v49, v49, v53
    s_waitcnt lgkmcnt(6)
    v_mfma_f32_32x32x16_bf16 v[120:135], v[84:87], v[68:71], v[120:135]
    ds_read_b64_tr_b16 v[100:101], v38 offset:18432
    ds_read_b64_tr_b16 v[102:103], v38 offset:18944
    v_lshlrev_b32 v50, 16, v78
    v_and_b32 v51, 0xffff0000, v78
    v_add_f32 v48, v48, v50
    v_add_f32 v49, v49, v51
    v_lshlrev_b32 v52, 16, v79
    v_and_b32 v53, 0xffff0000, v79
    v_add_f32 v48, v48, v52
    v_add_f32 v49, v49, v53
    s_waitcnt vmcnt(3)
    s_barrier
    s_cmp_eq_u32 s38, 0
    s_cbranch_scc0 LZC8
    v_mov_b32 v12, 0
    v_mov_b32 v13, 0
    v_mov_b32 v14, 0
    v_mov_b32 v15, 0
    v_mov_b32 v10, 18432
    ds_write_b128 v10, v[12:15]
    ds_write_b128 v10, v[12:15] offset:16
    ds_write_b128 v10, v[12:15] offset:32
    s_waitcnt lgkmcnt(0)
LZC8:
    v_lshlrev_b32 v230, 5, v4
    s_lshl_b32 s50, s36, 9
    s_add_u32 s50, s50, 14123008
    v_add_u32 v230, s50, v230
    s_mov_b64 s[62:63], exec
    s_mov_b32 exec_lo, 0xffff
    s_mov_b32 exec_hi, 0
    buffer_load_dword v231, v230, s[28:31], 0 offen sc0 sc1
    s_mov_b64 exec, s[62:63]
    s_waitcnt lgkmcnt(6)
    v_mfma_f32_32x32x16_bf16 v[136:151], v[88:91], v[64:67], v[136:151]
    ds_read_b128 v[56:59], v42 offset:0
    ds_read_b64_tr_b16 v[72:73], v30 offset:0
    ds_read_b64_tr_b16 v[74:75], v30 offset:512
    s_waitcnt lgkmcnt(7)
    v_mfma_f32_32x32x16_bf16 v[152:167], v[96:99], v[64:67], v[152:167]
    ds_read_b64_tr_b16 v[80:81], v33 offset:0
    ds_read_b64_tr_b16 v[82:83], v33 offset:512
    s_waitcnt lgkmcnt(7)
    v_mfma_f32_32x32x16_bf16 v[136:151], v[92:95], v[68:71], v[136:151]
    ds_read_b128 v[60:63], v45 offset:0
    ds_read_b64_tr_b16 v[76:77], v30 offset:2048
    ds_read_b64_tr_b16 v[78:79], v30 offset:2560
    s_waitcnt lgkmcnt(8)
    v_mfma_f32_32x32x16_bf16 v[152:167], v[100:103], v[68:71], v[152:167]
    ds_read_b64_tr_b16 v[84:85], v33 offset:2048
    ds_read_b64_tr_b16 v[86:87], v33 offset:2560
    s_waitcnt lgkmcnt(7)
    v_mfma_f32_32x32x16_bf16 v[104:119], v[72:75], v[56:59], v[104:119]
    ds_read_b64_tr_b16 v[88:89], v36 offset:0
    ds_read_b64_tr_b16 v[90:91], v36 offset:512
    v_lshlrev_b32 v50, 16, v72
    v_and_b32 v51, 0xffff0000, v72
    v_add_f32 v48, v48, v50
    v_add_f32 v49, v49, v51
    v_lshlrev_b32 v52, 16, v73
    v_and_b32 v53, 0xffff0000, v73
    v_add_f32 v48, v48, v52
    v_add_f32 v49, v49, v53
    s_waitcnt lgkmcnt(7)
    v_mfma_f32_32x32x16_bf16 v[120:135], v[80:83], v[56:59], v[120:135]
    ds_read_b64_tr_b16 v[96:97], v39 offset:0
    ds_read_b64_tr_b16 v[98:99], v39 offset:512
    v_lshlrev_b32 v50, 16, v74
    v_and_b32 v51, 0xffff0000, v74
    v_add_f32 v48, v48, v50
    v_add_f32 v49, v49, v51
    v_lshlrev_b32 v52, 16, v75
    v_and_b32 v53, 0xffff0000, v75
    v_add_f32 v48, v48, v52
    v_add_f32 v49, v49, v53
    s_waitcnt lgkmcnt(6)
    v_mfma_f32_32x32x16_bf16 v[104:119], v[76:79], v[60:63], v[104:119]
    ds_read_b64_tr_b16 v[92:93], v36 offset:2048
    ds_read_b64_tr_b16 v[94:95], v36 offset:2560
    v_lshlrev_b32 v50, 16, v76
    v_and_b32 v51, 0xffff0000, v76
    v_add_f32 v48, v48, v50
    v_add_f32 v49, v49, v51
    v_lshlrev_b32 v52, 16, v77
    v_and_b32 v53, 0xffff0000, v77
    v_add_f32 v48, v48, v52
    v_add_f32 v49, v49, v53
    s_waitcnt lgkmcnt(6)
    v_mfma_f32_32x32x16_bf16 v[120:135], v[84:87], v[60:63], v[120:135]
    ds_read_b64_tr_b16 v[100:101], v39 offset:2048
    ds_read_b64_tr_b16 v[102:103], v39 offset:2560
    v_lshlrev_b32 v50, 16, v78
    v_and_b32 v51, 0xffff0000, v78
    v_add_f32 v48, v48, v50
    v_add_f32 v49, v49, v51
    v_lshlrev_b32 v52, 16, v79
    v_and_b32 v53, 0xffff0000, v79
    v_add_f32 v48, v48, v52
    v_add_f32 v49, v49, v53
    s_waitcnt vmcnt(1)
    s_barrier
    s_waitcnt vmcnt(0)
    s_mov_b64 s[62:63], exec
    s_mov_b32 exec_lo, 0xffff
    s_mov_b32 exec_hi, 0
    v_cmp_ne_u32 vcc, s49, v231
    s_mov_b64 exec, s[62:63]
    s_cmp_eq_u64 vcc, 0
    s_cbranch_scc1 LEP9
    s_mov_b32 s50, 0
    s_mov_b32 s57, 0
    s_mov_b64 s[62:63], exec
    s_mov_b32 exec_lo, 0xffff
    s_mov_b32 exec_hi, 0
LP10:
    buffer_load_dword v231, v230, s[28:31], s50 offen sc0 sc1
    s_waitcnt vmcnt(0)
    v_cmp_ne_u32 vcc, s49, v231
    s_nop 0
    s_cmp_eq_u64 vcc, 0
    s_cbranch_scc1 LP10D
    s_add_u32 s57, s57, 1
    s_cmp_lt_u32 s57, 20000
    s_cbranch_scc0 LP10D
    s_sleep 1
    s_branch LP10
LP10D:
    s_mov_b64 exec, s[62:63]
LEP9:
    s_lshl_b32 s53, s36, 1
    s_lshr_b32 s51, s39, 1
    s_add_u32 s53, s53, s51
    s_lshl_b32 s53, s53, 9
    s_and_b32 s51, s39, 1
    s_lshl_b32 s51, s51, 8
    s_add_u32 s53, s53, s51
    s_add_u32 s53, s53, 14024704
    v_lshlrev_b32 v8, 3, v2
    buffer_load_dwordx2 v[184:185], v8, s[28:31], s53 offen sc1
    s_waitcnt lgkmcnt(6)
    v_mfma_f32_32x32x16_bf16 v[136:151], v[88:91], v[56:59], v[136:151]
    ds_read_b128 v[64:67], v42 offset:16384
    ds_read_b64_tr_b16 v[72:73], v30 offset:16384
    ds_read_b64_tr_b16 v[74:75], v30 offset:16896
    s_waitcnt lgkmcnt(7)
    v_mfma_f32_32x32x16_bf16 v[152:167], v[96:99], v[56:59], v[152:167]
    ds_read_b64_tr_b16 v[80:81], v33 offset:16384
    ds_read_b64_tr_b16 v[82:83], v33 offset:16896
    s_waitcnt lgkmcnt(7)
    v_mfma_f32_32x32x16_bf16 v[136:151], v[92:95], v[60:63], v[136:151]
    ds_read_b128 v[68:71], v45 offset:16384
    ds_read_b64_tr_b16 v[76:77], v30 offset:18432
    ds_read_b64_tr_b16 v[78:79], v30 offset:18944
    s_waitcnt lgkmcnt(8)
    v_mfma_f32_32x32x16_bf16 v[152:167], v[100:103], v[60:63], v[152:167]
    ds_read_b64_tr_b16 v[84:85], v33 offset:18432
    ds_read_b64_tr_b16 v[86:87], v33 offset:18944
    s_waitcnt lgkmcnt(7)
    v_mfma_f32_32x32x16_bf16 v[104:119], v[72:75], v[64:67], v[104:119]
    ds_read_b64_tr_b16 v[88:89], v36 offset:16384
    ds_read_b64_tr_b16 v[90:91], v36 offset:16896
    v_lshlrev_b32 v50, 16, v72
    v_and_b32 v51, 0xffff0000, v72
    v_add_f32 v48, v48, v50
    v_add_f32 v49, v49, v51
    v_lshlrev_b32 v52, 16, v73
    v_and_b32 v53, 0xffff0000, v73
    v_add_f32 v48, v48, v52
    v_add_f32 v49, v49, v53
    s_waitcnt lgkmcnt(7)
    v_mfma_f32_32x32x16_bf16 v[120:135], v[80:83], v[64:67], v[120:135]
    ds_read_b64_tr_b16 v[96:97], v39 offset:16384
    ds_read_b64_tr_b16 v[98:99], v39 offset:16896
    v_lshlrev_b32 v50, 16, v74
    v_and_b32 v51, 0xffff0000, v74
    v_add_f32 v48, v48, v50
    v_add_f32 v49, v49, v51
    v_lshlrev_b32 v52, 16, v75
    v_and_b32 v53, 0xffff0000, v75
    v_add_f32 v48, v48, v52
    v_add_f32 v49, v49, v53
    s_waitcnt lgkmcnt(6)
    v_mfma_f32_32x32x16_bf16 v[104:119], v[76:79], v[68:71], v[104:119]
    ds_read_b64_tr_b16 v[92:93], v36 offset:18432
    ds_read_b64_tr_b16 v[94:95], v36 offset:18944
    v_lshlrev_b32 v50, 16, v76
    v_and_b32 v51, 0xffff0000, v76
    v_add_f32 v48, v48, v50
    v_add_f32 v49, v49, v51
    v_lshlrev_b32 v52, 16, v77
    v_and_b32 v53, 0xffff0000, v77
    v_add_f32 v48, v48, v52
    v_add_f32 v49, v49, v53
    s_waitcnt lgkmcnt(6)
    v_mfma_f32_32x32x16_bf16 v[120:135], v[84:87], v[68:71], v[120:135]
    ds_read_b64_tr_b16 v[100:101], v39 offset:18432
    ds_read_b64_tr_b16 v[102:103], v39 offset:18944
    v_lshlrev_b32 v50, 16, v78
    v_and_b32 v51, 0xffff0000, v78
    v_add_f32 v48, v48, v50
    v_add_f32 v49, v49, v51
    v_lshlrev_b32 v52, 16, v79
    v_and_b32 v53, 0xffff0000, v79
    v_add_f32 v48, v48, v52
    v_add_f32 v49, v49, v53
    s_waitcnt lgkmcnt(6)
    v_mfma_f32_32x32x16_bf16 v[136:151], v[88:91], v[64:67], v[136:151]
    s_waitcnt lgkmcnt(4)
    v_mfma_f32_32x32x16_bf16 v[152:167], v[96:99], v[64:67], v[152:167]
    s_waitcnt lgkmcnt(2)
    v_mfma_f32_32x32x16_bf16 v[136:151], v[92:95], v[68:71], v[136:151]
    s_waitcnt lgkmcnt(0)
    v_mfma_f32_32x32x16_bf16 v[152:167], v[100:103], v[68:71], v[152:167]
    s_nop 11
    s_branch L_EPI
L_MBF:
    s_add_u32 m0, s47, 98304
    s_mov_b32 s42, 128
    buffer_load_dwordx4 v26, s[4:7], s42 offen lds
    s_add_u32 m0, s47, 106496
    s_mov_b32 s42, 229376
    buffer_load_dwordx4 v27, s[76:79], s42 offen lds
    s_add_u32 m0, s47, 114688
    s_mov_b32 s42, 192
    buffer_load_dwordx4 v26, s[4:7], s42 offen lds
    s_add_u32 m0, s47, 122880
    s_mov_b32 s42, 344064
    buffer_load_dwordx4 v27, s[76:79], s42 offen lds
    s_add_u32 m0, s47, 131072
    s_mov_b32 s42, 256
    buffer_load_dwordx4 v26, s[4:7], s42 offen lds
    s_add_u32 m0, s47, 139264
    s_mov_b32 s42, 458752
    buffer_load_dwordx4 v27, s[76:79], s42 offen lds
    s_lshr_b32 s46, s2, 3
    s_and_b32 s44, s46, 7
    s_lshl_b32 s44, s44, 3
    s_add_u32 s44, s44, s38
    s_and_b32 s45, s2, 7
    s_lshl_b32 s45, s45, 2
    s_lshr_b32 s46, s46, 3
    s_add_u32 s45, s45, s46
    s_lshl_b32 s43, s45, 6
    s_add_u32 s43, s43, s44
    s_lshl_b32 s44, s44, 15
    s_lshl_b32 s45, s45, 10
    s_add_u32 s44, s44, s45
    buffer_load_dwordx4 v[176:179], v6, s[4:7], s44 offen
    s_lshr_b32 s44, s2, 4
    s_lshl_b32 s44, s44, 4
    v_add_u32 v186, s44, v4
    v_lshrrev_b32 v190, 2, v1
    v_add_u32 v190, s44, v190
    s_and_b32 s45, s2, 7
    s_lshl_b32 s45, s45, 1
    s_bfe_u32 s46, s2, 0x10003
    s_add_u32 s45, s45, s46
    s_lshr_b32 s46, s45, 2
    s_and_b32 s48, s45, 3
    s_lshl_b32 s48, s48, 1
    s_add_u32 s48, s48, s40
    s_lshl_b32 s41, s48, 8
    s_lshl_b32 s73, s46, 4
    s_add_u32 s41, s41, s73
    s_lshl_b32 s73, s39, 2
    s_add_u32 s41, s41, s73
    v_add_u32 v187, s41, v5
    s_movk_i32 s73, 257
    v_mul_lo_u32 v187, v187, s73
    v_cmp_eq_u32 vcc, 0, v186
    v_mov_b32 v188, 256
    s_nop 0
    v_cndmask_b32 v188, v186, v188, vcc
    v_add_lshl_u32 v181, v187, v188, 1
    s_lshl_b32 s46, s46, 7
    s_lshl_b32 s48, s48, 4
    s_add_u32 s46, s46, s48
    s_lshl_b32 s73, s39, 2
    s_add_u32 s46, s46, s73
    v_and_b32 v188, 3, v1
    v_add_u32 v188, s46, v188
    v_lshlrev_b32 v188, 4, v188
    s_movk_i32 s73, 8448
    v_mad_u32_u24 v180, v190, s73, v188
    s_mov_b32 s57, 0
    buffer_load_ushort v168, v181, s[20:23], s57 offen
    s_mov_b32 s57, 0
    buffer_load_ushort v172, v181, s[24:27], s57 offen
    s_mov_b32 s57, 32896
    buffer_load_ushort v169, v181, s[20:23], s57 offen
    s_mov_b32 s57, 32896
    buffer_load_ushort v173, v181, s[24:27], s57 offen
    s_mov_b32 s57, 65792
    buffer_load_ushort v170, v181, s[20:23], s57 offen
    s_mov_b32 s57, 65792
    buffer_load_ushort v174, v181, s[24:27], s57 offen
    s_mov_b32 s57, 98688
    buffer_load_ushort v171, v181, s[20:23], s57 offen
    s_mov_b32 s57, 98688
    buffer_load_ushort v175, v181, s[24:27], s57 offen
    s_waitcnt vmcnt(17)
    s_barrier
    ds_read_b128 v[56:59], v41 offset:0
    ds_read_b128 v[72:75], v6 offset:0
    ds_read_b128 v[80:83], v6 offset:1024
    ds_read_b128 v[60:63], v44 offset:0
    ds_read_b128 v[76:79], v6 offset:4096
    ds_read_b128 v[84:87], v6 offset:5120
    s_and_b32 s50, s2, 7
    s_lshr_b32 s51, s2, 3
    s_lshl_b32 s53, s51, 3
    s_add_u32 s53, s53, s38
    s_cmp_lt_u32 s53, 128
    s_cbranch_scc0 LPF11W
    s_and_b32 s54, s53, 15
    s_lshl_b32 s54, s54, 2
    v_add_u32 v14, s54, v5
    v_lshlrev_b32 v14, 15, v14
    v_lshl_add_u32 v14, v4, 10, v14
    s_and_b32 s54, s50, 1
    s_lshl_b32 s54, s54, 14
    s_lshr_b32 s53, s53, 4
    s_cmp_lt_u32 s53, 3
    s_cselect_b32 s55, 0x10000000, 0
    s_lshl_b32 s53, s53, 7
    s_add_u32 s54, s54, s53
    s_add_u32 s54, s54, s55
    buffer_load_dword v182, v14, s[4:7], s54 offen
    s_branch LPF11D
LPF11W:
    s_sub_u32 s53, s53, 128
    s_and_b32 s54, s53, 63
    s_cmp_lt_u32 s54, 24
    s_cselect_b32 s55, 0x10000000, 0
    s_lshl_b32 s54, s54, 3
    v_lshrrev_b32 v14, 3, v1
    v_add_u32 v14, s54, v14
    s_movk_i32 s54, 3584
    v_mul_lo_u32 v14, v14, s54
    v_and_b32 v15, 7, v1
    v_lshl_add_u32 v14, v15, 7, v14
    s_lshr_b32 s54, s50, 1
    s_mul_i32 s54, s54, 896
    s_add_u32 s54, s54, s55
    s_cmp_lt_u32 s53, 64
    s_cbranch_scc0 LPF11U
    buffer_load_dword v182, v14, s[8:11], s54 offen
    s_branch LPF11D
LPF11U:
    buffer_load_dword v182, v14, s[12:15], s54 offen
LPF11D:
    s_waitcnt lgkmcnt(4)
    v_mfma_f32_32x32x16_bf16 v[104:119], v[56:59], v[72:75], 0
    ds_read_b128 v[88:91], v6 offset:2048
    s_waitcnt lgkmcnt(4)
    v_mfma_f32_32x32x16_bf16 v[120:135], v[56:59], v[80:83], 0
    ds_read_b128 v[96:99], v6 offset:3072
    s_waitcnt lgkmcnt(3)
    v_mfma_f32_32x32x16_bf16 v[104:119], v[60:63], v[76:79], v[104:119]
    ds_read_b128 v[92:95], v6 offset:6144
    s_waitcnt lgkmcnt(3)
    v_mfma_f32_32x32x16_bf16 v[120:135], v[60:63], v[84:87], v[120:135]
    ds_read_b128 v[100:103], v6 offset:7168
    s_waitcnt vmcnt(16)
    s_barrier
    s_waitcnt lgkmcnt(3)
    v_mfma_f32_32x32x16_bf16 v[136:151], v[56:59], v[88:91], 0
    ds_read_b128 v[64:67], v41 offset:16384
    ds_read_b128 v[72:75], v6 offset:8192
    s_waitcnt lgkmcnt(4)
    v_mfma_f32_32x32x16_bf16 v[152:167], v[56:59], v[96:99], 0
    ds_read_b128 v[80:83], v6 offset:9216
    s_add_u32 m0, s47, 147456
    s_mov_b32 s42, 320
    buffer_load_dwordx4 v26, s[4:7], s42 offen lds
    s_waitcnt lgkmcnt(4)
    v_mfma_f32_32x32x16_bf16 v[136:151], v[60:63], v[92:95], v[136:151]
    ds_read_b128 v[68:71], v44 offset:16384
    ds_read_b128 v[76:79], v6 offset:12288
    s_waitcnt lgkmcnt(5)
    v_mfma_f32_32x32x16_bf16 v[152:167], v[60:63], v[100:103], v[152:167]
    ds_read_b128 v[84:87], v6 offset:13312
    s_waitcnt lgkmcnt(4)
    v_mfma_f32_32x32x16_bf16 v[104:119], v[64:67], v[72:75], v[104:119]
    ds_read_b128 v[88:91], v6 offset:10240
    s_waitcnt lgkmcnt(4)
    v_mfma_f32_32x32x16_bf16 v[120:135], v[64:67], v[80:83], v[120:135]
    ds_read_b128 v[96:99], v6 offset:11264
    s_add_u32 m0, s47, 155648
    s_mov_b32 s42, 573440
    buffer_load_dwordx4 v27, s[76:79], s42 offen lds
    s_waitcnt lgkmcnt(3)
    v_mfma_f32_32x32x16_bf16 v[104:119], v[68:71], v[76:79], v[104:119]
    ds_read_b128 v[92:95], v6 offset:14336
    s_waitcnt lgkmcnt(3)
    v_mfma_f32_32x32x16_bf16 v[120:135], v[68:71], v[84:87], v[120:135]
    ds_read_b128 v[100:103], v6 offset:15360
    s_waitcnt vmcnt(16)
    s_barrier
    s_waitcnt lgkmcnt(3)
    v_mfma_f32_32x32x16_bf16 v[136:151], v[64:67], v[88:91], v[136:151]
    ds_read_b128 v[56:59], v42 offset:0
    ds_read_b128 v[72:75], v6 offset:16384
    s_waitcnt vmcnt(11)
    v_lshlrev_b32 v186, 16, v176
    v_and_b32 v187, 0xffff0000, v176
    s_waitcnt lgkmcnt(4)
    v_mfma_f32_32x32x16_bf16 v[152:167], v[64:67], v[96:99], v[152:167]
    ds_read_b128 v[80:83], v6 offset:17408
    v_lshlrev_b32 v188, 16, v177
    v_and_b32 v189, 0xffff0000, v177
    s_add_u32 m0, s47, 65536
    s_mov_b32 s42, 384
    buffer_load_dwordx4 v26, s[4:7], s42 offen lds
    s_waitcnt lgkmcnt(4)
    v_mfma_f32_32x32x16_bf16 v[136:151], v[68:71], v[92:95], v[136:151]
    ds_read_b128 v[60:63], v45 offset:0
    ds_read_b128 v[76:79], v6 offset:20480
    v_lshlrev_b32 v190, 16, v178
    v_and_b32 v191, 0xffff0000, v178
    s_waitcnt lgkmcnt(5)
    v_mfma_f32_32x32x16_bf16 v[152:167], v[68:71], v[100:103], v[152:167]
    ds_read_b128 v[84:87], v6 offset:21504
    v_lshlrev_b32 v192, 16, v179
    v_and_b32 v193, 0xffff0000, v179
    s_waitcnt lgkmcnt(4)
    v_mfma_f32_32x32x16_bf16 v[104:119], v[56:59], v[72:75], v[104:119]
    ds_read_b128 v[88:91], v6 offset:18432
    v_add_f32 v176, v186, v187
    v_mul_f32 v177, v186, v186
    s_waitcnt lgkmcnt(4)
    v_mfma_f32_32x32x16_bf16 v[120:135], v[56:59], v[80:83], v[120:135]
    ds_read_b128 v[96:99], v6 offset:19456
    v_fma_f32 v177, v187, v187, v177
    v_add_f32 v176, v176, v188
    s_add_u32 m0, s47, 73728
    s_mov_b32 s42, 688128
    buffer_load_dwordx4 v27, s[76:79], s42 offen lds
    s_waitcnt lgkmcnt(3)
    v_mfma_f32_32x32x16_bf16 v[104:119], v[60:63], v[76:79], v[104:119]
    ds_read_b128 v[92:95], v6 offset:22528
    v_fma_f32 v177, v188, v188, v177
    v_add_f32 v176, v176, v189
    s_waitcnt lgkmcnt(3)
    v_mfma_f32_32x32x16_bf16 v[120:135], v[60:63], v[84:87], v[120:135]
    ds_read_b128 v[100:103], v6 offset:23552
    v_fma_f32 v177, v189, v189, v177
    v_add_f32 v176, v176, v190
    s_barrier
    s_waitcnt lgkmcnt(3)
    v_mfma_f32_32x32x16_bf16 v[136:151], v[56:59], v[88:91], v[136:151]
    ds_read_b128 v[64:67], v42 offset:16384
    ds_read_b128 v[72:75], v6 offset:24576
    v_fma_f32 v177, v190, v190, v177
    v_add_f32 v176, v176, v191
    s_waitcnt lgkmcnt(4)
    v_mfma_f32_32x32x16_bf16 v[152:167], v[56:59], v[96:99], v[152:167]
    ds_read_b128 v[80:83], v6 offset:25600
    v_fma_f32 v177, v191, v191, v177
    v_add_f32 v176, v176, v192
    s_add_u32 m0, s47, 81920
    s_mov_b32 s42, 448
    buffer_load_dwordx4 v26, s[4:7], s42 offen lds
    s_waitcnt lgkmcnt(4)
    v_mfma_f32_32x32x16_bf16 v[136:151], v[60:63], v[92:95], v[136:151]
    ds_read_b128 v[68:71], v45 offset:16384
    ds_read_b128 v[76:79], v6 offset:28672
    v_fma_f32 v177, v192, v192, v177
    v_add_f32 v176, v176, v193
    s_waitcnt lgkmcnt(5)
    v_mfma_f32_32x32x16_bf16 v[152:167], v[60:63], v[100:103], v[152:167]
    ds_read_b128 v[84:87], v6 offset:29696
    v_fma_f32 v177, v193, v193, v177
    s_nop 1
    v_add_f32_dpp v176, v176, v176 row_ror:8 row_mask:0xf bank_mask:0xf
    v_add_f32_dpp v177, v177, v177 row_ror:8 row_mask:0xf bank_mask:0xf
    s_waitcnt lgkmcnt(4)
    v_mfma_f32_32x32x16_bf16 v[104:119], v[64:67], v[72:75], v[104:119]
    ds_read_b128 v[88:91], v6 offset:26624
    s_nop 1
    v_add_f32_dpp v176, v176, v176 row_ror:4 row_mask:0xf bank_mask:0xf
    v_add_f32_dpp v177, v177, v177 row_ror:4 row_mask:0xf bank_mask:0xf
    s_waitcnt lgkmcnt(4)
    v_mfma_f32_32x32x16_bf16 v[120:135], v[64:67], v[80:83], v[120:135]
    ds_read_b128 v[96:99], v6 offset:27648
    s_nop 1
    v_add_f32_dpp v176, v176, v176 row_ror:2 row_mask:0xf bank_mask:0xf
    v_add_f32_dpp v177, v177, v177 row_ror:2 row_mask:0xf bank_mask:0xf
    s_add_u32 m0, s47, 90112
    s_mov_b32 s42, 802816
    buffer_load_dwordx4 v27, s[76:79], s42 offen lds
    s_waitcnt lgkmcnt(3)
    v_mfma_f32_32x32x16_bf16 v[104:119], v[68:71], v[76:79], v[104:119]
    ds_read_b128 v[92:95], v6 offset:30720
    s_nop 1
    v_add_f32_dpp v176, v176, v176 row_ror:1 row_mask:0xf bank_mask:0xf
    v_add_f32_dpp v177, v177, v177 row_ror:1 row_mask:0xf bank_mask:0xf
    s_waitcnt lgkmcnt(3)
    v_mfma_f32_32x32x16_bf16 v[120:135], v[68:71], v[84:87], v[120:135]
    ds_read_b128 v[100:103], v6 offset:31744
    v_mov_b32 v178, v176
    v_mov_b32 v179, v177
    s_nop 1
    v_permlane16_swap_b32 v176, v178
    v_permlane16_swap_b32 v177, v179
    s_nop 0
    v_add_f32 v176, v176, v178
    v_add_f32 v177, v177, v179
    s_barrier
    s_waitcnt lgkmcnt(3)
    v_mfma_f32_32x32x16_bf16 v[136:151], v[64:67], v[88:91], v[136:151]
    ds_read_b128 v[56:59], v43 offset:0
    ds_read_b128 v[72:75], v6 offset:32768
    v_mov_b32 v178, v176
    v_mov_b32 v179, v177
    s_nop 1
    v_permlane32_swap_b32 v176, v178
    v_permlane32_swap_b32 v177, v179
    s_nop 0
    v_add_f32 v176, v176, v178
    v_add_f32 v177, v177, v179
    s_waitcnt lgkmcnt(4)
    v_mfma_f32_32x32x16_bf16 v[152:167], v[64:67], v[96:99], v[152:167]
    ds_read_b128 v[80:83], v6 offset:33792
    v_mul_f32 v176, 0x3b000000, v176
    v_mul_f32 v177, 0x3b000000, v177
    s_add_u32 m0, s47, 98304
    s_mov_b32 s42, 512
    buffer_load_dwordx4 v26, s[4:7], s42 offen lds
    s_waitcnt lgkmcnt(4)
    v_mfma_f32_32x32x16_bf16 v[136:151], v[68:71], v[92:95], v[136:151]
    ds_read_b128 v[60:63], v46 offset:0
    ds_read_b128 v[76:79], v6 offset:36864
    v_fma_f32 v177, -v176, v176, v177
    v_max_f32 v177, 0, v177
    s_waitcnt lgkmcnt(5)
    v_mfma_f32_32x32x16_bf16 v[152:167], v[68:71], v[100:103], v[152:167]
    ds_read_b128 v[84:87], v6 offset:37888
    v_cvt_pk_bf16_f32 v178, v176, v177
    v_lshlrev_b32 v176, 16, v178
    v_and_b32 v177, 0xffff0000, v178
    s_waitcnt lgkmcnt(4)
    v_mfma_f32_32x32x16_bf16 v[104:119], v[56:59], v[72:75], v[104:119]
    ds_read_b128 v[88:91], v6 offset:34816
    v_add_f32 v177, 0x3727c5ac, v177
    v_cvt_pk_bf16_f32 v178, v177, v177
    v_lshlrev_b32 v177, 16, v178
    s_waitcnt lgkmcnt(4)
    v_mfma_f32_32x32x16_bf16 v[120:135], v[56:59], v[80:83], v[120:135]
    ds_read_b128 v[96:99], v6 offset:35840
    v_sqrt_f32 v177, v177
    s_nop 0
    v_cvt_pk_bf16_f32 v178, v177, v177
    v_lshlrev_b32 v177, 16, v178
    s_add_u32 m0, s47, 106496
    s_mov_b32 s42, 917504
    buffer_load_dwordx4 v27, s[76:79], s42 offen lds
    s_waitcnt lgkmcnt(3)
    v_mfma_f32_32x32x16_bf16 v[104:119], v[60:63], v[76:79], v[104:119]
    ds_read_b128 v[92:95], v6 offset:38912
    v_rcp_f32 v178, v177
    v_mov_b32 v179, v176
    s_nop 0
    s_waitcnt lgkmcnt(3)
    v_mfma_f32_32x32x16_bf16 v[120:135], v[60:63], v[84:87], v[120:135]
    ds_read_b128 v[100:103], v6 offset:39936
    s_lshl_b32 s44, s43, 3
    s_add_u32 s44, s44, 14024704
    s_mov_b64 s[62:63], exec
    s_mov_b64 exec, 1
    buffer_store_dwordx2 v[178:179], v25, s[28:31], s44 offen sc1
    s_mov_b64 exec, s[62:63]
    s_waitcnt vmcnt(7)
    s_barrier
    s_waitcnt lgkmcnt(3)
    v_mfma_f32_32x32x16_bf16 v[136:151], v[56:59], v[88:91], v[136:151]
    ds_read_b128 v[64:67], v43 offset:16384
    ds_read_b128 v[72:75], v6 offset:40960
    s_waitcnt lgkmcnt(4)
    v_mfma_f32_32x32x16_bf16 v[152:167], v[56:59], v[96:99], v[152:167]
    ds_read_b128 v[80:83], v6 offset:41984
    s_add_u32 m0, s47, 114688
    s_mov_b32 s42, 576
    buffer_load_dwordx4 v26, s[4:7], s42 offen lds
    s_waitcnt lgkmcnt(4)
    v_mfma_f32_32x32x16_bf16 v[136:151], v[60:63], v[92:95], v[136:151]
    ds_read_b128 v[68:71], v46 offset:16384
    ds_read_b128 v[76:79], v6 offset:45056
    s_waitcnt lgkmcnt(5)
    v_mfma_f32_32x32x16_bf16 v[152:167], v[60:63], v[100:103], v[152:167]
    ds_read_b128 v[84:87], v6 offset:46080
    s_waitcnt lgkmcnt(4)
    v_mfma_f32_32x32x16_bf16 v[104:119], v[64:67], v[72:75], v[104:119]
    ds_read_b128 v[88:91], v6 offset:43008
    s_waitcnt lgkmcnt(4)
    v_mfma_f32_32x32x16_bf16 v[120:135], v[64:67], v[80:83], v[120:135]
    ds_read_b128 v[96:99], v6 offset:44032
    s_add_u32 m0, s47, 122880
    s_mov_b32 s42, 1032192
    buffer_load_dwordx4 v27, s[76:79], s42 offen lds
    s_waitcnt lgkmcnt(3)
    v_mfma_f32_32x32x16_bf16 v[104:119], v[68:71], v[76:79], v[104:119]
    ds_read_b128 v[92:95], v6 offset:47104
    s_waitcnt lgkmcnt(3)
    v_mfma_f32_32x32x16_bf16 v[120:135], v[68:71], v[84:87], v[120:135]
    ds_read_b128 v[100:103], v6 offset:48128
    s_waitcnt vmcnt(7)
    s_barrier
    s_waitcnt lgkmcnt(3)
    v_mfma_f32_32x32x16_bf16 v[136:151], v[64:67], v[88:91], v[136:151]
    ds_read_b128 v[56:59], v41 offset:0
    ds_read_b128 v[72:75], v6 offset:49152
    s_waitcnt lgkmcnt(4)
    v_mfma_f32_32x32x16_bf16 v[152:167], v[64:67], v[96:99], v[152:167]
    ds_read_b128 v[80:83], v6 offset:50176
    s_add_u32 m0, s47, 131072
    s_mov_b32 s42, 640
    buffer_load_dwordx4 v26, s[4:7], s42 offen lds
    s_waitcnt lgkmcnt(4)
    v_mfma_f32_32x32x16_bf16 v[136:151], v[68:71], v[92:95], v[136:151]
    ds_read_b128 v[60:63], v44 offset:0
    ds_read_b128 v[76:79], v6 offset:53248
    s_waitcnt lgkmcnt(5)
    v_mfma_f32_32x32x16_bf16 v[152:167], v[68:71], v[100:103], v[152:167]
    ds_read_b128 v[84:87], v6 offset:54272
    s_waitcnt lgkmcnt(4)
    v_mfma_f32_32x32x16_bf16 v[104:119], v[56:59], v[72:75], v[104:119]
    ds_read_b128 v[88:91], v6 offset:51200
    s_waitcnt lgkmcnt(4)
    v_mfma_f32_32x32x16_bf16 v[120:135], v[56:59], v[80:83], v[120:135]
    ds_read_b128 v[96:99], v6 offset:52224
    s_add_u32 m0, s47, 139264
    s_mov_b32 s42, 1146880
    buffer_load_dwordx4 v27, s[76:79], s42 offen lds
    s_waitcnt lgkmcnt(3)
    v_mfma_f32_32x32x16_bf16 v[104:119], v[60:63], v[76:79], v[104:119]
    ds_read_b128 v[92:95], v6 offset:55296
    s_waitcnt lgkmcnt(3)
    v_mfma_f32_32x32x16_bf16 v[120:135], v[60:63], v[84:87], v[120:135]
    ds_read_b128 v[100:103], v6 offset:56320
    s_waitcnt vmcnt(7)
    s_barrier
    s_waitcnt lgkmcnt(3)
    v_mfma_f32_32x32x16_bf16 v[136:151], v[56:59], v[88:91], v[136:151]
    ds_read_b128 v[64:67], v41 offset:16384
    ds_read_b128 v[72:75], v6 offset:57344
    v_lshl_or_b32 v168, v172, 16, v168
    s_waitcnt lgkmcnt(4)
    v_mfma_f32_32x32x16_bf16 v[152:167], v[56:59], v[96:99], v[152:167]
    ds_read_b128 v[80:83], v6 offset:58368
    v_lshl_or_b32 v169, v173, 16, v169
    v_lshl_or_b32 v170, v174, 16, v170
    s_add_u32 m0, s47, 147456
    s_mov_b32 s42, 704
    buffer_load_dwordx4 v26, s[4:7], s42 offen lds
    s_waitcnt lgkmcnt(4)
    v_mfma_f32_32x32x16_bf16 v[136:151], v[60:63], v[92:95], v[136:151]
    ds_read_b128 v[68:71], v44 offset:16384
    ds_read_b128 v[76:79], v6 offset:61440
    v_lshl_or_b32 v171, v175, 16, v171
    v_and_b32 v186, 3, v1
    v_lshlrev_b32 v186, 4, v186
    v_lshrrev_b32 v187, 2, v1
    v_add_lshl_u32 v186, v186, v187, 2
    s_waitcnt lgkmcnt(5)
    v_mfma_f32_32x32x16_bf16 v[152:167], v[60:63], v[100:103], v[152:167]
    ds_read_b128 v[84:87], v6 offset:62464
    ds_bpermute_b32 v172, v186, v168
    ds_bpermute_b32 v173, v186, v169
    s_waitcnt lgkmcnt(6)
    v_mfma_f32_32x32x16_bf16 v[104:119], v[64:67], v[72:75], v[104:119]
    ds_read_b128 v[88:91], v6 offset:59392
    ds_bpermute_b32 v174, v186, v170
    ds_bpermute_b32 v175, v186, v171
    s_waitcnt lgkmcnt(8)
    v_mfma_f32_32x32x16_bf16 v[120:135], v[64:67], v[80:83], v[120:135]
    ds_read_b128 v[96:99], v6 offset:60416
    s_waitcnt lgkmcnt(1)
    s_mov_b32 s44, 9568256
    buffer_store_dwordx4 v[172:175], v180, s[28:31], s44 offen sc1
    s_add_u32 m0, s47, 155648
    s_mov_b32 s42, 1261568
    buffer_load_dwordx4 v27, s[76:79], s42 offen lds
    v_mfma_f32_32x32x16_bf16 v[104:119], v[68:71], v[76:79], v[104:119]
    ds_read_b128 v[92:95], v6 offset:63488
    v_mfma_f32_32x32x16_bf16 v[120:135], v[68:71], v[84:87], v[120:135]
    ds_read_b128 v[100:103], v6 offset:64512
    s_waitcnt vmcnt(8)
    s_barrier
    v_mfma_f32_32x32x16_bf16 v[136:151], v[64:67], v[88:91], v[136:151]
    ds_read_b128 v[56:59], v42 offset:0
    ds_read_b128 v[72:75], v6 offset:0
    s_waitcnt lgkmcnt(4)
    v_mfma_f32_32x32x16_bf16 v[152:167], v[64:67], v[96:99], v[152:167]
    ds_read_b128 v[80:83], v6 offset:1024
    s_add_u32 m0, s47, 65536
    s_mov_b32 s42, 768
    buffer_load_dwordx4 v26, s[4:7], s42 offen lds
    s_waitcnt lgkmcnt(4)
    v_mfma_f32_32x32x16_bf16 v[136:151], v[68:71], v[92:95], v[136:151]
    ds_read_b128 v[60:63], v45 offset:0
    ds_read_b128 v[76:79], v6 offset:4096
    s_waitcnt lgkmcnt(5)
    v_mfma_f32_32x32x16_bf16 v[152:167], v[68:71], v[100:103], v[152:167]
    ds_read_b128 v[84:87], v6 offset:5120
    v_xor_b32 v104, v47, v104
    v_xor_b32 v105, v47, v105
    v_xor_b32 v106, v47, v106
    v_xor_b32 v107, v47, v107
    v_xor_b32 v108, v47, v108
    v_xor_b32 v109, v47, v109
    v_xor_b32 v110, v47, v110
    v_xor_b32 v111, v47, v111
    v_xor_b32 v112, v47, v112
    v_xor_b32 v113, v47, v113
    v_xor_b32 v114, v47, v114
    v_xor_b32 v115, v47, v115
    v_xor_b32 v116, v47, v116
    v_xor_b32 v117, v47, v117
    v_xor_b32 v118, v47, v118
    v_xor_b32 v119, v47, v119
    v_xor_b32 v120, v47, v120
    v_xor_b32 v121, v47, v121
    v_xor_b32 v122, v47, v122
    v_xor_b32 v123, v47, v123
    v_xor_b32 v124, v47, v124
    v_xor_b32 v125, v47, v125
    v_xor_b32 v126, v47, v126
    v_xor_b32 v127, v47, v127
    v_xor_b32 v128, v47, v128
    v_xor_b32 v129, v47, v129
    v_xor_b32 v130, v47, v130
    v_xor_b32 v131, v47, v131
    v_xor_b32 v132, v47, v132
    v_xor_b32 v133, v47, v133
    v_xor_b32 v134, v47, v134
    v_xor_b32 v135, v47, v135
    s_nop 1
    s_waitcnt lgkmcnt(4)
    v_mfma_f32_32x32x16_bf16 v[104:119], v[56:59], v[72:75], v[104:119]
    ds_read_b128 v[88:91], v6 offset:2048
    s_waitcnt lgkmcnt(4)
    v_mfma_f32_32x32x16_bf16 v[120:135], v[56:59], v[80:83], v[120:135]
    ds_read_b128 v[96:99], v6 offset:3072
    s_add_u32 m0, s47, 73728
    s_mov_b32 s42, 1376256
    buffer_load_dwordx4 v27, s[76:79], s42 offen lds
    s_waitcnt lgkmcnt(3)
    v_mfma_f32_32x32x16_bf16 v[104:119], v[60:63], v[76:79], v[104:119]
    ds_read_b128 v[92:95], v6 offset:6144
    s_waitcnt lgkmcnt(3)
    v_mfma_f32_32x32x16_bf16 v[120:135], v[60:63], v[84:87], v[120:135]
    ds_read_b128 v[100:103], v6 offset:7168
    s_waitcnt vmcnt(7)
    s_barrier
    v_xor_b32 v136, v47, v136
    v_xor_b32 v137, v47, v137
    v_xor_b32 v138, v47, v138
    v_xor_b32 v139, v47, v139
    v_xor_b32 v140, v47, v140
    v_xor_b32 v141, v47, v141
    v_xor_b32 v142, v47, v142
    v_xor_b32 v143, v47, v143
    v_xor_b32 v144, v47, v144
    v_xor_b32 v145, v47, v145
    v_xor_b32 v146, v47, v146
    v_xor_b32 v147, v47, v147
    v_xor_b32 v148, v47, v148
    v_xor_b32 v149, v47, v149
    v_xor_b32 v150, v47, v150
    v_xor_b32 v151, v47, v151
    v_xor_b32 v152, v47, v152
    v_xor_b32 v153, v47, v153
    v_xor_b32 v154, v47, v154
    v_xor_b32 v155, v47, v155
    v_xor_b32 v156, v47, v156
    v_xor_b32 v157, v47, v157
    v_xor_b32 v158, v47, v158
    v_xor_b32 v159, v47, v159
    v_xor_b32 v160, v47, v160
    v_xor_b32 v161, v47, v161
    v_xor_b32 v162, v47, v162
    v_xor_b32 v163, v47, v163
    v_xor_b32 v164, v47, v164
    v_xor_b32 v165, v47, v165
    v_xor_b32 v166, v47, v166
    v_xor_b32 v167, v47, v167
    s_nop 1
    s_waitcnt lgkmcnt(3)
    v_mfma_f32_32x32x16_bf16 v[136:151], v[56:59], v[88:91], v[136:151]
    ds_read_b128 v[64:67], v42 offset:16384
    ds_read_b128 v[72:75], v6 offset:8192
    s_waitcnt lgkmcnt(4)
    v_mfma_f32_32x32x16_bf16 v[152:167], v[56:59], v[96:99], v[152:167]
    ds_read_b128 v[80:83], v6 offset:9216
    s_add_u32 m0, s47, 81920
    s_mov_b32 s42, 832
    buffer_load_dwordx4 v26, s[4:7], s42 offen lds
    s_waitcnt lgkmcnt(4)
    v_mfma_f32_32x32x16_bf16 v[136:151], v[60:63], v[92:95], v[136:151]
    ds_read_b128 v[68:71], v45 offset:16384
    ds_read_b128 v[76:79], v6 offset:12288
    s_waitcnt lgkmcnt(5)
    v_mfma_f32_32x32x16_bf16 v[152:167], v[60:63], v[100:103], v[152:167]
    ds_read_b128 v[84:87], v6 offset:13312
    s_waitcnt lgkmcnt(4)
    v_mfma_f32_32x32x16_bf16 v[104:119], v[64:67], v[72:75], v[104:119]
    ds_read_b128 v[88:91], v6 offset:10240
    s_waitcnt lgkmcnt(4)
    v_mfma_f32_32x32x16_bf16 v[120:135], v[64:67], v[80:83], v[120:135]
    ds_read_b128 v[96:99], v6 offset:11264
    s_add_u32 m0, s47, 90112
    s_mov_b32 s42, 1490944
    buffer_load_dwordx4 v27, s[76:79], s42 offen lds
    s_waitcnt lgkmcnt(3)
    v_mfma_f32_32x32x16_bf16 v[104:119], v[68:71], v[76:79], v[104:119]
    ds_read_b128 v[92:95], v6 offset:14336
    s_waitcnt lgkmcnt(3)
    v_mfma_f32_32x32x16_bf16 v[120:135], v[68:71], v[84:87], v[120:135]
    ds_read_b128 v[100:103], v6 offset:15360
    s_waitcnt vmcnt(7)
    s_barrier
    s_waitcnt lgkmcnt(3)
    v_mfma_f32_32x32x16_bf16 v[136:151], v[64:67], v[88:91], v[136:151]
    ds_read_b128 v[56:59], v43 offset:0
    ds_read_b128 v[72:75], v6 offset:16384
    s_waitcnt lgkmcnt(4)
    v_mfma_f32_32x32x16_bf16 v[152:167], v[64:67], v[96:99], v[152:167]
    ds_read_b128 v[80:83], v6 offset:17408
    s_add_u32 m0, s47, 98304
    s_mov_b32 s42, 896
    buffer_load_dwordx4 v26, s[4:7], s42 offen lds
    s_waitcnt lgkmcnt(4)
    v_mfma_f32_32x32x16_bf16 v[136:151], v[68:71], v[92:95], v[136:151]
    ds_read_b128 v[60:63], v46 offset:0
    ds_read_b128 v[76:79], v6 offset:20480
    s_waitcnt lgkmcnt(5)
    v_mfma_f32_32x32x16_bf16 v[152:167], v[68:71], v[100:103], v[152:167]
    ds_read_b128 v[84:87], v6 offset:21504
    s_waitcnt lgkmcnt(4)
    v_mfma_f32_32x32x16_bf16 v[104:119], v[56:59], v[72:75], v[104:119]
    ds_read_b128 v[88:91], v6 offset:18432
    s_waitcnt lgkmcnt(4)
    v_mfma_f32_32x32x16_bf16 v[120:135], v[56:59], v[80:83], v[120:135]
    ds_read_b128 v[96:99], v6 offset:19456
    s_add_u32 m0, s47, 106496
    s_mov_b32 s42, 1605632
    buffer_load_dwordx4 v27, s[76:79], s42 offen lds
    s_waitcnt lgkmcnt(3)
    v_mfma_f32_32x32x16_bf16 v[104:119], v[60:63], v[76:79], v[104:119]
    ds_read_b128 v[92:95], v6 offset:22528
    s_waitcnt lgkmcnt(3)
    v_mfma_f32_32x32x16_bf16 v[120:135], v[60:63], v[84:87], v[120:135]
    ds_read_b128 v[100:103], v6 offset:23552
    s_waitcnt vmcnt(6)
    s_barrier
    s_waitcnt lgkmcnt(3)
    v_mfma_f32_32x32x16_bf16 v[136:151], v[56:59], v[88:91], v[136:151]
    ds_read_b128 v[64:67], v43 offset:16384
    ds_read_b128 v[72:75], v6 offset:24576
    s_waitcnt lgkmcnt(4)
    v_mfma_f32_32x32x16_bf16 v[152:167], v[56:59], v[96:99], v[152:167]
    ds_read_b128 v[80:83], v6 offset:25600
    s_add_u32 m0, s47, 114688
    s_mov_b32 s42, 960
    buffer_load_dwordx4 v26, s[4:7], s42 offen lds
    s_waitcnt lgkmcnt(4)
    v_mfma_f32_32x32x16_bf16 v[136:151], v[60:63], v[92:95], v[136:151]
    ds_read_b128 v[68:71], v46 offset:16384
    ds_read_b128 v[76:79], v6 offset:28672
    s_waitcnt lgkmcnt(5)
    v_mfma_f32_32x32x16_bf16 v[152:167], v[60:63], v[100:103], v[152:167]
    ds_read_b128 v[84:87], v6 offset:29696
    s_lshr_b32 s57, s2, 3
    s_lshl_b32 s57, s57, 3
    s_add_u32 s57, s57, s38
    s_lshl_b32 s57, s57, 13
    v_lshlrev_b32 v181, 7, v1
    buffer_load_dword v182, v181, s[16:19], s57 offen
    s_waitcnt lgkmcnt(4)
    v_mfma_f32_32x32x16_bf16 v[104:119], v[64:67], v[72:75], v[104:119]
    ds_read_b128 v[88:91], v6 offset:26624
    s_waitcnt lgkmcnt(4)
    v_mfma_f32_32x32x16_bf16 v[120:135], v[64:67], v[80:83], v[120:135]
    ds_read_b128 v[96:99], v6 offset:27648
    s_add_u32 m0, s47, 122880
    s_mov_b32 s42, 1720320
    buffer_load_dwordx4 v27, s[76:79], s42 offen lds
    s_waitcnt lgkmcnt(3)
    v_mfma_f32_32x32x16_bf16 v[104:119], v[68:71], v[76:79], v[104:119]
    ds_read_b128 v[92:95], v6 offset:30720
    s_waitcnt lgkmcnt(3)
    v_mfma_f32_32x32x16_bf16 v[120:135], v[68:71], v[84:87], v[120:135]
    ds_read_b128 v[100:103], v6 offset:31744
    s_waitcnt vmcnt(7)
    s_barrier
    s_waitcnt lgkmcnt(3)
    v_mfma_f32_32x32x16_bf16 v[136:151], v[64:67], v[88:91], v[136:151]
    ds_read_b128 v[56:59], v41 offset:0
    ds_read_b128 v[72:75], v6 offset:32768
    s_waitcnt lgkmcnt(4)
    v_mfma_f32_32x32x16_bf16 v[152:167], v[64:67], v[96:99], v[152:167]
    ds_read_b128 v[80:83], v6 offset:33792
    s_waitcnt lgkmcnt(4)
    v_mfma_f32_32x32x16_bf16 v[136:151], v[68:71], v[92:95], v[136:151]
    ds_read_b128 v[60:63], v44 offset:0
    ds_read_b128 v[76:79], v6 offset:36864
    s_waitcnt lgkmcnt(5)
    v_mfma_f32_32x32x16_bf16 v[152:167], v[68:71], v[100:103], v[152:167]
    ds_read_b128 v[84:87], v6 offset:37888
    s_waitcnt lgkmcnt(4)
    v_mfma_f32_32x32x16_bf16 v[104:119], v[56:59], v[72:75], v[104:119]
    ds_read_b128 v[88:91], v6 offset:34816
    s_waitcnt lgkmcnt(4)
    v_mfma_f32_32x32x16_bf16 v[120:135], v[56:59], v[80:83], v[120:135]
    ds_read_b128 v[96:99], v6 offset:35840
    s_waitcnt lgkmcnt(3)
    v_mfma_f32_32x32x16_bf16 v[104:119], v[60:63], v[76:79], v[104:119]
    ds_read_b128 v[92:95], v6 offset:38912
    s_waitcnt lgkmcnt(3)
    v_mfma_f32_32x32x16_bf16 v[120:135], v[60:63], v[84:87], v[120:135]
    ds_read_b128 v[100:103], v6 offset:39936
    s_waitcnt vmcnt(5)
    s_barrier
    s_waitcnt lgkmcnt(3)
    v_mfma_f32_32x32x16_bf16 v[136:151], v[56:59], v[88:91], v[136:151]
    ds_read_b128 v[64:67], v41 offset:16384
    ds_read_b128 v[72:75], v6 offset:40960
    s_waitcnt lgkmcnt(4)
    v_mfma_f32_32x32x16_bf16 v[152:167], v[56:59], v[96:99], v[152:167]
    ds_read_b128 v[80:83], v6 offset:41984
    s_waitcnt lgkmcnt(4)
    v_mfma_f32_32x32x16_bf16 v[136:151], v[60:63], v[92:95], v[136:151]
    ds_read_b128 v[68:71], v44 offset:16384
    ds_read_b128 v[76:79], v6 offset:45056
    s_waitcnt lgkmcnt(5)
    v_mfma_f32_32x32x16_bf16 v[152:167], v[60:63], v[100:103], v[152:167]
    ds_read_b128 v[84:87], v6 offset:46080
    s_waitcnt lgkmcnt(4)
    v_mfma_f32_32x32x16_bf16 v[104:119], v[64:67], v[72:75], v[104:119]
    ds_read_b128 v[88:91], v6 offset:43008
    s_waitcnt lgkmcnt(4)
    v_mfma_f32_32x32x16_bf16 v[120:135], v[64:67], v[80:83], v[120:135]
    ds_read_b128 v[96:99], v6 offset:44032
    s_waitcnt lgkmcnt(3)
    v_mfma_f32_32x32x16_bf16 v[104:119], v[68:71], v[76:79], v[104:119]
    ds_read_b128 v[92:95], v6 offset:47104
    s_waitcnt lgkmcnt(3)
    v_mfma_f32_32x32x16_bf16 v[120:135], v[68:71], v[84:87], v[120:135]
    ds_read_b128 v[100:103], v6 offset:48128
    s_waitcnt vmcnt(3)
    s_barrier
    v_lshlrev_b32 v230, 5, v4
    s_lshl_b32 s50, s36, 9
    s_add_u32 s50, s50, 14123008
    v_add_u32 v230, s50, v230
    s_mov_b64 s[62:63], exec
    s_mov_b32 exec_lo, 0xffff
    s_mov_b32 exec_hi, 0
    buffer_load_dword v231, v230, s[28:31], 0 offen sc0 sc1
    s_mov_b64 exec, s[62:63]
    s_waitcnt lgkmcnt(3)
    v_mfma_f32_32x32x16_bf16 v[136:151], v[64:67], v[88:91], v[136:151]
    ds_read_b128 v[56:59], v42 offset:0
    ds_read_b128 v[72:75], v6 offset:49152
    s_waitcnt lgkmcnt(4)
    v_mfma_f32_32x32x16_bf16 v[152:167], v[64:67], v[96:99], v[152:167]
    ds_read_b128 v[80:83], v6 offset:50176
    s_waitcnt lgkmcnt(4)
    v_mfma_f32_32x32x16_bf16 v[136:151], v[68:71], v[92:95], v[136:151]
    ds_read_b128 v[60:63], v45 offset:0
    ds_read_b128 v[76:79], v6 offset:53248
    s_waitcnt lgkmcnt(5)
    v_mfma_f32_32x32x16_bf16 v[152:167], v[68:71], v[100:103], v[152:167]
    ds_read_b128 v[84:87], v6 offset:54272
    s_waitcnt lgkmcnt(4)
    v_mfma_f32_32x32x16_bf16 v[104:119], v[56:59], v[72:75], v[104:119]
    ds_read_b128 v[88:91], v6 offset:51200
    s_waitcnt lgkmcnt(4)
    v_mfma_f32_32x32x16_bf16 v[120:135], v[56:59], v[80:83], v[120:135]
    ds_read_b128 v[96:99], v6 offset:52224
    s_waitcnt lgkmcnt(3)
    v_mfma_f32_32x32x16_bf16 v[104:119], v[60:63], v[76:79], v[104:119]
    ds_read_b128 v[92:95], v6 offset:55296
    s_waitcnt lgkmcnt(3)
    v_mfma_f32_32x32x16_bf16 v[120:135], v[60:63], v[84:87], v[120:135]
    ds_read_b128 v[100:103], v6 offset:56320
    s_waitcnt vmcnt(1)
    s_barrier
    s_waitcnt vmcnt(0)
    s_mov_b64 s[62:63], exec
    s_mov_b32 exec_lo, 0xffff
    s_mov_b32 exec_hi, 0
    v_cmp_ne_u32 vcc, s49, v231
    s_mov_b64 exec, s[62:63]
    s_cmp_eq_u64 vcc, 0
    s_cbranch_scc1 LEP12
    s_mov_b32 s50, 0
    s_mov_b32 s57, 0
    s_mov_b64 s[62:63], exec
    s_mov_b32 exec_lo, 0xffff
    s_mov_b32 exec_hi, 0
LP13:
    buffer_load_dword v231, v230, s[28:31], s50 offen sc0 sc1
    s_waitcnt vmcnt(0)
    v_cmp_ne_u32 vcc, s49, v231
    s_nop 0
    s_cmp_eq_u64 vcc, 0
    s_cbranch_scc1 LP13D
    s_add_u32 s57, s57, 1
    s_cmp_lt_u32 s57, 20000
    s_cbranch_scc0 LP13D
    s_sleep 1
    s_branch LP13
LP13D:
    s_mov_b64 exec, s[62:63]
LEP12:
    s_lshl_b32 s53, s36, 1
    s_lshr_b32 s51, s39, 1
    s_add_u32 s53, s53, s51
    s_lshl_b32 s53, s53, 9
    s_and_b32 s51, s39, 1
    s_lshl_b32 s51, s51, 8
    s_add_u32 s53, s53, s51
    s_add_u32 s53, s53, 14024704
    v_lshlrev_b32 v8, 3, v2
    buffer_load_dwordx2 v[184:185], v8, s[28:31], s53 offen sc1
    s_waitcnt lgkmcnt(3)
    v_mfma_f32_32x32x16_bf16 v[136:151], v[56:59], v[88:91], v[136:151]
    ds_read_b128 v[64:67], v42 offset:16384
    ds_read_b128 v[72:75], v6 offset:57344
    s_waitcnt lgkmcnt(4)
    v_mfma_f32_32x32x16_bf16 v[152:167], v[56:59], v[96:99], v[152:167]
    ds_read_b128 v[80:83], v6 offset:58368
    s_waitcnt lgkmcnt(4)
    v_mfma_f32_32x32x16_bf16 v[136:151], v[60:63], v[92:95], v[136:151]
    ds_read_b128 v[68:71], v45 offset:16384
    ds_read_b128 v[76:79], v6 offset:61440
    s_waitcnt lgkmcnt(5)
    v_mfma_f32_32x32x16_bf16 v[152:167], v[60:63], v[100:103], v[152:167]
    ds_read_b128 v[84:87], v6 offset:62464
    s_waitcnt lgkmcnt(4)
    v_mfma_f32_32x32x16_bf16 v[104:119], v[64:67], v[72:75], v[104:119]
    ds_read_b128 v[88:91], v6 offset:59392
    s_waitcnt lgkmcnt(4)
    v_mfma_f32_32x32x16_bf16 v[120:135], v[64:67], v[80:83], v[120:135]
    ds_read_b128 v[96:99], v6 offset:60416
    s_waitcnt lgkmcnt(3)
    v_mfma_f32_32x32x16_bf16 v[104:119], v[68:71], v[76:79], v[104:119]
    ds_read_b128 v[92:95], v6 offset:63488
    s_waitcnt lgkmcnt(3)
    v_mfma_f32_32x32x16_bf16 v[120:135], v[68:71], v[84:87], v[120:135]
    ds_read_b128 v[100:103], v6 offset:64512
    s_waitcnt lgkmcnt(3)
    v_mfma_f32_32x32x16_bf16 v[136:151], v[64:67], v[88:91], v[136:151]
    s_waitcnt lgkmcnt(2)
    v_mfma_f32_32x32x16_bf16 v[152:167], v[64:67], v[96:99], v[152:167]
    s_waitcnt lgkmcnt(1)
    v_mfma_f32_32x32x16_bf16 v[136:151], v[68:71], v[92:95], v[136:151]
    s_waitcnt lgkmcnt(0)
    v_mfma_f32_32x32x16_bf16 v[152:167], v[68:71], v[100:103], v[152:167]
    s_nop 11
    v_xor_b32 v104, v47, v104
    v_xor_b32 v105, v47, v105
    v_xor_b32 v106, v47, v106
    v_xor_b32 v107, v47, v107
    v_xor_b32 v108, v47, v108
    v_xor_b32 v109, v47, v109
    v_xor_b32 v110, v47, v110
    v_xor_b32 v111, v47, v111
    v_xor_b32 v112, v47, v112
    v_xor_b32 v113, v47, v113
    v_xor_b32 v114, v47, v114
    v_xor_b32 v115, v47, v115
    v_xor_b32 v116, v47, v116
    v_xor_b32 v117, v47, v117
    v_xor_b32 v118, v47, v118
    v_xor_b32 v119, v47, v119
    v_xor_b32 v120, v47, v120
    v_xor_b32 v121, v47, v121
    v_xor_b32 v122, v47, v122
    v_xor_b32 v123, v47, v123
    v_xor_b32 v124, v47, v124
    v_xor_b32 v125, v47, v125
    v_xor_b32 v126, v47, v126
    v_xor_b32 v127, v47, v127
    v_xor_b32 v128, v47, v128
    v_xor_b32 v129, v47, v129
    v_xor_b32 v130, v47, v130
    v_xor_b32 v131, v47, v131
    v_xor_b32 v132, v47, v132
    v_xor_b32 v133, v47, v133
    v_xor_b32 v134, v47, v134
    v_xor_b32 v135, v47, v135
    v_xor_b32 v136, v47, v136
    v_xor_b32 v137, v47, v137
    v_xor_b32 v138, v47, v138
    v_xor_b32 v139, v47, v139
    v_xor_b32 v140, v47, v140
    v_xor_b32 v141, v47, v141
    v_xor_b32 v142, v47, v142
    v_xor_b32 v143, v47, v143
    v_xor_b32 v144, v47, v144
    v_xor_b32 v145, v47, v145
    v_xor_b32 v146, v47, v146
    v_xor_b32 v147, v47, v147
    v_xor_b32 v148, v47, v148
    v_xor_b32 v149, v47, v149
    v_xor_b32 v150, v47, v150
    v_xor_b32 v151, v47, v151
    v_xor_b32 v152, v47, v152
    v_xor_b32 v153, v47, v153
    v_xor_b32 v154, v47, v154
    v_xor_b32 v155, v47, v155
    v_xor_b32 v156, v47, v156
    v_xor_b32 v157, v47, v157
    v_xor_b32 v158, v47, v158
    v_xor_b32 v159, v47, v159
    v_xor_b32 v160, v47, v160
    v_xor_b32 v161, v47, v161
    v_xor_b32 v162, v47, v162
    v_xor_b32 v163, v47, v163
    v_xor_b32 v164, v47, v164
    v_xor_b32 v165, v47, v165
    v_xor_b32 v166, v47, v166
    v_xor_b32 v167, v47, v167
L_EPI:
    s_and_b32 s51, s75, s40
    s_cmp_eq_u32 s51, 0
    s_cbranch_scc0 L_NOCS
    v_add_f32 v48, v48, v49
    s_lshl_b32 s51, s58, 7
    v_mov_b32 v9, v48
    v_lshlrev_b32 v11, 2, v2
    v_add_u32 v11, s51, v11
    v_permlane32_swap_b32 v48, v9
    s_nop 0
    v_add_f32 v48, v48, v9
    ds_write_b32 v11, v48 offset:16384
L_NOCS:
    s_waitcnt lgkmcnt(0)
    v_mov_b32 v20, 18460
    v_mov_b32 v21, 1
    s_mov_b64 s[62:63], exec
    s_mov_b64 exec, 1
    ds_add_u32 v20, v21
    s_mov_b64 exec, s[62:63]
    s_and_b32 s51, s75, s40
    s_cmp_eq_u32 s51, 0
    s_cbranch_scc0 L_E2
    s_lshl_b32 s50, s36, 1
    s_lshr_b32 s51, s39, 1
    s_add_u32 s50, s50, s51
    s_mul_i32 s53, s50, 229376
    s_and_b32 s51, s39, 1
    s_lshl_b32 s51, s51, 10
    s_add_u32 s53, s53, s51
    s_mov_b32 s80, 0xbdd2d3e8
    v_mov_b32 v34, 0xc0135761
    v_mov_b32 v57, 0
    v_mov_b32 v58, 0
    v_mov_b32 v59, 0
    v_mov_b32 v73, 0
    v_mov_b32 v74, 0
    v_mov_b32 v75, 0
    v_mov_b32 v77, 0
    v_mov_b32 v78, 0
    v_mov_b32 v79, 0
    v_mov_b32 v81, 0
    v_mov_b32 v82, 0
    v_mov_b32 v83, 0
    v_mov_b32 v85, 0
    v_mov_b32 v86, 0
    v_mov_b32 v87, 0
    v_mov_b32 v20, 18460
    s_mov_b32 s57, 0
LLW14:
    ds_read_b32 v22, v20
    s_waitcnt lgkmcnt(0)
    v_readfirstlane_b32 s56, v22
    s_add_u32 s57, s57, 1
    s_cmp_ge_u32 s57, 400000
    s_cbranch_scc1 LLW14D
    s_cmp_ge_u32 s56, 8
    s_cbranch_scc1 LLW14D
    s_branch LLW14
LLW14D:
    s_cmp_eq_u32 s38, 0
    s_cbranch_scc0 L_NPW
    s_lshr_b32 s50, s2, 4
    s_lshl_b32 s50, s50, 9
    s_and_b32 s51, s2, 7
    s_lshl_b32 s51, s51, 1
    s_bfe_u32 s52, s2, 0x10003
    s_add_u32 s51, s51, s52
    s_lshl_b32 s51, s51, 5
    s_add_u32 s50, s50, s51
    s_add_u32 s50, s50, 14098432
    s_mov_b64 s[62:63], exec
    s_mov_b64 exec, 1
    buffer_store_dword v24, v25, s[28:31], s50 offen sc0 sc1
    s_mov_b64 exec, s[62:63]
L_NPW:
    s_lshl_b32 s50, s58, 7
    v_lshlrev_b32 v10, 2, v2
    v_add_u32 v10, s50, v10
    ds_read_b32 v14, v10 offset:16384
    s_lshl_b32 s50, s59, 7
    v_lshlrev_b32 v11, 2, v2
    v_add_u32 v11, s50, v11
    ds_read_b32 v15, v11 offset:16384
    s_lshl_b32 s50, s60, 7
    v_lshlrev_b32 v12, 2, v2
    v_add_u32 v12, s50, v12
    ds_read_b32 v16, v12 offset:16384
    s_lshl_b32 s50, s61, 7
    v_lshlrev_b32 v13, 2, v2
    v_add_u32 v13, s50, v13
    ds_read_b32 v17, v13 offset:16384
    s_waitcnt vmcnt(0)
    v_mov_b32 v30, v184
    v_xor_b32 v8, 0x80000000, v185
    v_cvt_pk_bf16_f32 v8, v8, v8
    v_cmp_eq_u32 vcc, 0, v3
    v_mov_b32 v56, 0
    s_nop 0
    v_cndmask_b32 v56, v56, v8, vcc
    s_waitcnt lgkmcnt(0)
    v_cvt_pk_bf16_f32 v8, v14, v14
    v_lshlrev_b32 v8, 16, v8
    v_sub_f32 v9, v14, v8
    v_cvt_pk_bf16_f32 v72, v8, v9
    v_cvt_pk_bf16_f32 v8, v15, v15
    v_lshlrev_b32 v8, 16, v8
    v_sub_f32 v9, v15, v8
    v_cvt_pk_bf16_f32 v76, v8, v9
    v_cvt_pk_bf16_f32 v8, v16, v16
    v_lshlrev_b32 v8, 16, v8
    v_sub_f32 v9, v16, v8
    v_cvt_pk_bf16_f32 v80, v8, v9
    v_cvt_pk_bf16_f32 v8, v17, v17
    v_lshlrev_b32 v8, 16, v8
    v_sub_f32 v9, v17, v8
    v_cvt_pk_bf16_f32 v84, v8, v9
    s_nop 1
    v_mfma_f32_32x32x16_bf16 v[104:119], v[72:75], v[56:59], v[104:119]
    v_mfma_f32_32x32x16_bf16 v[120:135], v[76:79], v[56:59], v[120:135]
    v_mfma_f32_32x32x16_bf16 v[136:151], v[80:83], v[56:59], v[136:151]
    v_mfma_f32_32x32x16_bf16 v[152:167], v[84:87], v[56:59], v[152:167]
    s_mul_i32 s66, s39, 28
    s_lshl_b32 s67, s39, 15
    s_add_u32 s67, s67, 32768
    v_lshrrev_b32 v14, 3, v1
    v_and_b32 v15, 7, v1
    v_bfe_u32 v16, v1, 4, 1
    v_lshlrev_b32 v16, 2, v16
    v_xor_b32 v27, v15, v16
    v_lshlrev_b32 v15, 4, v27
    v_lshl_add_u32 v26, v14, 10, v15
    s_lshl_b32 s68, s66, 14
    s_lshl_b32 s50, s65, 7
    s_add_u32 s68, s68, s50
    s_waitcnt lgkmcnt(0)
    s_cmp_eq_u32 s40, 0
    s_cbranch_scc0 L_E1
    s_setprio 1
    s_add_u32 s50, s74, s58
    s_lshl_b32 s50, s50, 11
    s_add_u32 s50, s50, s53
    s_nop 5
    v_pk_mul_f32 v[104:105], v[104:105], v[30:31] op_sel_hi:[1,0]
    v_pk_mul_f32 v[106:107], v[106:107], v[30:31] op_sel_hi:[1,0]
    v_pk_mul_f32 v[108:109], v[108:109], v[30:31] op_sel_hi:[1,0]
    v_pk_mul_f32 v[110:111], v[110:111], v[30:31] op_sel_hi:[1,0]
    v_pk_mul_f32 v[112:113], v[112:113], v[30:31] op_sel_hi:[1,0]
    v_pk_mul_f32 v[114:115], v[114:115], v[30:31] op_sel_hi:[1,0]
    v_pk_mul_f32 v[116:117], v[116:117], v[30:31] op_sel_hi:[1,0]
    v_pk_mul_f32 v[118:119], v[118:119], v[30:31] op_sel_hi:[1,0]
    v_pk_mul_f32 v[8:9], v[104:105], v[104:105]
    v_pk_mul_f32 v[10:11], v[106:107], v[106:107]
    v_pk_mul_f32 v[12:13], v[108:109], v[108:109]
    v_pk_mul_f32 v[14:15], v[110:111], v[110:111]
    v_pk_fma_f32 v[8:9], v[8:9], s[80:81], v[34:35] op_sel_hi:[1,0,0]
    v_pk_fma_f32 v[10:11], v[10:11], s[80:81], v[34:35] op_sel_hi:[1,0,0]
    v_pk_fma_f32 v[12:13], v[12:13], s[80:81], v[34:35] op_sel_hi:[1,0,0]
    v_pk_fma_f32 v[14:15], v[14:15], s[80:81], v[34:35] op_sel_hi:[1,0,0]
    v_pk_mul_f32 v[8:9], v[8:9], v[104:105]
    v_pk_mul_f32 v[10:11], v[10:11], v[106:107]
    v_pk_mul_f32 v[12:13], v[12:13], v[108:109]
    v_pk_mul_f32 v[14:15], v[14:15], v[110:111]
    v_exp_f32 v8, v8
    v_exp_f32 v9, v9
    v_exp_f32 v10, v10
    v_exp_f32 v11, v11
    v_exp_f32 v12, v12
    v_exp_f32 v13, v13
    v_exp_f32 v14, v14
    v_exp_f32 v15, v15
    v_pk_mul_f32 v[104:105], v[104:105], v[112:113]
    v_pk_mul_f32 v[106:107], v[106:107], v[114:115]
    v_pk_mul_f32 v[108:109], v[108:109], v[116:117]
    v_pk_mul_f32 v[110:111], v[110:111], v[118:119]
    v_pk_add_f32 v[8:9], v[8:9], 1.0 op_sel_hi:[1,0]
    v_pk_add_f32 v[10:11], v[10:11], 1.0 op_sel_hi:[1,0]
    v_pk_add_f32 v[12:13], v[12:13], 1.0 op_sel_hi:[1,0]
    v_pk_add_f32 v[14:15], v[14:15], 1.0 op_sel_hi:[1,0]
    v_rcp_f32 v8, v8
    v_rcp_f32 v9, v9
    v_rcp_f32 v10, v10
    v_rcp_f32 v11, v11
    v_rcp_f32 v12, v12
    v_rcp_f32 v13, v13
    v_rcp_f32 v14, v14
    v_rcp_f32 v15, v15
    s_nop 0
    v_pk_mul_f32 v[104:105], v[104:105], v[8:9]
    v_pk_mul_f32 v[106:107], v[106:107], v[10:11]
    v_pk_mul_f32 v[108:109], v[108:109], v[12:13]
    v_pk_mul_f32 v[110:111], v[110:111], v[14:15]
    v_cvt_pk_bf16_f32 v112, v104, v105
    v_cvt_pk_bf16_f32 v113, v106, v107
    v_cvt_pk_bf16_f32 v114, v108, v109
    v_cvt_pk_bf16_f32 v115, v110, v111
    buffer_store_dwordx4 v[112:115], v6, s[28:31], s50 offen sc1
    s_add_u32 s50, s74, s59
    s_lshl_b32 s50, s50, 11
    s_add_u32 s50, s50, s53
    v_pk_mul_f32 v[120:121], v[120:121], v[30:31] op_sel_hi:[1,0]
    v_pk_mul_f32 v[122:123], v[122:123], v[30:31] op_sel_hi:[1,0]
    v_pk_mul_f32 v[124:125], v[124:125], v[30:31] op_sel_hi:[1,0]
    v_pk_mul_f32 v[126:127], v[126:127], v[30:31] op_sel_hi:[1,0]
    v_pk_mul_f32 v[128:129], v[128:129], v[30:31] op_sel_hi:[1,0]
    v_pk_mul_f32 v[130:131], v[130:131], v[30:31] op_sel_hi:[1,0]
    v_pk_mul_f32 v[132:133], v[132:133], v[30:31] op_sel_hi:[1,0]
    v_pk_mul_f32 v[134:135], v[134:135], v[30:31] op_sel_hi:[1,0]
    v_pk_mul_f32 v[8:9], v[120:121], v[120:121]
    v_pk_mul_f32 v[10:11], v[122:123], v[122:123]
    v_pk_mul_f32 v[12:13], v[124:125], v[124:125]
    v_pk_mul_f32 v[14:15], v[126:127], v[126:127]
    v_pk_fma_f32 v[8:9], v[8:9], s[80:81], v[34:35] op_sel_hi:[1,0,0]
    v_pk_fma_f32 v[10:11], v[10:11], s[80:81], v[34:35] op_sel_hi:[1,0,0]
    v_pk_fma_f32 v[12:13], v[12:13], s[80:81], v[34:35] op_sel_hi:[1,0,0]
    v_pk_fma_f32 v[14:15], v[14:15], s[80:81], v[34:35] op_sel_hi:[1,0,0]
    v_pk_mul_f32 v[8:9], v[8:9], v[120:121]
    v_pk_mul_f32 v[10:11], v[10:11], v[122:123]
    v_pk_mul_f32 v[12:13], v[12:13], v[124:125]
    v_pk_mul_f32 v[14:15], v[14:15], v[126:127]
    v_exp_f32 v8, v8
    v_exp_f32 v9, v9
    v_exp_f32 v10, v10
    v_exp_f32 v11, v11
    v_exp_f32 v12, v12
    v_exp_f32 v13, v13
    v_exp_f32 v14, v14
    v_exp_f32 v15, v15
    v_pk_mul_f32 v[120:121], v[120:121], v[128:129]
    v_pk_mul_f32 v[122:123], v[122:123], v[130:131]
    v_pk_mul_f32 v[124:125], v[124:125], v[132:133]
    v_pk_mul_f32 v[126:127], v[126:127], v[134:135]
    v_pk_add_f32 v[8:9], v[8:9], 1.0 op_sel_hi:[1,0]
    v_pk_add_f32 v[10:11], v[10:11], 1.0 op_sel_hi:[1,0]
    v_pk_add_f32 v[12:13], v[12:13], 1.0 op_sel_hi:[1,0]
    v_pk_add_f32 v[14:15], v[14:15], 1.0 op_sel_hi:[1,0]
    v_rcp_f32 v8, v8
    v_rcp_f32 v9, v9
    v_rcp_f32 v10, v10
    v_rcp_f32 v11, v11
    v_rcp_f32 v12, v12
    v_rcp_f32 v13, v13
    v_rcp_f32 v14, v14
    v_rcp_f32 v15, v15
    s_nop 0
    v_pk_mul_f32 v[120:121], v[120:121], v[8:9]
    v_pk_mul_f32 v[122:123], v[122:123], v[10:11]
    v_pk_mul_f32 v[124:125], v[124:125], v[12:13]
    v_pk_mul_f32 v[126:127], v[126:127], v[14:15]
    v_cvt_pk_bf16_f32 v128, v120, v121
    v_cvt_pk_bf16_f32 v129, v122, v123
    v_cvt_pk_bf16_f32 v130, v124, v125
    v_cvt_pk_bf16_f32 v131, v126, v127
    buffer_store_dwordx4 v[128:131], v6, s[28:31], s50 offen sc1
    s_add_u32 s50, s74, s60
    s_lshl_b32 s50, s50, 11
    s_add_u32 s50, s50, s53
    v_pk_mul_f32 v[136:137], v[136:137], v[30:31] op_sel_hi:[1,0]
    v_pk_mul_f32 v[138:139], v[138:139], v[30:31] op_sel_hi:[1,0]
    v_pk_mul_f32 v[140:141], v[140:141], v[30:31] op_sel_hi:[1,0]
    v_pk_mul_f32 v[142:143], v[142:143], v[30:31] op_sel_hi:[1,0]
    v_pk_mul_f32 v[144:145], v[144:145], v[30:31] op_sel_hi:[1,0]
    v_pk_mul_f32 v[146:147], v[146:147], v[30:31] op_sel_hi:[1,0]
    v_pk_mul_f32 v[148:149], v[148:149], v[30:31] op_sel_hi:[1,0]
    v_pk_mul_f32 v[150:151], v[150:151], v[30:31] op_sel_hi:[1,0]
    v_pk_mul_f32 v[8:9], v[136:137], v[136:137]
    v_pk_mul_f32 v[10:11], v[138:139], v[138:139]
    v_pk_mul_f32 v[12:13], v[140:141], v[140:141]
    v_pk_mul_f32 v[14:15], v[142:143], v[142:143]
    v_pk_fma_f32 v[8:9], v[8:9], s[80:81], v[34:35] op_sel_hi:[1,0,0]
    v_pk_fma_f32 v[10:11], v[10:11], s[80:81], v[34:35] op_sel_hi:[1,0,0]
    v_pk_fma_f32 v[12:13], v[12:13], s[80:81], v[34:35] op_sel_hi:[1,0,0]
    v_pk_fma_f32 v[14:15], v[14:15], s[80:81], v[34:35] op_sel_hi:[1,0,0]
    v_pk_mul_f32 v[8:9], v[8:9], v[136:137]
    v_pk_mul_f32 v[10:11], v[10:11], v[138:139]
    v_pk_mul_f32 v[12:13], v[12:13], v[140:141]
    v_pk_mul_f32 v[14:15], v[14:15], v[142:143]
    v_exp_f32 v8, v8
    v_exp_f32 v9, v9
    v_exp_f32 v10, v10
    v_exp_f32 v11, v11
    v_exp_f32 v12, v12
    v_exp_f32 v13, v13
    v_exp_f32 v14, v14
    v_exp_f32 v15, v15
    v_pk_mul_f32 v[136:137], v[136:137], v[144:145]
    v_pk_mul_f32 v[138:139], v[138:139], v[146:147]
    v_pk_mul_f32 v[140:141], v[140:141], v[148:149]
    v_pk_mul_f32 v[142:143], v[142:143], v[150:151]
    v_pk_add_f32 v[8:9], v[8:9], 1.0 op_sel_hi:[1,0]
    v_pk_add_f32 v[10:11], v[10:11], 1.0 op_sel_hi:[1,0]
    v_pk_add_f32 v[12:13], v[12:13], 1.0 op_sel_hi:[1,0]
    v_pk_add_f32 v[14:15], v[14:15], 1.0 op_sel_hi:[1,0]
    v_rcp_f32 v8, v8
    v_rcp_f32 v9, v9
    v_rcp_f32 v10, v10
    v_rcp_f32 v11, v11
    v_rcp_f32 v12, v12
    v_rcp_f32 v13, v13
    v_rcp_f32 v14, v14
    v_rcp_f32 v15, v15
    s_nop 0
    v_pk_mul_f32 v[136:137], v[136:137], v[8:9]
    v_pk_mul_f32 v[138:139], v[138:139], v[10:11]
    v_pk_mul_f32 v[140:141], v[140:141], v[12:13]
    v_pk_mul_f32 v[142:143], v[142:143], v[14:15]
    v_cvt_pk_bf16_f32 v144, v136, v137
    v_cvt_pk_bf16_f32 v145, v138, v139
    v_cvt_pk_bf16_f32 v146, v140, v141
    v_cvt_pk_bf16_f32 v147, v142, v143
    buffer_store_dwordx4 v[144:147], v6, s[28:31], s50 offen sc1
    s_add_u32 s50, s74, s61
    s_lshl_b32 s50, s50, 11
    s_add_u32 s50, s50, s53
    v_pk_mul_f32 v[152:153], v[152:153], v[30:31] op_sel_hi:[1,0]
    v_pk_mul_f32 v[154:155], v[154:155], v[30:31] op_sel_hi:[1,0]
    v_pk_mul_f32 v[156:157], v[156:157], v[30:31] op_sel_hi:[1,0]
    v_pk_mul_f32 v[158:159], v[158:159], v[30:31] op_sel_hi:[1,0]
    v_pk_mul_f32 v[160:161], v[160:161], v[30:31] op_sel_hi:[1,0]
    v_pk_mul_f32 v[162:163], v[162:163], v[30:31] op_sel_hi:[1,0]
    v_pk_mul_f32 v[164:165], v[164:165], v[30:31] op_sel_hi:[1,0]
    v_pk_mul_f32 v[166:167], v[166:167], v[30:31] op_sel_hi:[1,0]
    v_pk_mul_f32 v[8:9], v[152:153], v[152:153]
    v_pk_mul_f32 v[10:11], v[154:155], v[154:155]
    v_pk_mul_f32 v[12:13], v[156:157], v[156:157]
    v_pk_mul_f32 v[14:15], v[158:159], v[158:159]
    v_pk_fma_f32 v[8:9], v[8:9], s[80:81], v[34:35] op_sel_hi:[1,0,0]
    v_pk_fma_f32 v[10:11], v[10:11], s[80:81], v[34:35] op_sel_hi:[1,0,0]
    v_pk_fma_f32 v[12:13], v[12:13], s[80:81], v[34:35] op_sel_hi:[1,0,0]
    v_pk_fma_f32 v[14:15], v[14:15], s[80:81], v[34:35] op_sel_hi:[1,0,0]
    v_pk_mul_f32 v[8:9], v[8:9], v[152:153]
    v_pk_mul_f32 v[10:11], v[10:11], v[154:155]
    v_pk_mul_f32 v[12:13], v[12:13], v[156:157]
    v_pk_mul_f32 v[14:15], v[14:15], v[158:159]
    v_exp_f32 v8, v8
    v_exp_f32 v9, v9
    v_exp_f32 v10, v10
    v_exp_f32 v11, v11
    v_exp_f32 v12, v12
    v_exp_f32 v13, v13
    v_exp_f32 v14, v14
    v_exp_f32 v15, v15
    v_pk_mul_f32 v[152:153], v[152:153], v[160:161]
    v_pk_mul_f32 v[154:155], v[154:155], v[162:163]
    v_pk_mul_f32 v[156:157], v[156:157], v[164:165]
    v_pk_mul_f32 v[158:159], v[158:159], v[166:167]
    v_pk_add_f32 v[8:9], v[8:9], 1.0 op_sel_hi:[1,0]
    v_pk_add_f32 v[10:11], v[10:11], 1.0 op_sel_hi:[1,0]
    v_pk_add_f32 v[12:13], v[12:13], 1.0 op_sel_hi:[1,0]
    v_pk_add_f32 v[14:15], v[14:15], 1.0 op_sel_hi:[1,0]
    v_rcp_f32 v8, v8
    v_rcp_f32 v9, v9
    v_rcp_f32 v10, v10
    v_rcp_f32 v11, v11
    v_rcp_f32 v12, v12
    v_rcp_f32 v13, v13
    v_rcp_f32 v14, v14
    v_rcp_f32 v15, v15
    s_nop 0
    v_pk_mul_f32 v[152:153], v[152:153], v[8:9]
    v_pk_mul_f32 v[154:155], v[154:155], v[10:11]
    v_pk_mul_f32 v[156:157], v[156:157], v[12:13]
    v_pk_mul_f32 v[158:159], v[158:159], v[14:15]
    v_cvt_pk_bf16_f32 v160, v152, v153
    v_cvt_pk_bf16_f32 v161, v154, v155
    v_cvt_pk_bf16_f32 v162, v156, v157
    v_cvt_pk_bf16_f32 v163, v158, v159
    buffer_store_dwordx4 v[160:163], v6, s[28:31], s50 offen sc1
    s_setprio 0
    v_mov_b32 v20, v26
    v_mov_b32 v21, v27
    v_mov_b32 v26, v20
    v_mov_b32 v27, v21
    s_xor_b32 s50, s71, 0
    s_lshl_b32 s50, s50, 10
    v_add_u32 v28, s50, v6
    s_xor_b32 s50, s71, 1
    s_lshl_b32 s50, s50, 10
    v_add_u32 v29, s50, v6
    s_mul_i32 s69, s64, 112
    s_add_u32 s69, s69, s66
    s_lshl_b32 s69, s69, 11
    v_lshrrev_b32 v8, 2, v4
    v_lshl_add_u32 v9, v3, 2, v8
    v_lshlrev_b32 v9, 7, v9
    v_and_b32 v10, 3, v4
    v_lshl_add_u32 v9, v10, 3, v9
    v_add_u32 v9, s67, v9
    v_and_b32 v10, 1, v5
    v_lshl_add_u32 v13, v10, 5, v9
    v_xor_b32 v10, s72, v10
    v_lshl_add_u32 v9, v10, 5, v9
    v_lshrrev_b32 v11, 1, v8
    s_xor_b32 s50, s70, 0
    v_xor_b32 v12, s50, v11
    v_lshl_add_u32 v30, v12, 6, v9
    s_xor_b32 s50, s70, 1
    v_xor_b32 v12, s50, v11
    v_lshl_add_u32 v31, v12, 6, v9
    s_xor_b32 s50, s71, 0
    v_xor_b32 v12, s50, v11
    v_lshl_add_u32 v32, v12, 6, v13
    s_xor_b32 s50, s71, 1
    v_xor_b32 v12, s50, v11
    v_lshl_add_u32 v33, v12, 6, v13
    s_lshl_b32 s50, s71, 20
    s_lshl_b32 s51, s64, 10
    s_add_u32 s50, s50, s51
    s_lshl_b32 s51, s65, 7
    s_add_u32 s50, s50, s51
    s_lshl_b32 s51, s70, 6
    s_add_u32 s50, s50, s51
    s_lshl_b32 s51, s72, 5
    s_add_u32 s50, s50, s51
    v_lshlrev_b32 v38, 15, v2
    v_add_u32 v38, s50, v38
    v_lshl_add_u32 v8, v3, 3, v38
    buffer_load_dwordx2 v[34:35], v8, s[4:7], 0 offen
    buffer_load_dwordx2 v[36:37], v8, s[4:7], 0 offen offset:16
    v_lshl_add_u32 v38, v3, 4, v38
    s_waitcnt vmcnt(2)
    v_mov_b32 v16, 18436
    v_mov_b32 v17, 1
    s_mov_b64 s[62:63], exec
    s_mov_b64 exec, 1
    ds_add_rtn_u32 v18, v16, v17
    s_waitcnt lgkmcnt(0)
    v_readfirstlane_b32 s51, v18
    s_lshl_b32 s50, s36, 9
    s_lshl_b32 s52, s37, 5
    s_add_u32 s50, s50, s52
    s_add_u32 s50, s50, 14106624
    s_cmp_eq_u32 s75, 0
    s_cselect_b32 s52, 7, 3
    s_cmp_eq_u32 s51, s52
    s_cbranch_scc0 LLP15
    buffer_store_dword v24, v25, s[28:31], s50 offen sc0 sc1
LLP15:
    s_mov_b64 exec, s[62:63]
    s_add_u32 m0, s67, 16384
    s_add_u32 s56, s68, 131072
    buffer_load_dwordx4 v26, s[16:19], s56 offen lds
    s_add_u32 m0, s67, 17408
    s_add_u32 s56, s68, 139264
    buffer_load_dwordx4 v26, s[16:19], s56 offen lds
    s_add_u32 m0, s67, 18432
    s_add_u32 s56, s68, 147456
    buffer_load_dwordx4 v26, s[16:19], s56 offen lds
    s_add_u32 m0, s67, 19456
    s_add_u32 s56, s68, 155648
    buffer_load_dwordx4 v26, s[16:19], s56 offen lds
    s_add_u32 m0, s67, 20480
    s_add_u32 s56, s68, 163840
    buffer_load_dwordx4 v26, s[16:19], s56 offen lds
    s_add_u32 m0, s67, 21504
    s_add_u32 s56, s68, 172032
    buffer_load_dwordx4 v26, s[16:19], s56 offen lds
    s_add_u32 m0, s67, 22528
    s_add_u32 s56, s68, 180224
    buffer_load_dwordx4 v26, s[16:19], s56 offen lds
    s_add_u32 m0, s67, 23552
    s_add_u32 s56, s68, 188416
    buffer_load_dwordx4 v26, s[16:19], s56 offen lds
    s_add_u32 m0, s67, 24576
    s_add_u32 s56, s68, 196608
    buffer_load_dwordx4 v26, s[16:19], s56 offen lds
    s_add_u32 m0, s67, 25600
    s_add_u32 s56, s68, 204800
    buffer_load_dwordx4 v26, s[16:19], s56 offen lds
    s_add_u32 m0, s67, 26624
    s_add_u32 s56, s68, 212992
    buffer_load_dwordx4 v26, s[16:19], s56 offen lds
    s_add_u32 m0, s67, 27648
    s_add_u32 s56, s68, 221184
    buffer_load_dwordx4 v26, s[16:19], s56 offen lds
    s_add_u32 m0, s67, 28672
    s_add_u32 s56, s68, 229376
    buffer_load_dwordx4 v26, s[16:19], s56 offen lds
    s_add_u32 m0, s67, 29696
    s_add_u32 s56, s68, 237568
    buffer_load_dwordx4 v26, s[16:19], s56 offen lds
    s_add_u32 m0, s67, 30720
    s_add_u32 s56, s68, 245760
    buffer_load_dwordx4 v26, s[16:19], s56 offen lds
    s_add_u32 m0, s67, 31744
    s_add_u32 s56, s68, 253952
    buffer_load_dwordx4 v26, s[16:19], s56 offen lds
    s_cmp_eq_u32 s38, 0
    s_cbranch_scc0 L_XW
    v_lshlrev_b32 v8, 5, v4
    s_lshr_b32 s50, s2, 6
    s_lshl_b32 s50, s50, 9
    s_add_u32 s50, s50, 14094336
    s_lshr_b32 s51, s2, 4
    s_lshl_b32 s51, s51, 9
    s_add_u32 s51, s51, 14098432
    v_add_u32 v9, s51, v8
    v_add_u32 v8, s50, v8
    v_cmp_gt_u32 vcc, 16, v1
    s_mov_b32 s52, 0
    s_nop 0
    v_cndmask_b32 v8, v9, v8, vcc
    s_mov_b32 s57, 0
    s_mov_b64 s[62:63], exec
    s_mov_b32 exec_lo, -1
    s_mov_b32 exec_hi, 0
LP16:
    buffer_load_dword v10, v8, s[28:31], s52 offen sc0 sc1
    s_waitcnt vmcnt(0)
    v_cmp_ne_u32 vcc, s49, v10
    s_nop 0
    s_cmp_eq_u64 vcc, 0
    s_cbranch_scc1 LP16D
    s_add_u32 s57, s57, 1
    s_cmp_lt_u32 s57, 20000
    s_cbranch_scc0 LP16D
    s_sleep 2
    s_branch LP16
LP16D:
    s_mov_b64 exec, s[62:63]
    v_mov_b32 v20, 18464
    v_mov_b32 v21, 1
    ds_write_b32 v20, v21
    s_waitcnt lgkmcnt(0)
    s_branch L_XD
L_XW:
    v_mov_b32 v20, 18464
    s_mov_b32 s57, 0
LLW17:
    ds_read_b32 v22, v20
    s_waitcnt lgkmcnt(0)
    v_readfirstlane_b32 s56, v22
    s_add_u32 s57, s57, 1
    s_cmp_ge_u32 s57, 400000
    s_cbranch_scc1 LLW17D
    s_cmp_ge_u32 s56, 1
    s_cbranch_scc1 LLW17D
    s_sleep 1
    s_branch LLW17
LLW17D:
L_XD:
    v_lshrrev_b32 v8, 3, v1
    v_and_b32 v9, 7, v1
    s_mul_i32 s50, s2, 8448
    s_lshl_b32 s51, s38, 11
    s_add_u32 s52, s50, s51
    s_add_u32 s52, s52, 7340032
    v_lshrrev_b32 v10, 1, v8
    v_xor_b32 v10, v10, v9
    v_lshlrev_b32 v10, 4, v10
    v_lshl_add_u32 v11, v8, 7, v10
    s_add_u32 m0, s51, 0
    s_add_u32 s53, s52, 0
    buffer_load_dwordx4 v11, s[28:31], s53 offen sc1 lds
    v_lshrrev_b32 v10, 1, v8
    v_xor_b32 v10, 4, v10
    v_xor_b32 v10, v10, v9
    v_lshlrev_b32 v10, 4, v10
    v_lshl_add_u32 v12, v8, 7, v10
    s_add_u32 m0, s51, 1024
    s_add_u32 s53, s52, 1024
    buffer_load_dwordx4 v12, s[28:31], s53 offen sc1 lds
    s_add_u32 s53, s51, s50
    s_add_u32 s53, s53, 9568256
    buffer_load_dwordx4 v[72:75], v6, s[28:31], s53 offen offset:0 sc1
    buffer_load_dwordx4 v[76:79], v6, s[28:31], s53 offen offset:1024 sc1
    s_lshl_b32 s44, s38, 4
    v_add_u32 v18, s44, v4
    v_cvt_f32_u32 v18, v18
    v_cvt_f32_u32 v17, v5
    v_mul_f32 v16, 0x3c800000, v18
    v_cos_f32 v8, v16
    v_sin_f32 v9, v16
    s_nop 0
    v_mul_f32 v19, 0x41000000, v17
    v_mul_f32 v19, v19, v16
    v_fract_f32 v19, v19
    v_cos_f32 v10, v19
    v_sin_f32 v11, v19
    s_nop 0
    v_pk_mul_f32 v[12:13], v[10:11], v[8:9] op_sel_hi:[1,0]
    v_pk_fma_f32 v[12:13], v[10:11], v[8:9], v[12:13] op_sel:[1,1,0] op_sel_hi:[0,1,1] neg_lo:[1,0,0]
    v_cvt_pk_bf16_f32 v192, v10, v12
    v_cvt_pk_bf16_f32 v200, v11, v13
    v_pk_mul_f32 v[10:11], v[12:13], v[8:9] op_sel_hi:[1,0]
    v_pk_fma_f32 v[10:11], v[12:13], v[8:9], v[10:11] op_sel:[1,1,0] op_sel_hi:[0,1,1] neg_lo:[1,0,0]
    v_pk_mul_f32 v[12:13], v[10:11], v[8:9] op_sel_hi:[1,0]
    v_pk_fma_f32 v[12:13], v[10:11], v[8:9], v[12:13] op_sel:[1,1,0] op_sel_hi:[0,1,1] neg_lo:[1,0,0]
    v_cvt_pk_bf16_f32 v193, v10, v12
    v_cvt_pk_bf16_f32 v201, v11, v13
    v_pk_mul_f32 v[10:11], v[12:13], v[8:9] op_sel_hi:[1,0]
    v_pk_fma_f32 v[10:11], v[12:13], v[8:9], v[10:11] op_sel:[1,1,0] op_sel_hi:[0,1,1] neg_lo:[1,0,0]
    v_pk_mul_f32 v[12:13], v[10:11], v[8:9] op_sel_hi:[1,0]
    v_pk_fma_f32 v[12:13], v[10:11], v[8:9], v[12:13] op_sel:[1,1,0] op_sel_hi:[0,1,1] neg_lo:[1,0,0]
    v_cvt_pk_bf16_f32 v194, v10, v12
    v_cvt_pk_bf16_f32 v202, v11, v13
    v_pk_mul_f32 v[10:11], v[12:13], v[8:9] op_sel_hi:[1,0]
    v_pk_fma_f32 v[10:11], v[12:13], v[8:9], v[10:11] op_sel:[1,1,0] op_sel_hi:[0,1,1] neg_lo:[1,0,0]
    v_pk_mul_f32 v[12:13], v[10:11], v[8:9] op_sel_hi:[1,0]
    v_pk_fma_f32 v[12:13], v[10:11], v[8:9], v[12:13] op_sel:[1,1,0] op_sel_hi:[0,1,1] neg_lo:[1,0,0]
    v_cvt_pk_bf16_f32 v195, v10, v12
    v_cvt_pk_bf16_f32 v203, v11, v13
    v_mul_f32 v19, 0x41000000, v17
    v_add_f32 v19, 0x42000000, v19
    v_mul_f32 v19, v19, v16
    v_fract_f32 v19, v19
    v_cos_f32 v10, v19
    v_sin_f32 v11, v19
    s_nop 0
    v_pk_mul_f32 v[12:13], v[10:11], v[8:9] op_sel_hi:[1,0]
    v_pk_fma_f32 v[12:13], v[10:11], v[8:9], v[12:13] op_sel:[1,1,0] op_sel_hi:[0,1,1] neg_lo:[1,0,0]
    v_cvt_pk_bf16_f32 v196, v10, v12
    v_cvt_pk_bf16_f32 v204, v11, v13
    v_pk_mul_f32 v[10:11], v[12:13], v[8:9] op_sel_hi:[1,0]
    v_pk_fma_f32 v[10:11], v[12:13], v[8:9], v[10:11] op_sel:[1,1,0] op_sel_hi:[0,1,1] neg_lo:[1,0,0]
    v_pk_mul_f32 v[12:13], v[10:11], v[8:9] op_sel_hi:[1,0]
    v_pk_fma_f32 v[12:13], v[10:11], v[8:9], v[12:13] op_sel:[1,1,0] op_sel_hi:[0,1,1] neg_lo:[1,0,0]
    v_cvt_pk_bf16_f32 v197, v10, v12
    v_cvt_pk_bf16_f32 v205, v11, v13
    v_pk_mul_f32 v[10:11], v[12:13], v[8:9] op_sel_hi:[1,0]
    v_pk_fma_f32 v[10:11], v[12:13], v[8:9], v[10:11] op_sel:[1,1,0] op_sel_hi:[0,1,1] neg_lo:[1,0,0]
    v_pk_mul_f32 v[12:13], v[10:11], v[8:9] op_sel_hi:[1,0]
    v_pk_fma_f32 v[12:13], v[10:11], v[8:9], v[12:13] op_sel:[1,1,0] op_sel_hi:[0,1,1] neg_lo:[1,0,0]
    v_cvt_pk_bf16_f32 v198, v10, v12
    v_cvt_pk_bf16_f32 v206, v11, v13
    v_pk_mul_f32 v[10:11], v[12:13], v[8:9] op_sel_hi:[1,0]
    v_pk_fma_f32 v[10:11], v[12:13], v[8:9], v[10:11] op_sel:[1,1,0] op_sel_hi:[0,1,1] neg_lo:[1,0,0]
    v_pk_mul_f32 v[12:13], v[10:11], v[8:9] op_sel_hi:[1,0]
    v_pk_fma_f32 v[12:13], v[10:11], v[8:9], v[12:13] op_sel:[1,1,0] op_sel_hi:[0,1,1] neg_lo:[1,0,0]
    v_cvt_pk_bf16_f32 v199, v10, v12
    v_cvt_pk_bf16_f32 v207, v11, v13
    v_cvt_f32_u32 v16, v4
    v_mul_f32 v16, 0x3d000000, v16
    v_cos_f32 v8, v16
    v_sin_f32 v9, v16
    s_nop 0
    v_mul_f32 v19, 4.0, v17
    v_mul_f32 v19, v19, v16
    v_fract_f32 v19, v19
    v_cos_f32 v10, v19
    v_sin_f32 v11, v19
    s_nop 0
    v_pk_mul_f32 v[12:13], v[10:11], v[8:9] op_sel_hi:[1,0]
    v_pk_fma_f32 v[12:13], v[10:11], v[8:9], v[12:13] op_sel:[1,1,0] op_sel_hi:[0,1,1] neg_lo:[1,0,0]
    v_cvt_pk_bf16_f32 v208, v10, v12
    v_cvt_pk_bf16_f32 v216, v11, v13
    v_pk_mul_f32 v[10:11], v[12:13], v[8:9] op_sel_hi:[1,0]
    v_pk_fma_f32 v[10:11], v[12:13], v[8:9], v[10:11] op_sel:[1,1,0] op_sel_hi:[0,1,1] neg_lo:[1,0,0]
    v_pk_mul_f32 v[12:13], v[10:11], v[8:9] op_sel_hi:[1,0]
    v_pk_fma_f32 v[12:13], v[10:11], v[8:9], v[12:13] op_sel:[1,1,0] op_sel_hi:[0,1,1] neg_lo:[1,0,0]
    v_cvt_pk_bf16_f32 v209, v10, v12
    v_cvt_pk_bf16_f32 v217, v11, v13
    v_mul_f32 v19, 4.0, v17
    v_add_f32 v19, 0x41800000, v19
    v_mul_f32 v19, v19, v16
    v_fract_f32 v19, v19
    v_cos_f32 v10, v19
    v_sin_f32 v11, v19
    s_nop 0
    v_pk_mul_f32 v[12:13], v[10:11], v[8:9] op_sel_hi:[1,0]
    v_pk_fma_f32 v[12:13], v[10:11], v[8:9], v[12:13] op_sel:[1,1,0] op_sel_hi:[0,1,1] neg_lo:[1,0,0]
    v_cvt_pk_bf16_f32 v210, v10, v12
    v_cvt_pk_bf16_f32 v218, v11, v13
    v_pk_mul_f32 v[10:11], v[12:13], v[8:9] op_sel_hi:[1,0]
    v_pk_fma_f32 v[10:11], v[12:13], v[8:9], v[10:11] op_sel:[1,1,0] op_sel_hi:[0,1,1] neg_lo:[1,0,0]
    v_pk_mul_f32 v[12:13], v[10:11], v[8:9] op_sel_hi:[1,0]
    v_pk_fma_f32 v[12:13], v[10:11], v[8:9], v[12:13] op_sel:[1,1,0] op_sel_hi:[0,1,1] neg_lo:[1,0,0]
    v_cvt_pk_bf16_f32 v211, v10, v12
    v_cvt_pk_bf16_f32 v219, v11, v13
    v_cvt_f32_u32 v16, v4
    v_add_f32 v16, 0x41800000, v16
    v_mul_f32 v16, 0x3d000000, v16
    v_cos_f32 v8, v16
    v_sin_f32 v9, v16
    s_nop 0
    v_mul_f32 v19, 4.0, v17
    v_mul_f32 v19, v19, v16
    v_fract_f32 v19, v19
    v_cos_f32 v10, v19
    v_sin_f32 v11, v19
    s_nop 0
    v_pk_mul_f32 v[12:13], v[10:11], v[8:9] op_sel_hi:[1,0]
    v_pk_fma_f32 v[12:13], v[10:11], v[8:9], v[12:13] op_sel:[1,1,0] op_sel_hi:[0,1,1] neg_lo:[1,0,0]
    v_cvt_pk_bf16_f32 v212, v10, v12
    v_cvt_pk_bf16_f32 v220, v11, v13
    v_pk_mul_f32 v[10:11], v[12:13], v[8:9] op_sel_hi:[1,0]
    v_pk_fma_f32 v[10:11], v[12:13], v[8:9], v[10:11] op_sel:[1,1,0] op_sel_hi:[0,1,1] neg_lo:[1,0,0]
    v_pk_mul_f32 v[12:13], v[10:11], v[8:9] op_sel_hi:[1,0]
    v_pk_fma_f32 v[12:13], v[10:11], v[8:9], v[12:13] op_sel:[1,1,0] op_sel_hi:[0,1,1] neg_lo:[1,0,0]
    v_cvt_pk_bf16_f32 v213, v10, v12
    v_cvt_pk_bf16_f32 v221, v11, v13
    v_mul_f32 v19, 4.0, v17
    v_add_f32 v19, 0x41800000, v19
    v_mul_f32 v19, v19, v16
    v_fract_f32 v19, v19
    v_cos_f32 v10, v19
    v_sin_f32 v11, v19
    s_nop 0
    v_pk_mul_f32 v[12:13], v[10:11], v[8:9] op_sel_hi:[1,0]
    v_pk_fma_f32 v[12:13], v[10:11], v[8:9], v[12:13] op_sel:[1,1,0] op_sel_hi:[0,1,1] neg_lo:[1,0,0]
    v_cvt_pk_bf16_f32 v214, v10, v12
    v_cvt_pk_bf16_f32 v222, v11, v13
    v_pk_mul_f32 v[10:11], v[12:13], v[8:9] op_sel_hi:[1,0]
    v_pk_fma_f32 v[10:11], v[12:13], v[8:9], v[10:11] op_sel:[1,1,0] op_sel_hi:[0,1,1] neg_lo:[1,0,0]
    v_pk_mul_f32 v[12:13], v[10:11], v[8:9] op_sel_hi:[1,0]
    v_pk_fma_f32 v[12:13], v[10:11], v[8:9], v[12:13] op_sel:[1,1,0] op_sel_hi:[0,1,1] neg_lo:[1,0,0]
    v_cvt_pk_bf16_f32 v215, v10, v12
    v_cvt_pk_bf16_f32 v223, v11, v13
    v_mul_f32 v16, 0x3a000000, v18
    s_cmp_eq_u32 s2, 0
    s_mov_b32 s45, 0x3a800000
    s_cselect_b32 s44, s45, 0x3ab504f3
    v_mul_f32 v19, 4.0, v17
    v_mul_f32 v8, v19, v16
    v_add_f32 v9, v8, v16
    v_add_f32 v10, v9, v16
    v_add_f32 v11, v10, v16
    v_cos_f32 v224, v8
    v_cos_f32 v225, v9
    v_cos_f32 v226, v10
    v_cos_f32 v227, v11
    v_sin_f32 v232, v8
    v_sin_f32 v233, v9
    v_sin_f32 v234, v10
    v_sin_f32 v235, v11
    s_nop 0
    v_pk_mul_f32 v[224:225], v[224:225], s[44:45] op_sel_hi:[1,0]
    v_pk_mul_f32 v[232:233], v[232:233], s[44:45] op_sel_hi:[1,0]
    v_pk_mul_f32 v[226:227], v[226:227], s[44:45] op_sel_hi:[1,0]
    v_pk_mul_f32 v[234:235], v[234:235], s[44:45] op_sel_hi:[1,0]
    v_mul_f32 v19, 4.0, v17
    v_add_f32 v19, 0x41800000, v19
    v_mul_f32 v8, v19, v16
    v_add_f32 v9, v8, v16
    v_add_f32 v10, v9, v16
    v_add_f32 v11, v10, v16
    v_cos_f32 v228, v8
    v_cos_f32 v229, v9
    v_cos_f32 v230, v10
    v_cos_f32 v231, v11
    v_sin_f32 v236, v8
    v_sin_f32 v237, v9
    v_sin_f32 v238, v10
    v_sin_f32 v239, v11
    s_nop 0
    v_pk_mul_f32 v[228:229], v[228:229], s[44:45] op_sel_hi:[1,0]
    v_pk_mul_f32 v[236:237], v[236:237], s[44:45] op_sel_hi:[1,0]
    v_pk_mul_f32 v[230:231], v[230:231], s[44:45] op_sel_hi:[1,0]
    v_pk_mul_f32 v[238:239], v[238:239], s[44:45] op_sel_hi:[1,0]
    v_xor_b32 v80, 0x80008000, v200
    v_xor_b32 v88, 0x80008000, v216
    v_xor_b32 v81, 0x80008000, v201
    v_xor_b32 v89, 0x80008000, v217
    v_xor_b32 v82, 0x80008000, v202
    v_xor_b32 v90, 0x80008000, v218
    v_xor_b32 v83, 0x80008000, v203
    v_xor_b32 v91, 0x80008000, v219
    v_xor_b32 v84, 0x80008000, v204
    v_xor_b32 v92, 0x80008000, v220
    v_xor_b32 v85, 0x80008000, v205
    v_xor_b32 v93, 0x80008000, v221
    v_xor_b32 v86, 0x80008000, v206
    v_xor_b32 v94, 0x80008000, v222
    v_xor_b32 v87, 0x80008000, v207
    v_xor_b32 v95, 0x80008000, v223
    v_lshrrev_b32 v13, 1, v4
    v_xor_b32 v13, v13, v5
    v_lshlrev_b32 v14, 7, v4
    v_lshl_add_u32 v16, v13, 4, v14
    v_xor_b32 v13, 4, v13
    v_lshl_add_u32 v17, v13, 4, v14
    s_waitcnt vmcnt(2)
    v_mov_b32 v20, 18448
    v_mov_b32 v21, 1
    s_mov_b64 s[62:63], exec
    s_mov_b64 exec, 1
    ds_add_u32 v20, v21
    s_mov_b64 exec, s[62:63]
    s_mov_b32 s57, 0
L_FA:
    ds_read_b32 v22, v20
    s_waitcnt lgkmcnt(0)
    v_readfirstlane_b32 s56, v22
    s_add_u32 s57, s57, 1
    s_cmp_ge_u32 s57, 100000
    s_cbranch_scc1 L_FAD
    s_cmp_lt_u32 s56, 4
    s_cbranch_scc1 L_FA
L_FAD:
    ds_read_b128 v[40:43], v16 offset:0
    ds_read_b128 v[44:47], v17 offset:0
    ds_read_b128 v[48:51], v16 offset:2048
    ds_read_b128 v[52:55], v17 offset:2048
    ds_read_b128 v[56:59], v16 offset:4096
    ds_read_b128 v[60:63], v17 offset:4096
    ds_read_b128 v[64:67], v16 offset:6144
    ds_read_b128 v[68:71], v17 offset:6144
    s_waitcnt lgkmcnt(0)
    v_mfma_f32_16x16x32_bf16 v[96:99], v[40:43], v[192:195], 0
    v_mfma_f32_16x16x32_bf16 v[104:107], v[56:59], v[192:195], 0
    v_mfma_f32_16x16x32_bf16 v[100:103], v[48:51], v[192:195], 0
    v_mfma_f32_16x16x32_bf16 v[108:111], v[64:67], v[192:195], 0
    v_mfma_f32_16x16x32_bf16 v[96:99], v[44:47], v[196:199], v[96:99]
    v_mfma_f32_16x16x32_bf16 v[104:107], v[60:63], v[196:199], v[104:107]
    v_mfma_f32_16x16x32_bf16 v[100:103], v[52:55], v[196:199], v[100:103]
    v_mfma_f32_16x16x32_bf16 v[108:111], v[68:71], v[196:199], v[108:111]
    v_mfma_f32_16x16x32_bf16 v[96:99], v[56:59], v[200:203], v[96:99]
    v_mfma_f32_16x16x32_bf16 v[104:107], v[40:43], v[80:83], v[104:107]
    v_mfma_f32_16x16x32_bf16 v[100:103], v[64:67], v[200:203], v[100:103]
    v_mfma_f32_16x16x32_bf16 v[108:111], v[48:51], v[80:83], v[108:111]
    v_mfma_f32_16x16x32_bf16 v[96:99], v[60:63], v[204:207], v[96:99]
    v_mfma_f32_16x16x32_bf16 v[104:107], v[44:47], v[84:87], v[104:107]
    v_mfma_f32_16x16x32_bf16 v[100:103], v[68:71], v[204:207], v[100:103]
    v_mfma_f32_16x16x32_bf16 v[108:111], v[52:55], v[84:87], v[108:111]
    s_nop 7
    v_pk_mul_f32 v[8:9], v[96:97], v[224:225]
    v_pk_mul_f32 v[12:13], v[104:105], v[224:225]
    v_pk_mul_f32 v[10:11], v[98:99], v[226:227]
    v_pk_mul_f32 v[14:15], v[106:107], v[226:227]
    v_pk_fma_f32 v[8:9], v[104:105], v[232:233], v[8:9]
    v_pk_fma_f32 v[12:13], v[96:97], v[232:233], v[12:13] neg_lo:[1,0,0] neg_hi:[1,0,0]
    v_pk_fma_f32 v[10:11], v[106:107], v[234:235], v[10:11]
    v_pk_fma_f32 v[14:15], v[98:99], v[234:235], v[14:15] neg_lo:[1,0,0] neg_hi:[1,0,0]
    v_cvt_pk_bf16_f32 v128, v8, v9
    v_cvt_pk_bf16_f32 v129, v10, v11
    v_cvt_pk_bf16_f32 v132, v12, v13
    v_cvt_pk_bf16_f32 v133, v14, v15
    v_pk_mul_f32 v[16:17], v[100:101], v[228:229]
    v_pk_mul_f32 v[20:21], v[108:109], v[228:229]
    v_pk_mul_f32 v[18:19], v[102:103], v[230:231]
    v_pk_mul_f32 v[22:23], v[110:111], v[230:231]
    v_pk_fma_f32 v[16:17], v[108:109], v[236:237], v[16:17]
    v_pk_fma_f32 v[20:21], v[100:101], v[236:237], v[20:21] neg_lo:[1,0,0] neg_hi:[1,0,0]
    v_pk_fma_f32 v[18:19], v[110:111], v[238:239], v[18:19]
    v_pk_fma_f32 v[22:23], v[102:103], v[238:239], v[22:23] neg_lo:[1,0,0] neg_hi:[1,0,0]
    v_cvt_pk_bf16_f32 v130, v16, v17
    v_cvt_pk_bf16_f32 v131, v18, v19
    v_cvt_pk_bf16_f32 v134, v20, v21
    v_cvt_pk_bf16_f32 v135, v22, v23
    s_nop 1
    v_mfma_f32_16x16x32_bf16 v[112:115], v[208:211], v[128:131], 0
    v_mfma_f32_16x16x32_bf16 v[120:123], v[208:211], v[132:135], 0
    v_mfma_f32_16x16x32_bf16 v[116:119], v[212:215], v[128:131], 0
    v_mfma_f32_16x16x32_bf16 v[124:127], v[212:215], v[132:135], 0
    v_mfma_f32_16x16x32_bf16 v[112:115], v[216:219], v[132:135], v[112:115]
    v_mfma_f32_16x16x32_bf16 v[120:123], v[88:91], v[128:131], v[120:123]
    v_mfma_f32_16x16x32_bf16 v[116:119], v[220:223], v[132:135], v[116:119]
    v_mfma_f32_16x16x32_bf16 v[124:127], v[92:95], v[128:131], v[124:127]
    s_waitcnt vmcnt(0)
    v_lshlrev_b32 v96, 16, v72
    v_and_b32 v104, 0xffff0000, v72
    v_lshlrev_b32 v97, 16, v73
    v_and_b32 v105, 0xffff0000, v73
    v_lshlrev_b32 v98, 16, v74
    v_and_b32 v106, 0xffff0000, v74
    v_lshlrev_b32 v99, 16, v75
    v_and_b32 v107, 0xffff0000, v75
    v_lshlrev_b32 v100, 16, v76
    v_and_b32 v108, 0xffff0000, v76
    v_lshlrev_b32 v101, 16, v77
    v_and_b32 v109, 0xffff0000, v77
    v_lshlrev_b32 v102, 16, v78
    v_and_b32 v110, 0xffff0000, v78
    v_lshlrev_b32 v103, 16, v79
    v_and_b32 v111, 0xffff0000, v79
    s_nop 1
    v_pk_mul_f32 v[8:9], v[112:113], v[96:97]
    v_pk_mul_f32 v[12:13], v[120:121], v[96:97]
    v_pk_mul_f32 v[10:11], v[114:115], v[98:99]
    v_pk_mul_f32 v[14:15], v[122:123], v[98:99]
    v_pk_fma_f32 v[8:9], v[120:121], v[104:105], v[8:9] neg_lo:[1,0,0] neg_hi:[1,0,0]
    v_pk_fma_f32 v[12:13], v[112:113], v[104:105], v[12:13]
    v_pk_fma_f32 v[10:11], v[122:123], v[106:107], v[10:11] neg_lo:[1,0,0] neg_hi:[1,0,0]
    v_pk_fma_f32 v[14:15], v[114:115], v[106:107], v[14:15]
    v_cvt_pk_bf16_f32 v128, v8, v9
    v_cvt_pk_bf16_f32 v129, v10, v11
    v_cvt_pk_bf16_f32 v132, v12, v13
    v_cvt_pk_bf16_f32 v133, v14, v15
    v_pk_mul_f32 v[16:17], v[116:117], v[100:101]
    v_pk_mul_f32 v[20:21], v[124:125], v[100:101]
    v_pk_mul_f32 v[18:19], v[118:119], v[102:103]
    v_pk_mul_f32 v[22:23], v[126:127], v[102:103]
    v_pk_fma_f32 v[16:17], v[124:125], v[108:109], v[16:17] neg_lo:[1,0,0] neg_hi:[1,0,0]
    v_pk_fma_f32 v[20:21], v[116:117], v[108:109], v[20:21]
    v_pk_fma_f32 v[18:19], v[126:127], v[110:111], v[18:19] neg_lo:[1,0,0] neg_hi:[1,0,0]
    v_pk_fma_f32 v[22:23], v[118:119], v[110:111], v[22:23]
    v_cvt_pk_bf16_f32 v130, v16, v17
    v_cvt_pk_bf16_f32 v131, v18, v19
    v_cvt_pk_bf16_f32 v134, v20, v21
    v_cvt_pk_bf16_f32 v135, v22, v23
    s_nop 1
    v_mfma_f32_16x16x32_bf16 v[112:115], v[208:211], v[128:131], 0
    v_mfma_f32_16x16x32_bf16 v[120:123], v[208:211], v[132:135], 0
    v_mfma_f32_16x16x32_bf16 v[116:119], v[212:215], v[128:131], 0
    v_mfma_f32_16x16x32_bf16 v[124:127], v[212:215], v[132:135], 0
    v_mfma_f32_16x16x32_bf16 v[112:115], v[88:91], v[132:135], v[112:115]
    v_mfma_f32_16x16x32_bf16 v[120:123], v[216:219], v[128:131], v[120:123]
    v_mfma_f32_16x16x32_bf16 v[116:119], v[92:95], v[132:135], v[116:119]
    v_mfma_f32_16x16x32_bf16 v[124:127], v[220:223], v[128:131], v[124:127]
    s_nop 7
    v_pk_mul_f32 v[8:9], v[112:113], v[224:225]
    v_pk_mul_f32 v[12:13], v[120:121], v[224:225]
    v_pk_mul_f32 v[10:11], v[114:115], v[226:227]
    v_pk_mul_f32 v[14:15], v[122:123], v[226:227]
    v_pk_fma_f32 v[8:9], v[120:121], v[232:233], v[8:9] neg_lo:[1,0,0] neg_hi:[1,0,0]
    v_pk_fma_f32 v[12:13], v[112:113], v[232:233], v[12:13]
    v_pk_fma_f32 v[10:11], v[122:123], v[234:235], v[10:11] neg_lo:[1,0,0] neg_hi:[1,0,0]
    v_pk_fma_f32 v[14:15], v[114:115], v[234:235], v[14:15]
    v_cvt_pk_bf16_f32 v96, v8, v9
    v_cvt_pk_bf16_f32 v97, v10, v11
    v_cvt_pk_bf16_f32 v104, v12, v13
    v_cvt_pk_bf16_f32 v105, v14, v15
    v_pk_mul_f32 v[16:17], v[116:117], v[228:229]
    v_pk_mul_f32 v[20:21], v[124:125], v[228:229]
    v_pk_mul_f32 v[18:19], v[118:119], v[230:231]
    v_pk_mul_f32 v[22:23], v[126:127], v[230:231]
    v_pk_fma_f32 v[16:17], v[124:125], v[236:237], v[16:17] neg_lo:[1,0,0] neg_hi:[1,0,0]
    v_pk_fma_f32 v[20:21], v[116:117], v[236:237], v[20:21]
    v_pk_fma_f32 v[18:19], v[126:127], v[238:239], v[18:19] neg_lo:[1,0,0] neg_hi:[1,0,0]
    v_pk_fma_f32 v[22:23], v[118:119], v[238:239], v[22:23]
    v_cvt_pk_bf16_f32 v100, v16, v17
    v_cvt_pk_bf16_f32 v101, v18, v19
    v_cvt_pk_bf16_f32 v108, v20, v21
    v_cvt_pk_bf16_f32 v109, v22, v23
    s_lshl_b32 s50, s38, 10
    v_lshlrev_b32 v8, 6, v4
    v_lshl_add_u32 v8, v5, 3, v8
    v_add_u32 v8, s50, v8
    ds_write_b64 v8, v[96:97] offset:8192
    ds_write_b64 v8, v[104:105] offset:12288
    ds_write_b64 v8, v[100:101] offset:8224
    ds_write_b64 v8, v[108:109] offset:12320
    s_waitcnt lgkmcnt(0)
    v_mov_b32 v20, 18440
    v_mov_b32 v21, 1
    s_mov_b64 s[62:63], exec
    s_mov_b64 exec, 1
    ds_add_u32 v20, v21
    s_mov_b64 exec, s[62:63]
    s_mov_b32 s57, 0
L_FB:
    ds_read_b32 v22, v20
    s_waitcnt lgkmcnt(0)
    v_readfirstlane_b32 s56, v22
    s_add_u32 s57, s57, 1
    s_cmp_ge_u32 s57, 100000
    s_cbranch_scc1 L_FBD
    s_cmp_lt_u32 s56, 4
    s_cbranch_scc1 L_FB
L_FBD:
    v_lshrrev_b32 v9, 2, v4
    v_lshl_add_u32 v9, v5, 3, v9
    v_lshlrev_b32 v9, 6, v9
    v_and_b32 v10, 3, v4
    v_lshl_add_u32 v9, v10, 3, v9
    ds_read_b64_tr_b16 v[40:41], v9 offset:8192
    ds_read_b64_tr_b16 v[42:43], v9 offset:8448
    ds_read_b64_tr_b16 v[44:45], v9 offset:10240
    ds_read_b64_tr_b16 v[46:47], v9 offset:10496
    ds_read_b64_tr_b16 v[48:49], v9 offset:8224
    ds_read_b64_tr_b16 v[50:51], v9 offset:8480
    ds_read_b64_tr_b16 v[52:53], v9 offset:10272
    ds_read_b64_tr_b16 v[54:55], v9 offset:10528
    ds_read_b64_tr_b16 v[56:57], v9 offset:12288
    ds_read_b64_tr_b16 v[58:59], v9 offset:12544
    ds_read_b64_tr_b16 v[60:61], v9 offset:14336
    ds_read_b64_tr_b16 v[62:63], v9 offset:14592
    ds_read_b64_tr_b16 v[64:65], v9 offset:12320
    ds_read_b64_tr_b16 v[66:67], v9 offset:12576
    ds_read_b64_tr_b16 v[68:69], v9 offset:14368
    ds_read_b64_tr_b16 v[70:71], v9 offset:14624
    s_waitcnt lgkmcnt(0)
    v_mfma_f32_16x16x32_bf16 v[112:115], v[192:195], v[40:43], 0
    v_mfma_f32_16x16x32_bf16 v[120:123], v[192:195], v[56:59], 0
    v_mfma_f32_16x16x32_bf16 v[116:119], v[192:195], v[48:51], 0
    v_mfma_f32_16x16x32_bf16 v[124:127], v[192:195], v[64:67], 0
    v_mfma_f32_16x16x32_bf16 v[112:115], v[196:199], v[44:47], v[112:115]
    v_mfma_f32_16x16x32_bf16 v[120:123], v[196:199], v[60:63], v[120:123]
    v_mfma_f32_16x16x32_bf16 v[116:119], v[196:199], v[52:55], v[116:119]
    v_mfma_f32_16x16x32_bf16 v[124:127], v[196:199], v[68:71], v[124:127]
    v_mfma_f32_16x16x32_bf16 v[112:115], v[80:83], v[56:59], v[112:115]
    v_mfma_f32_16x16x32_bf16 v[120:123], v[200:203], v[40:43], v[120:123]
    v_mfma_f32_16x16x32_bf16 v[116:119], v[80:83], v[64:67], v[116:119]
    v_mfma_f32_16x16x32_bf16 v[124:127], v[200:203], v[48:51], v[124:127]
    v_mfma_f32_16x16x32_bf16 v[112:115], v[84:87], v[60:63], v[112:115]
    v_mfma_f32_16x16x32_bf16 v[120:123], v[204:207], v[44:47], v[120:123]
    v_mfma_f32_16x16x32_bf16 v[116:119], v[84:87], v[68:71], v[116:119]
    v_mfma_f32_16x16x32_bf16 v[124:127], v[204:207], v[52:55], v[124:127]
    s_nop 7
    v_cvt_pk_bf16_f32 v128, v112, v113
    v_cvt_pk_bf16_f32 v129, v114, v115
    v_cvt_pk_bf16_f32 v130, v116, v117
    v_cvt_pk_bf16_f32 v131, v118, v119
    v_cvt_pk_bf16_f32 v132, v120, v121
    v_cvt_pk_bf16_f32 v133, v122, v123
    v_cvt_pk_bf16_f32 v134, v124, v125
    v_cvt_pk_bf16_f32 v135, v126, v127
    s_lshl_b32 s50, s38, 1
    v_lshrrev_b32 v8, 1, v5
    v_add_u32 v8, s50, v8
    v_lshrrev_b32 v9, 1, v4
    v_xor_b32 v8, v8, v9
    v_lshlrev_b32 v8, 4, v8
    v_lshl_add_u32 v8, v4, 7, v8
    v_and_b32 v9, 1, v5
    v_lshl_add_u32 v8, v9, 3, v8
    ds_write_b64 v8, v[128:129] offset:0
    ds_write_b64 v8, v[130:131] offset:2048
    ds_write_b64 v8, v[132:133] offset:4096
    ds_write_b64 v8, v[134:135] offset:6144
    s_waitcnt lgkmcnt(0)
    v_mov_b32 v20, 18452
    v_mov_b32 v21, 1
    s_mov_b64 s[62:63], exec
    s_mov_b64 exec, 1
    ds_add_u32 v20, v21
    s_mov_b64 exec, s[62:63]
    s_mov_b32 s57, 0
L_FC:
    ds_read_b32 v22, v20
    s_waitcnt lgkmcnt(0)
    v_readfirstlane_b32 s56, v22
    s_add_u32 s57, s57, 1
    s_cmp_ge_u32 s57, 100000
    s_cbranch_scc1 L_FCD
    s_cmp_lt_u32 s56, 4
    s_cbranch_scc1 L_FC
L_FCD:
    v_lshrrev_b32 v8, 3, v1
    v_and_b32 v9, 7, v1
    v_lshrrev_b32 v10, 1, v8
    v_xor_b32 v10, v10, v9
    v_lshlrev_b32 v10, 4, v10
    v_lshl_add_u32 v10, v8, 7, v10
    s_lshl_b32 s50, s38, 11
    v_add_u32 v10, s50, v10
    ds_read_b128 v[96:99], v10 offset:0
    v_lshrrev_b32 v10, 1, v8
    v_xor_b32 v10, 4, v10
    v_xor_b32 v10, v10, v9
    v_lshlrev_b32 v10, 4, v10
    v_lshl_add_u32 v10, v8, 7, v10
    s_lshl_b32 s50, s38, 11
    v_add_u32 v10, s50, v10
    ds_read_b128 v[100:103], v10 offset:1024
    s_mul_i32 s50, s2, 8448
    s_lshl_b32 s51, s38, 11
    s_add_u32 s50, s50, s51
    s_add_u32 s50, s50, 11796480
    s_waitcnt lgkmcnt(1)
    buffer_store_dwordx4 v[96:99], v6, s[28:31], s50 offen sc1
    s_waitcnt lgkmcnt(0)
    buffer_store_dwordx4 v[100:103], v6, s[28:31], s50 offen offset:1024 sc1
    s_waitcnt vmcnt(0)
    v_mov_b32 v16, 18444
    v_mov_b32 v17, 1
    s_mov_b64 s[62:63], exec
    s_mov_b64 exec, 1
    ds_add_rtn_u32 v18, v16, v17
    s_waitcnt lgkmcnt(0)
    v_readfirstlane_b32 s51, v18
    s_lshl_b32 s50, s2, 5
    s_add_u32 s50, s50, 14114816
    s_cmp_eq_u32 s51, 3
    s_cbranch_scc0 LLP18
    buffer_store_dword v24, v25, s[28:31], s50 offen sc0 sc1
LLP18:
    s_mov_b64 exec, s[62:63]
    s_branch L_RED2
L_E1:
    s_setprio 1
    s_add_u32 s50, s74, s58
    s_lshl_b32 s50, s50, 11
    s_add_u32 s50, s50, s53
    s_nop 5
    v_pk_mul_f32 v[104:105], v[104:105], v[30:31] op_sel_hi:[1,0]
    v_pk_mul_f32 v[106:107], v[106:107], v[30:31] op_sel_hi:[1,0]
    v_pk_mul_f32 v[108:109], v[108:109], v[30:31] op_sel_hi:[1,0]
    v_pk_mul_f32 v[110:111], v[110:111], v[30:31] op_sel_hi:[1,0]
    v_pk_mul_f32 v[112:113], v[112:113], v[30:31] op_sel_hi:[1,0]
    v_pk_mul_f32 v[114:115], v[114:115], v[30:31] op_sel_hi:[1,0]
    v_pk_mul_f32 v[116:117], v[116:117], v[30:31] op_sel_hi:[1,0]
    v_pk_mul_f32 v[118:119], v[118:119], v[30:31] op_sel_hi:[1,0]
    v_pk_mul_f32 v[8:9], v[104:105], v[104:105]
    v_pk_mul_f32 v[10:11], v[106:107], v[106:107]
    v_pk_mul_f32 v[12:13], v[108:109], v[108:109]
    v_pk_mul_f32 v[14:15], v[110:111], v[110:111]
    v_pk_fma_f32 v[8:9], v[8:9], s[80:81], v[34:35] op_sel_hi:[1,0,0]
    v_pk_fma_f32 v[10:11], v[10:11], s[80:81], v[34:35] op_sel_hi:[1,0,0]
    v_pk_fma_f32 v[12:13], v[12:13], s[80:81], v[34:35] op_sel_hi:[1,0,0]
    v_pk_fma_f32 v[14:15], v[14:15], s[80:81], v[34:35] op_sel_hi:[1,0,0]
    v_pk_mul_f32 v[8:9], v[8:9], v[104:105]
    v_pk_mul_f32 v[10:11], v[10:11], v[106:107]
    v_pk_mul_f32 v[12:13], v[12:13], v[108:109]
    v_pk_mul_f32 v[14:15], v[14:15], v[110:111]
    v_exp_f32 v8, v8
    v_exp_f32 v9, v9
    v_exp_f32 v10, v10
    v_exp_f32 v11, v11
    v_exp_f32 v12, v12
    v_exp_f32 v13, v13
    v_exp_f32 v14, v14
    v_exp_f32 v15, v15
    v_pk_mul_f32 v[104:105], v[104:105], v[112:113]
    v_pk_mul_f32 v[106:107], v[106:107], v[114:115]
    v_pk_mul_f32 v[108:109], v[108:109], v[116:117]
    v_pk_mul_f32 v[110:111], v[110:111], v[118:119]
    v_pk_add_f32 v[8:9], v[8:9], 1.0 op_sel_hi:[1,0]
    v_pk_add_f32 v[10:11], v[10:11], 1.0 op_sel_hi:[1,0]
    v_pk_add_f32 v[12:13], v[12:13], 1.0 op_sel_hi:[1,0]
    v_pk_add_f32 v[14:15], v[14:15], 1.0 op_sel_hi:[1,0]
    v_rcp_f32 v8, v8
    v_rcp_f32 v9, v9
    v_rcp_f32 v10, v10
    v_rcp_f32 v11, v11
    v_rcp_f32 v12, v12
    v_rcp_f32 v13, v13
    v_rcp_f32 v14, v14
    v_rcp_f32 v15, v15
    s_nop 0
    v_pk_mul_f32 v[104:105], v[104:105], v[8:9]
    v_pk_mul_f32 v[106:107], v[106:107], v[10:11]
    v_pk_mul_f32 v[108:109], v[108:109], v[12:13]
    v_pk_mul_f32 v[110:111], v[110:111], v[14:15]
    v_cvt_pk_bf16_f32 v112, v104, v105
    v_cvt_pk_bf16_f32 v113, v106, v107
    v_cvt_pk_bf16_f32 v114, v108, v109
    v_cvt_pk_bf16_f32 v115, v110, v111
    buffer_store_dwordx4 v[112:115], v6, s[28:31], s50 offen sc1
    s_add_u32 s50, s74, s59
    s_lshl_b32 s50, s50, 11
    s_add_u32 s50, s50, s53
    v_pk_mul_f32 v[120:121], v[120:121], v[30:31] op_sel_hi:[1,0]
    v_pk_mul_f32 v[122:123], v[122:123], v[30:31] op_sel_hi:[1,0]
    v_pk_mul_f32 v[124:125], v[124:125], v[30:31] op_sel_hi:[1,0]
    v_pk_mul_f32 v[126:127], v[126:127], v[30:31] op_sel_hi:[1,0]
    v_pk_mul_f32 v[128:129], v[128:129], v[30:31] op_sel_hi:[1,0]
    v_pk_mul_f32 v[130:131], v[130:131], v[30:31] op_sel_hi:[1,0]
    v_pk_mul_f32 v[132:133], v[132:133], v[30:31] op_sel_hi:[1,0]
    v_pk_mul_f32 v[134:135], v[134:135], v[30:31] op_sel_hi:[1,0]
    v_pk_mul_f32 v[8:9], v[120:121], v[120:121]
    v_pk_mul_f32 v[10:11], v[122:123], v[122:123]
    v_pk_mul_f32 v[12:13], v[124:125], v[124:125]
    v_pk_mul_f32 v[14:15], v[126:127], v[126:127]
    v_pk_fma_f32 v[8:9], v[8:9], s[80:81], v[34:35] op_sel_hi:[1,0,0]
    v_pk_fma_f32 v[10:11], v[10:11], s[80:81], v[34:35] op_sel_hi:[1,0,0]
    v_pk_fma_f32 v[12:13], v[12:13], s[80:81], v[34:35] op_sel_hi:[1,0,0]
    v_pk_fma_f32 v[14:15], v[14:15], s[80:81], v[34:35] op_sel_hi:[1,0,0]
    v_pk_mul_f32 v[8:9], v[8:9], v[120:121]
    v_pk_mul_f32 v[10:11], v[10:11], v[122:123]
    v_pk_mul_f32 v[12:13], v[12:13], v[124:125]
    v_pk_mul_f32 v[14:15], v[14:15], v[126:127]
    v_exp_f32 v8, v8
    v_exp_f32 v9, v9
    v_exp_f32 v10, v10
    v_exp_f32 v11, v11
    v_exp_f32 v12, v12
    v_exp_f32 v13, v13
    v_exp_f32 v14, v14
    v_exp_f32 v15, v15
    v_pk_mul_f32 v[120:121], v[120:121], v[128:129]
    v_pk_mul_f32 v[122:123], v[122:123], v[130:131]
    v_pk_mul_f32 v[124:125], v[124:125], v[132:133]
    v_pk_mul_f32 v[126:127], v[126:127], v[134:135]
    v_pk_add_f32 v[8:9], v[8:9], 1.0 op_sel_hi:[1,0]
    v_pk_add_f32 v[10:11], v[10:11], 1.0 op_sel_hi:[1,0]
    v_pk_add_f32 v[12:13], v[12:13], 1.0 op_sel_hi:[1,0]
    v_pk_add_f32 v[14:15], v[14:15], 1.0 op_sel_hi:[1,0]
    v_rcp_f32 v8, v8
    v_rcp_f32 v9, v9
    v_rcp_f32 v10, v10
    v_rcp_f32 v11, v11
    v_rcp_f32 v12, v12
    v_rcp_f32 v13, v13
    v_rcp_f32 v14, v14
    v_rcp_f32 v15, v15
    s_nop 0
    v_pk_mul_f32 v[120:121], v[120:121], v[8:9]
    v_pk_mul_f32 v[122:123], v[122:123], v[10:11]
    v_pk_mul_f32 v[124:125], v[124:125], v[12:13]
    v_pk_mul_f32 v[126:127], v[126:127], v[14:15]
    v_cvt_pk_bf16_f32 v128, v120, v121
    v_cvt_pk_bf16_f32 v129, v122, v123
    v_cvt_pk_bf16_f32 v130, v124, v125
    v_cvt_pk_bf16_f32 v131, v126, v127
    buffer_store_dwordx4 v[128:131], v6, s[28:31], s50 offen sc1
    s_add_u32 s50, s74, s60
    s_lshl_b32 s50, s50, 11
    s_add_u32 s50, s50, s53
    v_pk_mul_f32 v[136:137], v[136:137], v[30:31] op_sel_hi:[1,0]
    v_pk_mul_f32 v[138:139], v[138:139], v[30:31] op_sel_hi:[1,0]
    v_pk_mul_f32 v[140:141], v[140:141], v[30:31] op_sel_hi:[1,0]
    v_pk_mul_f32 v[142:143], v[142:143], v[30:31] op_sel_hi:[1,0]
    v_pk_mul_f32 v[144:145], v[144:145], v[30:31] op_sel_hi:[1,0]
    v_pk_mul_f32 v[146:147], v[146:147], v[30:31] op_sel_hi:[1,0]
    v_pk_mul_f32 v[148:149], v[148:149], v[30:31] op_sel_hi:[1,0]
    v_pk_mul_f32 v[150:151], v[150:151], v[30:31] op_sel_hi:[1,0]
    v_pk_mul_f32 v[8:9], v[136:137], v[136:137]
    v_pk_mul_f32 v[10:11], v[138:139], v[138:139]
    v_pk_mul_f32 v[12:13], v[140:141], v[140:141]
    v_pk_mul_f32 v[14:15], v[142:143], v[142:143]
    v_pk_fma_f32 v[8:9], v[8:9], s[80:81], v[34:35] op_sel_hi:[1,0,0]
    v_pk_fma_f32 v[10:11], v[10:11], s[80:81], v[34:35] op_sel_hi:[1,0,0]
    v_pk_fma_f32 v[12:13], v[12:13], s[80:81], v[34:35] op_sel_hi:[1,0,0]
    v_pk_fma_f32 v[14:15], v[14:15], s[80:81], v[34:35] op_sel_hi:[1,0,0]
    v_pk_mul_f32 v[8:9], v[8:9], v[136:137]
    v_pk_mul_f32 v[10:11], v[10:11], v[138:139]
    v_pk_mul_f32 v[12:13], v[12:13], v[140:141]
    v_pk_mul_f32 v[14:15], v[14:15], v[142:143]
    v_exp_f32 v8, v8
    v_exp_f32 v9, v9
    v_exp_f32 v10, v10
    v_exp_f32 v11, v11
    v_exp_f32 v12, v12
    v_exp_f32 v13, v13
    v_exp_f32 v14, v14
    v_exp_f32 v15, v15
    v_pk_mul_f32 v[136:137], v[136:137], v[144:145]
    v_pk_mul_f32 v[138:139], v[138:139], v[146:147]
    v_pk_mul_f32 v[140:141], v[140:141], v[148:149]
    v_pk_mul_f32 v[142:143], v[142:143], v[150:151]
    v_pk_add_f32 v[8:9], v[8:9], 1.0 op_sel_hi:[1,0]
    v_pk_add_f32 v[10:11], v[10:11], 1.0 op_sel_hi:[1,0]
    v_pk_add_f32 v[12:13], v[12:13], 1.0 op_sel_hi:[1,0]
    v_pk_add_f32 v[14:15], v[14:15], 1.0 op_sel_hi:[1,0]
    v_rcp_f32 v8, v8
    v_rcp_f32 v9, v9
    v_rcp_f32 v10, v10
    v_rcp_f32 v11, v11
    v_rcp_f32 v12, v12
    v_rcp_f32 v13, v13
    v_rcp_f32 v14, v14
    v_rcp_f32 v15, v15
    s_nop 0
    v_pk_mul_f32 v[136:137], v[136:137], v[8:9]
    v_pk_mul_f32 v[138:139], v[138:139], v[10:11]
    v_pk_mul_f32 v[140:141], v[140:141], v[12:13]
    v_pk_mul_f32 v[142:143], v[142:143], v[14:15]
    v_cvt_pk_bf16_f32 v144, v136, v137
    v_cvt_pk_bf16_f32 v145, v138, v139
    v_cvt_pk_bf16_f32 v146, v140, v141
    v_cvt_pk_bf16_f32 v147, v142, v143
    buffer_store_dwordx4 v[144:147], v6, s[28:31], s50 offen sc1
    s_add_u32 s50, s74, s61
    s_lshl_b32 s50, s50, 11
    s_add_u32 s50, s50, s53
    v_pk_mul_f32 v[152:153], v[152:153], v[30:31] op_sel_hi:[1,0]
    v_pk_mul_f32 v[154:155], v[154:155], v[30:31] op_sel_hi:[1,0]
    v_pk_mul_f32 v[156:157], v[156:157], v[30:31] op_sel_hi:[1,0]
    v_pk_mul_f32 v[158:159], v[158:159], v[30:31] op_sel_hi:[1,0]
    v_pk_mul_f32 v[160:161], v[160:161], v[30:31] op_sel_hi:[1,0]
    v_pk_mul_f32 v[162:163], v[162:163], v[30:31] op_sel_hi:[1,0]
    v_pk_mul_f32 v[164:165], v[164:165], v[30:31] op_sel_hi:[1,0]
    v_pk_mul_f32 v[166:167], v[166:167], v[30:31] op_sel_hi:[1,0]
    v_pk_mul_f32 v[8:9], v[152:153], v[152:153]
    v_pk_mul_f32 v[10:11], v[154:155], v[154:155]
    v_pk_mul_f32 v[12:13], v[156:157], v[156:157]
    v_pk_mul_f32 v[14:15], v[158:159], v[158:159]
    v_pk_fma_f32 v[8:9], v[8:9], s[80:81], v[34:35] op_sel_hi:[1,0,0]
    v_pk_fma_f32 v[10:11], v[10:11], s[80:81], v[34:35] op_sel_hi:[1,0,0]
    v_pk_fma_f32 v[12:13], v[12:13], s[80:81], v[34:35] op_sel_hi:[1,0,0]
    v_pk_fma_f32 v[14:15], v[14:15], s[80:81], v[34:35] op_sel_hi:[1,0,0]
    v_pk_mul_f32 v[8:9], v[8:9], v[152:153]
    v_pk_mul_f32 v[10:11], v[10:11], v[154:155]
    v_pk_mul_f32 v[12:13], v[12:13], v[156:157]
    v_pk_mul_f32 v[14:15], v[14:15], v[158:159]
    v_exp_f32 v8, v8
    v_exp_f32 v9, v9
    v_exp_f32 v10, v10
    v_exp_f32 v11, v11
    v_exp_f32 v12, v12
    v_exp_f32 v13, v13
    v_exp_f32 v14, v14
    v_exp_f32 v15, v15
    v_pk_mul_f32 v[152:153], v[152:153], v[160:161]
    v_pk_mul_f32 v[154:155], v[154:155], v[162:163]
    v_pk_mul_f32 v[156:157], v[156:157], v[164:165]
    v_pk_mul_f32 v[158:159], v[158:159], v[166:167]
    v_pk_add_f32 v[8:9], v[8:9], 1.0 op_sel_hi:[1,0]
    v_pk_add_f32 v[10:11], v[10:11], 1.0 op_sel_hi:[1,0]
    v_pk_add_f32 v[12:13], v[12:13], 1.0 op_sel_hi:[1,0]
    v_pk_add_f32 v[14:15], v[14:15], 1.0 op_sel_hi:[1,0]
    v_rcp_f32 v8, v8
    v_rcp_f32 v9, v9
    v_rcp_f32 v10, v10
    v_rcp_f32 v11, v11
    v_rcp_f32 v12, v12
    v_rcp_f32 v13, v13
    v_rcp_f32 v14, v14
    v_rcp_f32 v15, v15
    s_nop 0
    v_pk_mul_f32 v[152:153], v[152:153], v[8:9]
    v_pk_mul_f32 v[154:155], v[154:155], v[10:11]
    v_pk_mul_f32 v[156:157], v[156:157], v[12:13]
    v_pk_mul_f32 v[158:159], v[158:159], v[14:15]
    v_cvt_pk_bf16_f32 v160, v152, v153
    v_cvt_pk_bf16_f32 v161, v154, v155
    v_cvt_pk_bf16_f32 v162, v156, v157
    v_cvt_pk_bf16_f32 v163, v158, v159
    buffer_store_dwordx4 v[160:163], v6, s[28:31], s50 offen sc1
    s_setprio 0
    v_mov_b32 v20, v26
    v_mov_b32 v21, v27
    v_mov_b32 v26, v20
    v_mov_b32 v27, v21
    s_xor_b32 s50, s71, 0
    s_lshl_b32 s50, s50, 10
    v_add_u32 v28, s50, v6
    s_xor_b32 s50, s71, 1
    s_lshl_b32 s50, s50, 10
    v_add_u32 v29, s50, v6
    s_mul_i32 s69, s64, 112
    s_add_u32 s69, s69, s66
    s_lshl_b32 s69, s69, 11
    v_lshrrev_b32 v8, 2, v4
    v_lshl_add_u32 v9, v3, 2, v8
    v_lshlrev_b32 v9, 7, v9
    v_and_b32 v10, 3, v4
    v_lshl_add_u32 v9, v10, 3, v9
    v_add_u32 v9, s67, v9
    v_and_b32 v10, 1, v5
    v_lshl_add_u32 v13, v10, 5, v9
    v_xor_b32 v10, s72, v10
    v_lshl_add_u32 v9, v10, 5, v9
    v_lshrrev_b32 v11, 1, v8
    s_xor_b32 s50, s70, 0
    v_xor_b32 v12, s50, v11
    v_lshl_add_u32 v30, v12, 6, v9
    s_xor_b32 s50, s70, 1
    v_xor_b32 v12, s50, v11
    v_lshl_add_u32 v31, v12, 6, v9
    s_xor_b32 s50, s71, 0
    v_xor_b32 v12, s50, v11
    v_lshl_add_u32 v32, v12, 6, v13
    s_xor_b32 s50, s71, 1
    v_xor_b32 v12, s50, v11
    v_lshl_add_u32 v33, v12, 6, v13
    s_lshl_b32 s50, s71, 20
    s_lshl_b32 s51, s64, 10
    s_add_u32 s50, s50, s51
    s_lshl_b32 s51, s65, 7
    s_add_u32 s50, s50, s51
    s_lshl_b32 s51, s70, 6
    s_add_u32 s50, s50, s51
    s_lshl_b32 s51, s72, 5
    s_add_u32 s50, s50, s51
    v_lshlrev_b32 v38, 15, v2
    v_add_u32 v38, s50, v38
    v_lshl_add_u32 v8, v3, 3, v38
    buffer_load_dwordx2 v[34:35], v8, s[4:7], 0 offen
    buffer_load_dwordx2 v[36:37], v8, s[4:7], 0 offen offset:16
    v_lshl_add_u32 v38, v3, 4, v38
    s_waitcnt vmcnt(2)
    v_mov_b32 v16, 18436
    v_mov_b32 v17, 1
    s_mov_b64 s[62:63], exec
    s_mov_b64 exec, 1
    ds_add_rtn_u32 v18, v16, v17
    s_waitcnt lgkmcnt(0)
    v_readfirstlane_b32 s51, v18
    s_lshl_b32 s50, s36, 9
    s_lshl_b32 s52, s37, 5
    s_add_u32 s50, s50, s52
    s_add_u32 s50, s50, 14106624
    s_cmp_eq_u32 s75, 0
    s_cselect_b32 s52, 7, 3
    s_cmp_eq_u32 s51, s52
    s_cbranch_scc0 LLP19
    buffer_store_dword v24, v25, s[28:31], s50 offen sc0 sc1
LLP19:
    s_mov_b64 exec, s[62:63]
    s_add_u32 m0, s67, 0
    s_add_u32 s56, s68, 0
    buffer_load_dwordx4 v26, s[16:19], s56 offen lds
    s_add_u32 m0, s67, 1024
    s_add_u32 s56, s68, 8192
    buffer_load_dwordx4 v26, s[16:19], s56 offen lds
    s_add_u32 m0, s67, 2048
    s_add_u32 s56, s68, 16384
    buffer_load_dwordx4 v26, s[16:19], s56 offen lds
    s_add_u32 m0, s67, 3072
    s_add_u32 s56, s68, 24576
    buffer_load_dwordx4 v26, s[16:19], s56 offen lds
    s_add_u32 m0, s67, 4096
    s_add_u32 s56, s68, 32768
    buffer_load_dwordx4 v26, s[16:19], s56 offen lds
    s_add_u32 m0, s67, 5120
    s_add_u32 s56, s68, 40960
    buffer_load_dwordx4 v26, s[16:19], s56 offen lds
    s_add_u32 m0, s67, 6144
    s_add_u32 s56, s68, 49152
    buffer_load_dwordx4 v26, s[16:19], s56 offen lds
    s_add_u32 m0, s67, 7168
    s_add_u32 s56, s68, 57344
    buffer_load_dwordx4 v26, s[16:19], s56 offen lds
    s_add_u32 m0, s67, 8192
    s_add_u32 s56, s68, 65536
    buffer_load_dwordx4 v26, s[16:19], s56 offen lds
    s_add_u32 m0, s67, 9216
    s_add_u32 s56, s68, 73728
    buffer_load_dwordx4 v26, s[16:19], s56 offen lds
    s_add_u32 m0, s67, 10240
    s_add_u32 s56, s68, 81920
    buffer_load_dwordx4 v26, s[16:19], s56 offen lds
    s_add_u32 m0, s67, 11264
    s_add_u32 s56, s68, 90112
    buffer_load_dwordx4 v26, s[16:19], s56 offen lds
    s_add_u32 m0, s67, 12288
    s_add_u32 s56, s68, 98304
    buffer_load_dwordx4 v26, s[16:19], s56 offen lds
    s_add_u32 m0, s67, 13312
    s_add_u32 s56, s68, 106496
    buffer_load_dwordx4 v26, s[16:19], s56 offen lds
    s_add_u32 m0, s67, 14336
    s_add_u32 s56, s68, 114688
    buffer_load_dwordx4 v26, s[16:19], s56 offen lds
    s_add_u32 m0, s67, 15360
    s_add_u32 s56, s68, 122880
    buffer_load_dwordx4 v26, s[16:19], s56 offen lds
    s_branch L_E3
L_E2:
    s_setprio 3
    s_waitcnt vmcnt(0)
    v_mov_b32 v30, v184
    s_lshl_b32 s50, s38, 7
    v_lshlrev_b32 v8, 2, v2
    v_add_u32 v8, s50, v8
    ds_write_b32 v8, v30 offset:17408
    v_lshlrev_b32 v9, 4, v3
    v_add_u32 v9, s50, v9
    s_waitcnt lgkmcnt(0)
    ds_read_b128 v[72:75], v9 offset:17408
    ds_read_b128 v[76:79], v9 offset:17440
    ds_read_b128 v[80:83], v9 offset:17472
    ds_read_b128 v[84:87], v9 offset:17504
    v_lshrrev_b32 v11, 2, v1
    v_and_b32 v12, 3, v1
    s_movk_i32 s50, 8448
    v_mul_u32_u24 v10, s50, v11
    v_lshl_add_u32 v10, v12, 4, v10
    v_and_b32 v13, 1, v12
    v_lshlrev_b32 v13, 1, v13
    v_lshrrev_b32 v12, 1, v12
    v_or_b32 v12, v12, v13
    v_lshl_add_u32 v11, v12, 4, v11
    v_lshlrev_b32 v11, 2, v11
    s_lshr_b32 s52, s37, 2
    s_mul_i32 s52, s52, 540672
    s_lshl_b32 s50, s36, 1
    s_lshr_b32 s51, s39, 1
    s_add_u32 s50, s50, s51
    s_lshl_b32 s50, s50, 7
    s_add_u32 s52, s52, s50
    s_and_b32 s50, s39, 1
    s_lshl_b32 s50, s50, 6
    s_add_u32 s52, s52, s50
    s_add_u32 s52, s52, 7340032
    s_waitcnt lgkmcnt(0)
    v_pk_mul_f32 v[104:105], v[104:105], v[72:73]
    v_pk_mul_f32 v[106:107], v[106:107], v[74:75]
    v_pk_mul_f32 v[108:109], v[108:109], v[76:77]
    v_pk_mul_f32 v[110:111], v[110:111], v[78:79]
    v_pk_mul_f32 v[112:113], v[112:113], v[80:81]
    v_pk_mul_f32 v[114:115], v[114:115], v[82:83]
    v_pk_mul_f32 v[116:117], v[116:117], v[84:85]
    v_pk_mul_f32 v[118:119], v[118:119], v[86:87]
    v_cvt_pk_bf16_f32 v88, v104, v105
    v_cvt_pk_bf16_f32 v89, v106, v107
    v_cvt_pk_bf16_f32 v90, v108, v109
    v_cvt_pk_bf16_f32 v91, v110, v111
    v_cvt_pk_bf16_f32 v92, v112, v113
    v_cvt_pk_bf16_f32 v93, v114, v115
    v_cvt_pk_bf16_f32 v94, v116, v117
    v_cvt_pk_bf16_f32 v95, v118, v119
    s_nop 1
    v_permlane32_swap_b32 v88, v90
    v_permlane32_swap_b32 v89, v91
    v_permlane32_swap_b32 v92, v94
    v_permlane32_swap_b32 v93, v95
    s_nop 1
    v_permlane16_swap_b32 v88, v92
    v_permlane16_swap_b32 v89, v93
    v_permlane16_swap_b32 v90, v94
    v_permlane16_swap_b32 v91, v95
    s_nop 0
    ds_bpermute_b32 v104, v11, v88
    ds_bpermute_b32 v105, v11, v89
    ds_bpermute_b32 v106, v11, v90
    ds_bpermute_b32 v107, v11, v91
    ds_bpermute_b32 v108, v11, v92
    ds_bpermute_b32 v109, v11, v93
    ds_bpermute_b32 v110, v11, v94
    ds_bpermute_b32 v111, v11, v95
    s_add_u32 s50, s52, 0
    s_add_u32 s51, s50, 4096
    s_waitcnt lgkmcnt(4)
    buffer_store_dwordx4 v[104:107], v10, s[28:31], s50 offen sc1
    s_waitcnt lgkmcnt(0)
    buffer_store_dwordx4 v[108:111], v10, s[28:31], s51 offen sc1
    v_pk_mul_f32 v[120:121], v[120:121], v[72:73]
    v_pk_mul_f32 v[122:123], v[122:123], v[74:75]
    v_pk_mul_f32 v[124:125], v[124:125], v[76:77]
    v_pk_mul_f32 v[126:127], v[126:127], v[78:79]
    v_pk_mul_f32 v[128:129], v[128:129], v[80:81]
    v_pk_mul_f32 v[130:131], v[130:131], v[82:83]
    v_pk_mul_f32 v[132:133], v[132:133], v[84:85]
    v_pk_mul_f32 v[134:135], v[134:135], v[86:87]
    v_cvt_pk_bf16_f32 v88, v120, v121
    v_cvt_pk_bf16_f32 v89, v122, v123
    v_cvt_pk_bf16_f32 v90, v124, v125
    v_cvt_pk_bf16_f32 v91, v126, v127
    v_cvt_pk_bf16_f32 v92, v128, v129
    v_cvt_pk_bf16_f32 v93, v130, v131
    v_cvt_pk_bf16_f32 v94, v132, v133
    v_cvt_pk_bf16_f32 v95, v134, v135
    s_nop 1
    v_permlane32_swap_b32 v88, v90
    v_permlane32_swap_b32 v89, v91
    v_permlane32_swap_b32 v92, v94
    v_permlane32_swap_b32 v93, v95
    s_nop 1
    v_permlane16_swap_b32 v88, v92
    v_permlane16_swap_b32 v89, v93
    v_permlane16_swap_b32 v90, v94
    v_permlane16_swap_b32 v91, v95
    s_nop 0
    ds_bpermute_b32 v120, v11, v88
    ds_bpermute_b32 v121, v11, v89
    ds_bpermute_b32 v122, v11, v90
    ds_bpermute_b32 v123, v11, v91
    ds_bpermute_b32 v124, v11, v92
    ds_bpermute_b32 v125, v11, v93
    ds_bpermute_b32 v126, v11, v94
    ds_bpermute_b32 v127, v11, v95
    s_add_u32 s50, s52, 135168
    s_add_u32 s51, s50, 4096
    s_waitcnt lgkmcnt(4)
    buffer_store_dwordx4 v[120:123], v10, s[28:31], s50 offen sc1
    s_waitcnt lgkmcnt(0)
    buffer_store_dwordx4 v[124:127], v10, s[28:31], s51 offen sc1
    v_pk_mul_f32 v[136:137], v[136:137], v[72:73]
    v_pk_mul_f32 v[138:139], v[138:139], v[74:75]
    v_pk_mul_f32 v[140:141], v[140:141], v[76:77]
    v_pk_mul_f32 v[142:143], v[142:143], v[78:79]
    v_pk_mul_f32 v[144:145], v[144:145], v[80:81]
    v_pk_mul_f32 v[146:147], v[146:147], v[82:83]
    v_pk_mul_f32 v[148:149], v[148:149], v[84:85]
    v_pk_mul_f32 v[150:151], v[150:151], v[86:87]
    v_cvt_pk_bf16_f32 v88, v136, v137
    v_cvt_pk_bf16_f32 v89, v138, v139
    v_cvt_pk_bf16_f32 v90, v140, v141
    v_cvt_pk_bf16_f32 v91, v142, v143
    v_cvt_pk_bf16_f32 v92, v144, v145
    v_cvt_pk_bf16_f32 v93, v146, v147
    v_cvt_pk_bf16_f32 v94, v148, v149
    v_cvt_pk_bf16_f32 v95, v150, v151
    s_nop 1
    v_permlane32_swap_b32 v88, v90
    v_permlane32_swap_b32 v89, v91
    v_permlane32_swap_b32 v92, v94
    v_permlane32_swap_b32 v93, v95
    s_nop 1
    v_permlane16_swap_b32 v88, v92
    v_permlane16_swap_b32 v89, v93
    v_permlane16_swap_b32 v90, v94
    v_permlane16_swap_b32 v91, v95
    s_nop 0
    ds_bpermute_b32 v136, v11, v88
    ds_bpermute_b32 v137, v11, v89
    ds_bpermute_b32 v138, v11, v90
    ds_bpermute_b32 v139, v11, v91
    ds_bpermute_b32 v140, v11, v92
    ds_bpermute_b32 v141, v11, v93
    ds_bpermute_b32 v142, v11, v94
    ds_bpermute_b32 v143, v11, v95
    s_add_u32 s50, s52, 270336
    s_add_u32 s51, s50, 4096
    s_waitcnt lgkmcnt(4)
    buffer_store_dwordx4 v[136:139], v10, s[28:31], s50 offen sc1
    s_waitcnt lgkmcnt(0)
    buffer_store_dwordx4 v[140:143], v10, s[28:31], s51 offen sc1
    v_pk_mul_f32 v[152:153], v[152:153], v[72:73]
    v_pk_mul_f32 v[154:155], v[154:155], v[74:75]
    v_pk_mul_f32 v[156:157], v[156:157], v[76:77]
    v_pk_mul_f32 v[158:159], v[158:159], v[78:79]
    v_pk_mul_f32 v[160:161], v[160:161], v[80:81]
    v_pk_mul_f32 v[162:163], v[162:163], v[82:83]
    v_pk_mul_f32 v[164:165], v[164:165], v[84:85]
    v_pk_mul_f32 v[166:167], v[166:167], v[86:87]
    v_cvt_pk_bf16_f32 v88, v152, v153
    v_cvt_pk_bf16_f32 v89, v154, v155
    v_cvt_pk_bf16_f32 v90, v156, v157
    v_cvt_pk_bf16_f32 v91, v158, v159
    v_cvt_pk_bf16_f32 v92, v160, v161
    v_cvt_pk_bf16_f32 v93, v162, v163
    v_cvt_pk_bf16_f32 v94, v164, v165
    v_cvt_pk_bf16_f32 v95, v166, v167
    s_nop 1
    v_permlane32_swap_b32 v88, v90
    v_permlane32_swap_b32 v89, v91
    v_permlane32_swap_b32 v92, v94
    v_permlane32_swap_b32 v93, v95
    s_nop 1
    v_permlane16_swap_b32 v88, v92
    v_permlane16_swap_b32 v89, v93
    v_permlane16_swap_b32 v90, v94
    v_permlane16_swap_b32 v91, v95
    s_nop 0
    ds_bpermute_b32 v152, v11, v88
    ds_bpermute_b32 v153, v11, v89
    ds_bpermute_b32 v154, v11, v90
    ds_bpermute_b32 v155, v11, v91
    ds_bpermute_b32 v156, v11, v92
    ds_bpermute_b32 v157, v11, v93
    ds_bpermute_b32 v158, v11, v94
    ds_bpermute_b32 v159, v11, v95
    s_add_u32 s50, s52, 405504
    s_add_u32 s51, s50, 4096
    s_waitcnt lgkmcnt(4)
    buffer_store_dwordx4 v[152:155], v10, s[28:31], s50 offen sc1
    s_waitcnt lgkmcnt(0)
    buffer_store_dwordx4 v[156:159], v10, s[28:31], s51 offen sc1
    s_setprio 0
    s_mul_i32 s66, s39, 28
    s_lshl_b32 s67, s39, 15
    s_add_u32 s67, s67, 32768
    v_lshrrev_b32 v14, 3, v1
    v_and_b32 v15, 7, v1
    v_bfe_u32 v16, v1, 4, 1
    v_lshlrev_b32 v16, 2, v16
    v_xor_b32 v27, v15, v16
    v_lshlrev_b32 v15, 4, v27
    v_lshl_add_u32 v26, v14, 10, v15
    s_lshl_b32 s68, s66, 14
    s_lshl_b32 s50, s65, 7
    s_add_u32 s68, s68, s50
    v_mov_b32 v20, 18460
    s_mov_b32 s57, 0
LLW20:
    ds_read_b32 v22, v20
    s_waitcnt lgkmcnt(0)
    v_readfirstlane_b32 s56, v22
    s_add_u32 s57, s57, 1
    s_cmp_ge_u32 s57, 400000
    s_cbranch_scc1 LLW20D
    s_cmp_ge_u32 s56, 8
    s_cbranch_scc1 LLW20D
    s_branch LLW20
LLW20D:
    v_mov_b32 v20, v26
    v_mov_b32 v21, v27
    v_mov_b32 v26, v20
    v_mov_b32 v27, v21
    s_xor_b32 s50, s71, 0
    s_lshl_b32 s50, s50, 10
    v_add_u32 v28, s50, v6
    s_xor_b32 s50, s71, 1
    s_lshl_b32 s50, s50, 10
    v_add_u32 v29, s50, v6
    s_mul_i32 s69, s64, 112
    s_add_u32 s69, s69, s66
    s_lshl_b32 s69, s69, 11
    v_lshrrev_b32 v8, 2, v4
    v_lshl_add_u32 v9, v3, 2, v8
    v_lshlrev_b32 v9, 7, v9
    v_and_b32 v10, 3, v4
    v_lshl_add_u32 v9, v10, 3, v9
    v_add_u32 v9, s67, v9
    v_and_b32 v10, 1, v5
    v_lshl_add_u32 v13, v10, 5, v9
    v_xor_b32 v10, s72, v10
    v_lshl_add_u32 v9, v10, 5, v9
    v_lshrrev_b32 v11, 1, v8
    s_xor_b32 s50, s70, 0
    v_xor_b32 v12, s50, v11
    v_lshl_add_u32 v30, v12, 6, v9
    s_xor_b32 s50, s70, 1
    v_xor_b32 v12, s50, v11
    v_lshl_add_u32 v31, v12, 6, v9
    s_xor_b32 s50, s71, 0
    v_xor_b32 v12, s50, v11
    v_lshl_add_u32 v32, v12, 6, v13
    s_xor_b32 s50, s71, 1
    v_xor_b32 v12, s50, v11
    v_lshl_add_u32 v33, v12, 6, v13
    s_lshl_b32 s50, s71, 20
    s_lshl_b32 s51, s64, 10
    s_add_u32 s50, s50, s51
    s_lshl_b32 s51, s65, 7
    s_add_u32 s50, s50, s51
    s_lshl_b32 s51, s70, 6
    s_add_u32 s50, s50, s51
    s_lshl_b32 s51, s72, 5
    s_add_u32 s50, s50, s51
    v_lshlrev_b32 v38, 15, v2
    v_add_u32 v38, s50, v38
    v_lshl_add_u32 v8, v3, 3, v38
    buffer_load_dwordx2 v[34:35], v8, s[4:7], 0 offen
    buffer_load_dwordx2 v[36:37], v8, s[4:7], 0 offen offset:16
    v_lshl_add_u32 v38, v3, 4, v38
    s_waitcnt vmcnt(2)
    v_mov_b32 v16, 18432
    v_mov_b32 v17, 1
    s_mov_b64 s[62:63], exec
    s_mov_b64 exec, 1
    ds_add_rtn_u32 v18, v16, v17
    s_waitcnt lgkmcnt(0)
    v_readfirstlane_b32 s51, v18
    s_lshr_b32 s50, s37, 2
    s_lshl_b32 s50, s50, 9
    s_lshl_b32 s52, s36, 5
    s_add_u32 s50, s50, s52
    s_add_u32 s50, s50, 14094336
    s_cmp_eq_u32 s51, 3
    s_cbranch_scc0 LLP21
    buffer_store_dword v24, v25, s[28:31], s50 offen sc0 sc1
LLP21:
    s_mov_b64 exec, s[62:63]
    s_add_u32 m0, s67, 0
    s_add_u32 s56, s68, 0
    buffer_load_dwordx4 v26, s[16:19], s56 offen lds
    s_add_u32 m0, s67, 1024
    s_add_u32 s56, s68, 8192
    buffer_load_dwordx4 v26, s[16:19], s56 offen lds
    s_add_u32 m0, s67, 2048
    s_add_u32 s56, s68, 16384
    buffer_load_dwordx4 v26, s[16:19], s56 offen lds
    s_add_u32 m0, s67, 3072
    s_add_u32 s56, s68, 24576
    buffer_load_dwordx4 v26, s[16:19], s56 offen lds
    s_add_u32 m0, s67, 4096
    s_add_u32 s56, s68, 32768
    buffer_load_dwordx4 v26, s[16:19], s56 offen lds
    s_add_u32 m0, s67, 5120
    s_add_u32 s56, s68, 40960
    buffer_load_dwordx4 v26, s[16:19], s56 offen lds
    s_add_u32 m0, s67, 6144
    s_add_u32 s56, s68, 49152
    buffer_load_dwordx4 v26, s[16:19], s56 offen lds
    s_add_u32 m0, s67, 7168
    s_add_u32 s56, s68, 57344
    buffer_load_dwordx4 v26, s[16:19], s56 offen lds
    s_add_u32 m0, s67, 8192
    s_add_u32 s56, s68, 65536
    buffer_load_dwordx4 v26, s[16:19], s56 offen lds
    s_add_u32 m0, s67, 9216
    s_add_u32 s56, s68, 73728
    buffer_load_dwordx4 v26, s[16:19], s56 offen lds
    s_add_u32 m0, s67, 10240
    s_add_u32 s56, s68, 81920
    buffer_load_dwordx4 v26, s[16:19], s56 offen lds
    s_add_u32 m0, s67, 11264
    s_add_u32 s56, s68, 90112
    buffer_load_dwordx4 v26, s[16:19], s56 offen lds
    s_add_u32 m0, s67, 12288
    s_add_u32 s56, s68, 98304
    buffer_load_dwordx4 v26, s[16:19], s56 offen lds
    s_add_u32 m0, s67, 13312
    s_add_u32 s56, s68, 106496
    buffer_load_dwordx4 v26, s[16:19], s56 offen lds
    s_add_u32 m0, s67, 14336
    s_add_u32 s56, s68, 114688
    buffer_load_dwordx4 v26, s[16:19], s56 offen lds
    s_add_u32 m0, s67, 15360
    s_add_u32 s56, s68, 122880
    buffer_load_dwordx4 v26, s[16:19], s56 offen lds
L_E3:
    s_cmp_eq_u32 s38, 4
    s_cbranch_scc0 LHP22W
    v_lshlrev_b32 v16, 5, v4
    s_lshr_b32 s50, s64, 1
    s_lshl_b32 s50, s50, 9
    s_add_u32 s50, s50, 14106624
    s_mov_b32 s57, 0
    s_mov_b64 s[62:63], exec
    s_mov_b32 exec_lo, 0xffff
    s_mov_b32 exec_hi, 0
LP23:
    buffer_load_dword v17, v16, s[28:31], s50 offen sc0 sc1
    s_waitcnt vmcnt(0)
    v_cmp_ne_u32 vcc, s49, v17
    s_nop 0
    s_cmp_eq_u64 vcc, 0
    s_cbranch_scc1 LP23D
    s_add_u32 s57, s57, 1
    s_cmp_lt_u32 s57, 20000
    s_cbranch_scc0 LP23D
    s_sleep 2
    s_branch LP23
LP23D:
    s_mov_b64 exec, s[62:63]
    v_mov_b32 v20, 18456
    v_mov_b32 v21, 1
    ds_write_b32 v20, v21
    s_waitcnt lgkmcnt(0)
    s_branch LHP22D
LHP22W:
    v_mov_b32 v20, 18456
    s_mov_b32 s57, 0
LLW24:
    ds_read_b32 v22, v20
    s_waitcnt lgkmcnt(0)
    v_readfirstlane_b32 s56, v22
    s_add_u32 s57, s57, 1
    s_cmp_ge_u32 s57, 400000
    s_cbranch_scc1 LLW24D
    s_cmp_ge_u32 s56, 1
    s_cbranch_scc1 LLW24D
    s_sleep 1
    s_branch LLW24
LLW24D:
    s_waitcnt vmcnt(0)
LHP22D:
    s_add_u32 s56, s69, 0
    buffer_load_dwordx4 v[104:107], v28, s[28:31], s56 offen sc1
    buffer_load_dwordx4 v[108:111], v29, s[28:31], s56 offen sc1
    s_add_u32 s56, s69, 2048
    buffer_load_dwordx4 v[112:115], v28, s[28:31], s56 offen sc1
    buffer_load_dwordx4 v[116:119], v29, s[28:31], s56 offen sc1
    s_add_u32 s56, s69, 4096
    buffer_load_dwordx4 v[120:123], v28, s[28:31], s56 offen sc1
    buffer_load_dwordx4 v[124:127], v29, s[28:31], s56 offen sc1
    s_add_u32 s56, s69, 6144
    buffer_load_dwordx4 v[128:131], v28, s[28:31], s56 offen sc1
    buffer_load_dwordx4 v[132:135], v29, s[28:31], s56 offen sc1
    s_add_u32 s56, s69, 8192
    buffer_load_dwordx4 v[136:139], v28, s[28:31], s56 offen sc1
    buffer_load_dwordx4 v[140:143], v29, s[28:31], s56 offen sc1
    s_add_u32 s56, s69, 10240
    buffer_load_dwordx4 v[144:147], v28, s[28:31], s56 offen sc1
    buffer_load_dwordx4 v[148:151], v29, s[28:31], s56 offen sc1
    s_add_u32 s56, s69, 12288
    buffer_load_dwordx4 v[152:155], v28, s[28:31], s56 offen sc1
    buffer_load_dwordx4 v[156:159], v29, s[28:31], s56 offen sc1
    s_add_u32 s56, s69, 14336
    buffer_load_dwordx4 v[160:163], v28, s[28:31], s56 offen sc1
    buffer_load_dwordx4 v[164:167], v29, s[28:31], s56 offen sc1
    ds_read_b64_tr_b16 v[168:169], v30 offset:0
    ds_read_b64_tr_b16 v[170:171], v30 offset:1024
    ds_read_b64_tr_b16 v[172:173], v31 offset:0
    ds_read_b64_tr_b16 v[174:175], v31 offset:1024
    ds_read_b64_tr_b16 v[176:177], v30 offset:2048
    ds_read_b64_tr_b16 v[178:179], v30 offset:3072
    ds_read_b64_tr_b16 v[180:181], v31 offset:2048
    ds_read_b64_tr_b16 v[182:183], v31 offset:3072
    s_waitcnt vmcnt(14)
    s_waitcnt lgkmcnt(6)
    v_mfma_f32_32x32x16_bf16 v[40:55], v[168:171], v[104:107], 0
    s_xor_b32 s44, s70, 0
    s_lshl_b32 s44, s44, 5
    s_lshl_b32 s45, s65, 6
    s_add_u32 s44, s44, s45
    s_lshl_b32 s45, s72, 4
    v_xor_b32 v20, s45, v2
    v_mfma_f32_32x32x16_bf16 v[56:71], v[168:171], v[108:111], 0
    v_add_u32 v20, s44, v20
    v_and_b32 v23, 1, v20
    v_cvt_f32_u32 v20, v20
    v_mul_f32 v20, 0x3b000000, v20
    v_cos_f32 v8, v20
    v_sin_f32 v9, -v20
    s_nop 0
    s_waitcnt lgkmcnt(4)
    v_mfma_f32_32x32x16_bf16 v[72:87], v[172:175], v[104:107], 0
    v_mul_f32 v21, 0x41000000, v20
    v_fract_f32 v21, v21
    v_cos_f32 v10, v21
    v_sin_f32 v11, -v21
    s_nop 0
    v_mul_f32 v21, 0x41800000, v20
    v_mfma_f32_32x32x16_bf16 v[88:103], v[172:175], v[108:111], 0
    v_fract_f32 v21, v21
    v_cos_f32 v12, v21
    v_sin_f32 v13, -v21
    s_nop 0
    s_sub_u32 s44, s38, 4
    s_lshl_b32 s44, s44, 6
    s_add_u32 s56, s69, 16384
    buffer_load_dwordx4 v[104:107], v28, s[28:31], s56 offen sc1
    buffer_load_dwordx4 v[108:111], v29, s[28:31], s56 offen sc1
    s_add_u32 m0, s67, 0
    s_add_u32 s56, s68, 262144
    buffer_load_dwordx4 v26, s[16:19], s56 offen lds
    s_add_u32 m0, s67, 1024
    s_add_u32 s56, s68, 270336
    buffer_load_dwordx4 v26, s[16:19], s56 offen lds
    ds_read_b64_tr_b16 v[168:169], v30 offset:4096
    ds_read_b64_tr_b16 v[170:171], v30 offset:5120
    ds_read_b64_tr_b16 v[172:173], v31 offset:4096
    ds_read_b64_tr_b16 v[174:175], v31 offset:5120
    s_waitcnt vmcnt(16)
    s_waitcnt lgkmcnt(6)
    v_mfma_f32_32x32x16_bf16 v[40:55], v[176:179], v[112:115], v[40:55]
    v_lshlrev_b32 v22, 2, v3
    v_add_u32 v22, s44, v22
    v_cvt_f32_u32 v21, v22
    v_mul_f32 v21, v21, v20
    v_fract_f32 v21, v21
    v_cos_f32 v18, v21
    v_sin_f32 v19, -v21
    s_nop 0
    v_mfma_f32_32x32x16_bf16 v[56:71], v[176:179], v[116:119], v[56:71]
    v_cvt_f32_u32 v22, v23
    v_fma_f32 v22, v22, -2.0, 1.0
    v_mov_b32 v14, v18
    v_mov_b32 v15, v19
    v_mul_f32 v16, v14, v8
    v_mul_f32 v17, v15, v8
    s_waitcnt lgkmcnt(4)
    v_mfma_f32_32x32x16_bf16 v[72:87], v[180:183], v[112:115], v[72:87]
    v_fma_f32 v16, -v15, v9, v16
    v_fma_f32 v17, v14, v9, v17
    s_sub_u32 s44, s38, 4
    v_or_b32 v21, s44, v3
    v_cmp_eq_u32 vcc, 0, v21
    s_nop 1
    v_cndmask_b32 v21, v14, v22, vcc
    v_mfma_f32_32x32x16_bf16 v[88:103], v[180:183], v[116:119], v[88:103]
    v_cvt_pk_bf16_f32 v192, v21, v16
    v_cvt_pk_bf16_f32 v200, v15, v17
    v_mul_f32 v14, v16, v8
    v_mul_f32 v15, v17, v8
    v_fma_f32 v14, -v17, v9, v14
    v_fma_f32 v15, v16, v9, v15
    s_add_u32 s56, s69, 18432
    buffer_load_dwordx4 v[112:115], v28, s[28:31], s56 offen sc1
    buffer_load_dwordx4 v[116:119], v29, s[28:31], s56 offen sc1
    s_add_u32 m0, s67, 2048
    s_add_u32 s56, s68, 278528
    buffer_load_dwordx4 v26, s[16:19], s56 offen lds
    s_add_u32 m0, s67, 3072
    s_add_u32 s56, s68, 286720
    buffer_load_dwordx4 v26, s[16:19], s56 offen lds
    ds_read_b64_tr_b16 v[176:177], v30 offset:6144
    ds_read_b64_tr_b16 v[178:179], v30 offset:7168
    ds_read_b64_tr_b16 v[180:181], v31 offset:6144
    ds_read_b64_tr_b16 v[182:183], v31 offset:7168
    s_waitcnt vmcnt(18)
    s_waitcnt lgkmcnt(6)
    v_mfma_f32_32x32x16_bf16 v[40:55], v[168:171], v[120:123], v[40:55]
    v_mul_f32 v16, v14, v8
    v_mul_f32 v17, v15, v8
    v_fma_f32 v16, -v15, v9, v16
    v_fma_f32 v17, v14, v9, v17
    v_cvt_pk_bf16_f32 v193, v14, v16
    v_cvt_pk_bf16_f32 v201, v15, v17
    v_mfma_f32_32x32x16_bf16 v[56:71], v[168:171], v[124:127], v[56:71]
    v_mul_f32 v14, v18, v10
    v_mul_f32 v15, v19, v10
    v_fma_f32 v14, -v19, v11, v14
    v_fma_f32 v15, v18, v11, v15
    v_mul_f32 v16, v14, v8
    v_mul_f32 v17, v15, v8
    s_waitcnt lgkmcnt(4)
    v_mfma_f32_32x32x16_bf16 v[72:87], v[172:175], v[120:123], v[72:87]
    v_fma_f32 v16, -v15, v9, v16
    v_fma_f32 v17, v14, v9, v17
    v_cvt_pk_bf16_f32 v194, v14, v16
    v_cvt_pk_bf16_f32 v202, v15, v17
    v_mul_f32 v14, v16, v8
    v_mul_f32 v15, v17, v8
    v_mfma_f32_32x32x16_bf16 v[88:103], v[172:175], v[124:127], v[88:103]
    v_fma_f32 v14, -v17, v9, v14
    v_fma_f32 v15, v16, v9, v15
    v_mul_f32 v16, v14, v8
    v_mul_f32 v17, v15, v8
    v_fma_f32 v16, -v15, v9, v16
    v_fma_f32 v17, v14, v9, v17
    s_add_u32 s56, s69, 20480
    buffer_load_dwordx4 v[120:123], v28, s[28:31], s56 offen sc1
    buffer_load_dwordx4 v[124:127], v29, s[28:31], s56 offen sc1
    s_add_u32 m0, s67, 4096
    s_add_u32 s56, s68, 294912
    buffer_load_dwordx4 v26, s[16:19], s56 offen lds
    s_add_u32 m0, s67, 5120
    s_add_u32 s56, s68, 303104
    buffer_load_dwordx4 v26, s[16:19], s56 offen lds
    ds_read_b64_tr_b16 v[168:169], v30 offset:8192
    ds_read_b64_tr_b16 v[170:171], v30 offset:9216
    ds_read_b64_tr_b16 v[172:173], v31 offset:8192
    ds_read_b64_tr_b16 v[174:175], v31 offset:9216
    s_waitcnt vmcnt(20)
    s_waitcnt lgkmcnt(6)
    v_mfma_f32_32x32x16_bf16 v[40:55], v[176:179], v[128:131], v[40:55]
    v_cvt_pk_bf16_f32 v195, v14, v16
    v_cvt_pk_bf16_f32 v203, v15, v17
    v_mul_f32 v14, v18, v12
    v_mul_f32 v15, v19, v12
    v_fma_f32 v14, -v19, v13, v14
    v_fma_f32 v15, v18, v13, v15
    v_mfma_f32_32x32x16_bf16 v[56:71], v[176:179], v[132:135], v[56:71]
    v_mov_b32 v18, v14
    v_mov_b32 v19, v15
    v_mov_b32 v14, v18
    v_mov_b32 v15, v19
    v_mul_f32 v16, v14, v8
    v_mul_f32 v17, v15, v8
    s_waitcnt lgkmcnt(4)
    v_mfma_f32_32x32x16_bf16 v[72:87], v[180:183], v[128:131], v[72:87]
    v_fma_f32 v16, -v15, v9, v16
    v_fma_f32 v17, v14, v9, v17
    v_cvt_pk_bf16_f32 v208, v14, v16
    v_cvt_pk_bf16_f32 v216, v15, v17
    v_mul_f32 v14, v16, v8
    v_mul_f32 v15, v17, v8
    v_mfma_f32_32x32x16_bf16 v[88:103], v[180:183], v[132:135], v[88:103]
    v_fma_f32 v14, -v17, v9, v14
    v_fma_f32 v15, v16, v9, v15
    v_mul_f32 v16, v14, v8
    v_mul_f32 v17, v15, v8
    v_fma_f32 v16, -v15, v9, v16
    v_fma_f32 v17, v14, v9, v17
    s_add_u32 s56, s69, 22528
    buffer_load_dwordx4 v[128:131], v28, s[28:31], s56 offen sc1
    buffer_load_dwordx4 v[132:135], v29, s[28:31], s56 offen sc1
    s_add_u32 m0, s67, 6144
    s_add_u32 s56, s68, 311296
    buffer_load_dwordx4 v26, s[16:19], s56 offen lds
    s_add_u32 m0, s67, 7168
    s_add_u32 s56, s68, 319488
    buffer_load_dwordx4 v26, s[16:19], s56 offen lds
    ds_read_b64_tr_b16 v[176:177], v30 offset:10240
    ds_read_b64_tr_b16 v[178:179], v30 offset:11264
    ds_read_b64_tr_b16 v[180:181], v31 offset:10240
    ds_read_b64_tr_b16 v[182:183], v31 offset:11264
    s_waitcnt vmcnt(22)
    s_waitcnt lgkmcnt(6)
    v_mfma_f32_32x32x16_bf16 v[40:55], v[168:171], v[136:139], v[40:55]
    v_cvt_pk_bf16_f32 v209, v14, v16
    v_cvt_pk_bf16_f32 v217, v15, v17
    v_mul_f32 v14, v18, v10
    v_mul_f32 v15, v19, v10
    v_fma_f32 v14, -v19, v11, v14
    v_fma_f32 v15, v18, v11, v15
    v_mfma_f32_32x32x16_bf16 v[56:71], v[168:171], v[140:143], v[56:71]
    v_mul_f32 v16, v14, v8
    v_mul_f32 v17, v15, v8
    v_fma_f32 v16, -v15, v9, v16
    v_fma_f32 v17, v14, v9, v17
    v_cvt_pk_bf16_f32 v210, v14, v16
    v_cvt_pk_bf16_f32 v218, v15, v17
    s_waitcnt lgkmcnt(4)
    v_mfma_f32_32x32x16_bf16 v[72:87], v[172:175], v[136:139], v[72:87]
    v_mul_f32 v14, v16, v8
    v_mul_f32 v15, v17, v8
    v_fma_f32 v14, -v17, v9, v14
    v_fma_f32 v15, v16, v9, v15
    v_mul_f32 v16, v14, v8
    v_mul_f32 v17, v15, v8
    v_mfma_f32_32x32x16_bf16 v[88:103], v[172:175], v[140:143], v[88:103]
    v_fma_f32 v16, -v15, v9, v16
    v_fma_f32 v17, v14, v9, v17
    v_cvt_pk_bf16_f32 v211, v14, v16
    v_cvt_pk_bf16_f32 v219, v15, v17
    v_mul_f32 v14, v18, v12
    v_mul_f32 v15, v19, v12
    s_add_u32 s56, s69, 24576
    buffer_load_dwordx4 v[136:139], v28, s[28:31], s56 offen sc1
    buffer_load_dwordx4 v[140:143], v29, s[28:31], s56 offen sc1
    s_add_u32 m0, s67, 8192
    s_add_u32 s56, s68, 327680
    buffer_load_dwordx4 v26, s[16:19], s56 offen lds
    s_add_u32 m0, s67, 9216
    s_add_u32 s56, s68, 335872
    buffer_load_dwordx4 v26, s[16:19], s56 offen lds
    ds_read_b64_tr_b16 v[168:169], v30 offset:12288
    ds_read_b64_tr_b16 v[170:171], v30 offset:13312
    ds_read_b64_tr_b16 v[172:173], v31 offset:12288
    ds_read_b64_tr_b16 v[174:175], v31 offset:13312
    s_waitcnt vmcnt(24)
    s_waitcnt lgkmcnt(6)
    v_mfma_f32_32x32x16_bf16 v[40:55], v[176:179], v[144:147], v[40:55]
    v_fma_f32 v14, -v19, v13, v14
    v_fma_f32 v15, v18, v13, v15
    v_mov_b32 v18, v14
    v_mov_b32 v19, v15
    v_mov_b32 v14, v18
    v_mov_b32 v15, v19
    v_mfma_f32_32x32x16_bf16 v[56:71], v[176:179], v[148:151], v[56:71]
    v_mul_f32 v16, v14, v8
    v_mul_f32 v17, v15, v8
    v_fma_f32 v16, -v15, v9, v16
    v_fma_f32 v17, v14, v9, v17
    v_cvt_pk_bf16_f32 v224, v14, v16
    v_cvt_pk_bf16_f32 v232, v15, v17
    s_waitcnt lgkmcnt(4)
    v_mfma_f32_32x32x16_bf16 v[72:87], v[180:183], v[144:147], v[72:87]
    v_mul_f32 v14, v16, v8
    v_mul_f32 v15, v17, v8
    v_fma_f32 v14, -v17, v9, v14
    v_fma_f32 v15, v16, v9, v15
    v_mul_f32 v16, v14, v8
    v_mul_f32 v17, v15, v8
    v_mfma_f32_32x32x16_bf16 v[88:103], v[180:183], v[148:151], v[88:103]
    v_fma_f32 v16, -v15, v9, v16
    v_fma_f32 v17, v14, v9, v17
    v_cvt_pk_bf16_f32 v225, v14, v16
    v_cvt_pk_bf16_f32 v233, v15, v17
    v_mul_f32 v14, v18, v10
    v_mul_f32 v15, v19, v10
    s_add_u32 s56, s69, 26624
    buffer_load_dwordx4 v[144:147], v28, s[28:31], s56 offen sc1
    buffer_load_dwordx4 v[148:151], v29, s[28:31], s56 offen sc1
    s_add_u32 m0, s67, 10240
    s_add_u32 s56, s68, 344064
    buffer_load_dwordx4 v26, s[16:19], s56 offen lds
    s_add_u32 m0, s67, 11264
    s_add_u32 s56, s68, 352256
    buffer_load_dwordx4 v26, s[16:19], s56 offen lds
    ds_read_b64_tr_b16 v[176:177], v30 offset:14336
    ds_read_b64_tr_b16 v[178:179], v30 offset:15360
    ds_read_b64_tr_b16 v[180:181], v31 offset:14336
    ds_read_b64_tr_b16 v[182:183], v31 offset:15360
    s_waitcnt vmcnt(26)
    s_waitcnt lgkmcnt(6)
    v_mfma_f32_32x32x16_bf16 v[40:55], v[168:171], v[152:155], v[40:55]
    v_fma_f32 v14, -v19, v11, v14
    v_fma_f32 v15, v18, v11, v15
    v_mul_f32 v16, v14, v8
    v_mul_f32 v17, v15, v8
    v_fma_f32 v16, -v15, v9, v16
    v_fma_f32 v17, v14, v9, v17
    v_mfma_f32_32x32x16_bf16 v[56:71], v[168:171], v[156:159], v[56:71]
    v_cvt_pk_bf16_f32 v226, v14, v16
    v_cvt_pk_bf16_f32 v234, v15, v17
    v_mul_f32 v14, v16, v8
    v_mul_f32 v15, v17, v8
    v_fma_f32 v14, -v17, v9, v14
    v_fma_f32 v15, v16, v9, v15
    s_waitcnt lgkmcnt(4)
    v_mfma_f32_32x32x16_bf16 v[72:87], v[172:175], v[152:155], v[72:87]
    v_mul_f32 v16, v14, v8
    v_mul_f32 v17, v15, v8
    v_fma_f32 v16, -v15, v9, v16
    v_fma_f32 v17, v14, v9, v17
    v_cvt_pk_bf16_f32 v227, v14, v16
    v_cvt_pk_bf16_f32 v235, v15, v17
    v_mfma_f32_32x32x16_bf16 v[88:103], v[172:175], v[156:159], v[88:103]
    v_mul_f32 v14, v18, v12
    v_mul_f32 v15, v19, v12
    v_fma_f32 v14, -v19, v13, v14
    v_fma_f32 v15, v18, v13, v15
    v_mov_b32 v18, v14
    v_mov_b32 v19, v15
    s_add_u32 s56, s69, 28672
    buffer_load_dwordx4 v[152:155], v28, s[28:31], s56 offen sc1
    buffer_load_dwordx4 v[156:159], v29, s[28:31], s56 offen sc1
    s_add_u32 m0, s67, 12288
    s_add_u32 s56, s68, 360448
    buffer_load_dwordx4 v26, s[16:19], s56 offen lds
    s_add_u32 m0, s67, 13312
    s_add_u32 s56, s68, 368640
    buffer_load_dwordx4 v26, s[16:19], s56 offen lds
    s_waitcnt lgkmcnt(0)
    v_mov_b32 v184, 18448
    s_mov_b32 s57, 0
LLW25:
    ds_read_b32 v186, v184
    s_waitcnt lgkmcnt(0)
    v_readfirstlane_b32 s56, v186
    s_add_u32 s57, s57, 1
    s_cmp_ge_u32 s57, 400000
    s_cbranch_scc1 LLW25D
    s_cmp_ge_u32 s56, 4
    s_cbranch_scc1 LLW25D
    s_branch LLW25
LLW25D:
    ds_read_b64_tr_b16 v[168:169], v30 offset:16384
    ds_read_b64_tr_b16 v[170:171], v30 offset:17408
    ds_read_b64_tr_b16 v[172:173], v31 offset:16384
    ds_read_b64_tr_b16 v[174:175], v31 offset:17408
    s_waitcnt vmcnt(28)
    v_mfma_f32_32x32x16_bf16 v[40:55], v[176:179], v[160:163], v[40:55]
    v_mov_b32 v14, v18
    v_mov_b32 v15, v19
    v_mul_f32 v16, v14, v8
    v_mul_f32 v17, v15, v8
    v_fma_f32 v16, -v15, v9, v16
    v_fma_f32 v17, v14, v9, v17
    v_mfma_f32_32x32x16_bf16 v[56:71], v[176:179], v[164:167], v[56:71]
    v_cvt_pk_bf16_f32 v240, v14, v16
    v_cvt_pk_bf16_f32 v248, v15, v17
    v_mul_f32 v14, v16, v8
    v_mul_f32 v15, v17, v8
    v_fma_f32 v14, -v17, v9, v14
    v_fma_f32 v15, v16, v9, v15
    v_mfma_f32_32x32x16_bf16 v[72:87], v[180:183], v[160:163], v[72:87]
    v_mul_f32 v16, v14, v8
    v_mul_f32 v17, v15, v8
    v_fma_f32 v16, -v15, v9, v16
    v_fma_f32 v17, v14, v9, v17
    v_cvt_pk_bf16_f32 v241, v14, v16
    v_cvt_pk_bf16_f32 v249, v15, v17
    v_mfma_f32_32x32x16_bf16 v[88:103], v[180:183], v[164:167], v[88:103]
    v_mul_f32 v14, v18, v10
    v_mul_f32 v15, v19, v10
    v_fma_f32 v14, -v19, v11, v14
    v_fma_f32 v15, v18, v11, v15
    v_mul_f32 v16, v14, v8
    v_mul_f32 v17, v15, v8
    s_add_u32 s56, s69, 30720
    buffer_load_dwordx4 v[160:163], v28, s[28:31], s56 offen sc1
    buffer_load_dwordx4 v[164:167], v29, s[28:31], s56 offen sc1
    s_add_u32 m0, s67, 14336
    s_add_u32 s56, s68, 376832
    buffer_load_dwordx4 v26, s[16:19], s56 offen lds
    s_add_u32 m0, s67, 15360
    s_add_u32 s56, s68, 385024
    buffer_load_dwordx4 v26, s[16:19], s56 offen lds
    ds_read_b64_tr_b16 v[176:177], v30 offset:18432
    ds_read_b64_tr_b16 v[178:179], v30 offset:19456
    ds_read_b64_tr_b16 v[180:181], v31 offset:18432
    ds_read_b64_tr_b16 v[182:183], v31 offset:19456
    s_waitcnt vmcnt(30)
    s_waitcnt lgkmcnt(6)
    v_mfma_f32_32x32x16_bf16 v[40:55], v[168:171], v[104:107], v[40:55]
    v_fma_f32 v16, -v15, v9, v16
    v_fma_f32 v17, v14, v9, v17
    v_cvt_pk_bf16_f32 v242, v14, v16
    v_cvt_pk_bf16_f32 v250, v15, v17
    v_mul_f32 v14, v16, v8
    v_mul_f32 v15, v17, v8
    v_mfma_f32_32x32x16_bf16 v[56:71], v[168:171], v[108:111], v[56:71]
    v_fma_f32 v14, -v17, v9, v14
    v_fma_f32 v15, v16, v9, v15
    v_mul_f32 v16, v14, v8
    v_mul_f32 v17, v15, v8
    v_fma_f32 v16, -v15, v9, v16
    v_fma_f32 v17, v14, v9, v17
    s_waitcnt lgkmcnt(4)
    v_mfma_f32_32x32x16_bf16 v[72:87], v[172:175], v[104:107], v[72:87]
    v_cvt_pk_bf16_f32 v243, v14, v16
    v_cvt_pk_bf16_f32 v251, v15, v17
    s_xor_b32 s44, s70, 1
    s_lshl_b32 s44, s44, 5
    s_lshl_b32 s45, s65, 6
    s_add_u32 s44, s44, s45
    s_lshl_b32 s45, s72, 4
    v_mfma_f32_32x32x16_bf16 v[88:103], v[172:175], v[108:111], v[88:103]
    v_xor_b32 v20, s45, v2
    v_add_u32 v20, s44, v20
    v_and_b32 v23, 1, v20
    v_cvt_f32_u32 v20, v20
    v_mul_f32 v20, 0x3b000000, v20
    v_cos_f32 v8, v20
    v_sin_f32 v9, -v20
    s_nop 0
    s_add_u32 s56, s69, 32768
    buffer_load_dwordx4 v[104:107], v28, s[28:31], s56 offen sc1
    buffer_load_dwordx4 v[108:111], v29, s[28:31], s56 offen sc1
    s_add_u32 m0, s67, 16384
    s_add_u32 s56, s68, 393216
    buffer_load_dwordx4 v26, s[16:19], s56 offen lds
    s_add_u32 m0, s67, 17408
    s_add_u32 s56, s68, 401408
    buffer_load_dwordx4 v26, s[16:19], s56 offen lds
    ds_read_b64_tr_b16 v[168:169], v30 offset:20480
    ds_read_b64_tr_b16 v[170:171], v30 offset:21504
    ds_read_b64_tr_b16 v[172:173], v31 offset:20480
    ds_read_b64_tr_b16 v[174:175], v31 offset:21504
    s_waitcnt vmcnt(30)
    s_waitcnt lgkmcnt(6)
    v_mfma_f32_32x32x16_bf16 v[40:55], v[176:179], v[112:115], v[40:55]
    v_mul_f32 v21, 0x41000000, v20
    v_fract_f32 v21, v21
    v_cos_f32 v10, v21
    v_sin_f32 v11, -v21
    s_nop 0
    v_mul_f32 v21, 0x41800000, v20
    v_mfma_f32_32x32x16_bf16 v[56:71], v[176:179], v[116:119], v[56:71]
    v_fract_f32 v21, v21
    v_cos_f32 v12, v21
    v_sin_f32 v13, -v21
    s_nop 0
    s_sub_u32 s44, s38, 4
    s_lshl_b32 s44, s44, 6
    s_waitcnt lgkmcnt(4)
    v_mfma_f32_32x32x16_bf16 v[72:87], v[180:183], v[112:115], v[72:87]
    v_lshlrev_b32 v22, 2, v3
    v_add_u32 v22, s44, v22
    v_cvt_f32_u32 v21, v22
    v_mul_f32 v21, v21, v20
    v_fract_f32 v21, v21
    v_cos_f32 v18, v21
    v_sin_f32 v19, -v21
    s_nop 0
    v_mfma_f32_32x32x16_bf16 v[88:103], v[180:183], v[116:119], v[88:103]
    v_cvt_f32_u32 v22, v23
    v_fma_f32 v22, v22, -2.0, 1.0
    v_mov_b32 v14, v18
    v_mov_b32 v15, v19
    v_mul_f32 v16, v14, v8
    v_mul_f32 v17, v15, v8
    s_add_u32 s56, s69, 34816
    buffer_load_dwordx4 v[112:115], v28, s[28:31], s56 offen sc1
    buffer_load_dwordx4 v[116:119], v29, s[28:31], s56 offen sc1
    s_add_u32 m0, s67, 18432
    s_add_u32 s56, s68, 409600
    buffer_load_dwordx4 v26, s[16:19], s56 offen lds
    s_add_u32 m0, s67, 19456
    s_add_u32 s56, s68, 417792
    buffer_load_dwordx4 v26, s[16:19], s56 offen lds
    ds_read_b64_tr_b16 v[176:177], v30 offset:22528
    ds_read_b64_tr_b16 v[178:179], v30 offset:23552
    ds_read_b64_tr_b16 v[180:181], v31 offset:22528
    ds_read_b64_tr_b16 v[182:183], v31 offset:23552
    s_waitcnt vmcnt(30)
    s_waitcnt lgkmcnt(6)
    v_mfma_f32_32x32x16_bf16 v[40:55], v[168:171], v[120:123], v[40:55]
    v_fma_f32 v16, -v15, v9, v16
    v_fma_f32 v17, v14, v9, v17
    s_sub_u32 s44, s38, 4
    v_or_b32 v21, s44, v3
    v_cmp_eq_u32 vcc, 0, v21
    s_nop 1
    v_cndmask_b32 v21, v14, v22, vcc
    v_mfma_f32_32x32x16_bf16 v[56:71], v[168:171], v[124:127], v[56:71]
    v_cvt_pk_bf16_f32 v196, v21, v16
    v_cvt_pk_bf16_f32 v204, v15, v17
    v_mul_f32 v14, v16, v8
    v_mul_f32 v15, v17, v8
    v_fma_f32 v14, -v17, v9, v14
    v_fma_f32 v15, v16, v9, v15
    s_waitcnt lgkmcnt(4)
    v_mfma_f32_32x32x16_bf16 v[72:87], v[172:175], v[120:123], v[72:87]
    v_mul_f32 v16, v14, v8
    v_mul_f32 v17, v15, v8
    v_fma_f32 v16, -v15, v9, v16
    v_fma_f32 v17, v14, v9, v17
    v_cvt_pk_bf16_f32 v197, v14, v16
    v_cvt_pk_bf16_f32 v205, v15, v17
    v_mfma_f32_32x32x16_bf16 v[88:103], v[172:175], v[124:127], v[88:103]
    v_mul_f32 v14, v18, v10
    v_mul_f32 v15, v19, v10
    v_fma_f32 v14, -v19, v11, v14
    v_fma_f32 v15, v18, v11, v15
    v_mul_f32 v16, v14, v8
    v_mul_f32 v17, v15, v8
    s_add_u32 s56, s69, 36864
    buffer_load_dwordx4 v[120:123], v28, s[28:31], s56 offen sc1
    buffer_load_dwordx4 v[124:127], v29, s[28:31], s56 offen sc1
    s_add_u32 m0, s67, 20480
    s_add_u32 s56, s68, 425984
    buffer_load_dwordx4 v26, s[16:19], s56 offen lds
    s_add_u32 m0, s67, 21504
    s_add_u32 s56, s68, 434176
    buffer_load_dwordx4 v26, s[16:19], s56 offen lds
    ds_read_b64_tr_b16 v[168:169], v30 offset:24576
    ds_read_b64_tr_b16 v[170:171], v30 offset:25600
    ds_read_b64_tr_b16 v[172:173], v31 offset:24576
    ds_read_b64_tr_b16 v[174:175], v31 offset:25600
    s_waitcnt vmcnt(30)
    s_waitcnt lgkmcnt(6)
    v_mfma_f32_32x32x16_bf16 v[40:55], v[176:179], v[128:131], v[40:55]
    v_fma_f32 v16, -v15, v9, v16
    v_fma_f32 v17, v14, v9, v17
    v_cvt_pk_bf16_f32 v198, v14, v16
    v_cvt_pk_bf16_f32 v206, v15, v17
    v_mul_f32 v14, v16, v8
    v_mul_f32 v15, v17, v8
    v_mfma_f32_32x32x16_bf16 v[56:71], v[176:179], v[132:135], v[56:71]
    v_fma_f32 v14, -v17, v9, v14
    v_fma_f32 v15, v16, v9, v15
    v_mul_f32 v16, v14, v8
    v_mul_f32 v17, v15, v8
    v_fma_f32 v16, -v15, v9, v16
    v_fma_f32 v17, v14, v9, v17
    s_waitcnt lgkmcnt(4)
    v_mfma_f32_32x32x16_bf16 v[72:87], v[180:183], v[128:131], v[72:87]
    v_cvt_pk_bf16_f32 v199, v14, v16
    v_cvt_pk_bf16_f32 v207, v15, v17
    v_mul_f32 v14, v18, v12
    v_mul_f32 v15, v19, v12
    v_fma_f32 v14, -v19, v13, v14
    v_fma_f32 v15, v18, v13, v15
    v_mfma_f32_32x32x16_bf16 v[88:103], v[180:183], v[132:135], v[88:103]
    v_mov_b32 v18, v14
    v_mov_b32 v19, v15
    v_mov_b32 v14, v18
    v_mov_b32 v15, v19
    v_mul_f32 v16, v14, v8
    v_mul_f32 v17, v15, v8
    s_add_u32 s56, s69, 38912
    buffer_load_dwordx4 v[128:131], v28, s[28:31], s56 offen sc1
    buffer_load_dwordx4 v[132:135], v29, s[28:31], s56 offen sc1
    s_add_u32 m0, s67, 22528
    s_add_u32 s56, s68, 442368
    buffer_load_dwordx4 v26, s[16:19], s56 offen lds
    s_add_u32 m0, s67, 23552
    s_add_u32 s56, s68, 450560
    buffer_load_dwordx4 v26, s[16:19], s56 offen lds
    ds_read_b64_tr_b16 v[176:177], v30 offset:26624
    ds_read_b64_tr_b16 v[178:179], v30 offset:27648
    ds_read_b64_tr_b16 v[180:181], v31 offset:26624
    ds_read_b64_tr_b16 v[182:183], v31 offset:27648
    s_waitcnt vmcnt(30)
    s_waitcnt lgkmcnt(6)
    v_mfma_f32_32x32x16_bf16 v[40:55], v[168:171], v[136:139], v[40:55]
    v_fma_f32 v16, -v15, v9, v16
    v_fma_f32 v17, v14, v9, v17
    v_cvt_pk_bf16_f32 v212, v14, v16
    v_cvt_pk_bf16_f32 v220, v15, v17
    v_mul_f32 v14, v16, v8
    v_mul_f32 v15, v17, v8
    v_mfma_f32_32x32x16_bf16 v[56:71], v[168:171], v[140:143], v[56:71]
    v_fma_f32 v14, -v17, v9, v14
    v_fma_f32 v15, v16, v9, v15
    v_mul_f32 v16, v14, v8
    v_mul_f32 v17, v15, v8
    v_fma_f32 v16, -v15, v9, v16
    v_fma_f32 v17, v14, v9, v17
    s_waitcnt lgkmcnt(4)
    v_mfma_f32_32x32x16_bf16 v[72:87], v[172:175], v[136:139], v[72:87]
    v_cvt_pk_bf16_f32 v213, v14, v16
    v_cvt_pk_bf16_f32 v221, v15, v17
    v_mul_f32 v14, v18, v10
    v_mul_f32 v15, v19, v10
    v_fma_f32 v14, -v19, v11, v14
    v_fma_f32 v15, v18, v11, v15
    v_mfma_f32_32x32x16_bf16 v[88:103], v[172:175], v[140:143], v[88:103]
    v_mul_f32 v16, v14, v8
    v_mul_f32 v17, v15, v8
    v_fma_f32 v16, -v15, v9, v16
    v_fma_f32 v17, v14, v9, v17
    v_cvt_pk_bf16_f32 v214, v14, v16
    v_cvt_pk_bf16_f32 v222, v15, v17
    s_add_u32 s56, s69, 40960
    buffer_load_dwordx4 v[136:139], v28, s[28:31], s56 offen sc1
    buffer_load_dwordx4 v[140:143], v29, s[28:31], s56 offen sc1
    ds_read_b64_tr_b16 v[168:169], v30 offset:28672
    ds_read_b64_tr_b16 v[170:171], v30 offset:29696
    ds_read_b64_tr_b16 v[172:173], v31 offset:28672
    ds_read_b64_tr_b16 v[174:175], v31 offset:29696
    s_waitcnt vmcnt(28)
    s_waitcnt lgkmcnt(6)
    v_mfma_f32_32x32x16_bf16 v[40:55], v[176:179], v[144:147], v[40:55]
    v_mul_f32 v14, v16, v8
    v_mul_f32 v15, v17, v8
    v_fma_f32 v14, -v17, v9, v14
    v_fma_f32 v15, v16, v9, v15
    v_mul_f32 v16, v14, v8
    v_mul_f32 v17, v15, v8
    v_mfma_f32_32x32x16_bf16 v[56:71], v[176:179], v[148:151], v[56:71]
    v_fma_f32 v16, -v15, v9, v16
    v_fma_f32 v17, v14, v9, v17
    v_cvt_pk_bf16_f32 v215, v14, v16
    v_cvt_pk_bf16_f32 v223, v15, v17
    v_mul_f32 v14, v18, v12
    v_mul_f32 v15, v19, v12
    s_waitcnt lgkmcnt(4)
    v_mfma_f32_32x32x16_bf16 v[72:87], v[180:183], v[144:147], v[72:87]
    v_fma_f32 v14, -v19, v13, v14
    v_fma_f32 v15, v18, v13, v15
    v_mov_b32 v18, v14
    v_mov_b32 v19, v15
    v_mov_b32 v14, v18
    v_mov_b32 v15, v19
    v_mfma_f32_32x32x16_bf16 v[88:103], v[180:183], v[148:151], v[88:103]
    v_mul_f32 v16, v14, v8
    v_mul_f32 v17, v15, v8
    v_fma_f32 v16, -v15, v9, v16
    v_fma_f32 v17, v14, v9, v17
    v_cvt_pk_bf16_f32 v228, v14, v16
    v_cvt_pk_bf16_f32 v236, v15, v17
    s_add_u32 s56, s69, 43008
    buffer_load_dwordx4 v[144:147], v28, s[28:31], s56 offen sc1
    buffer_load_dwordx4 v[148:151], v29, s[28:31], s56 offen sc1
    ds_read_b64_tr_b16 v[176:177], v30 offset:30720
    ds_read_b64_tr_b16 v[178:179], v30 offset:31744
    ds_read_b64_tr_b16 v[180:181], v31 offset:30720
    ds_read_b64_tr_b16 v[182:183], v31 offset:31744
    s_waitcnt vmcnt(26)
    s_waitcnt lgkmcnt(6)
    v_mfma_f32_32x32x16_bf16 v[40:55], v[168:171], v[152:155], v[40:55]
    v_mul_f32 v14, v16, v8
    v_mul_f32 v15, v17, v8
    v_fma_f32 v14, -v17, v9, v14
    v_fma_f32 v15, v16, v9, v15
    v_mul_f32 v16, v14, v8
    v_mul_f32 v17, v15, v8
    v_mfma_f32_32x32x16_bf16 v[56:71], v[168:171], v[156:159], v[56:71]
    v_fma_f32 v16, -v15, v9, v16
    v_fma_f32 v17, v14, v9, v17
    v_cvt_pk_bf16_f32 v229, v14, v16
    v_cvt_pk_bf16_f32 v237, v15, v17
    v_mul_f32 v14, v18, v10
    v_mul_f32 v15, v19, v10
    s_waitcnt lgkmcnt(4)
    v_mfma_f32_32x32x16_bf16 v[72:87], v[172:175], v[152:155], v[72:87]
    v_fma_f32 v14, -v19, v11, v14
    v_fma_f32 v15, v18, v11, v15
    v_mul_f32 v16, v14, v8
    v_mul_f32 v17, v15, v8
    v_fma_f32 v16, -v15, v9, v16
    v_fma_f32 v17, v14, v9, v17
    v_mfma_f32_32x32x16_bf16 v[88:103], v[172:175], v[156:159], v[88:103]
    v_cvt_pk_bf16_f32 v230, v14, v16
    v_cvt_pk_bf16_f32 v238, v15, v17
    v_mul_f32 v14, v16, v8
    v_mul_f32 v15, v17, v8
    v_fma_f32 v14, -v17, v9, v14
    v_fma_f32 v15, v16, v9, v15
    s_add_u32 s56, s69, 45056
    buffer_load_dwordx4 v[152:155], v28, s[28:31], s56 offen sc1
    buffer_load_dwordx4 v[156:159], v29, s[28:31], s56 offen sc1
    ds_read_b64_tr_b16 v[168:169], v30 offset:0
    ds_read_b64_tr_b16 v[170:171], v30 offset:1024
    ds_read_b64_tr_b16 v[172:173], v31 offset:0
    ds_read_b64_tr_b16 v[174:175], v31 offset:1024
    s_waitcnt vmcnt(24)
    s_waitcnt lgkmcnt(6)
    v_mfma_f32_32x32x16_bf16 v[40:55], v[176:179], v[160:163], v[40:55]
    v_mul_f32 v16, v14, v8
    v_mul_f32 v17, v15, v8
    v_fma_f32 v16, -v15, v9, v16
    v_fma_f32 v17, v14, v9, v17
    v_cvt_pk_bf16_f32 v231, v14, v16
    v_cvt_pk_bf16_f32 v239, v15, v17
    v_mfma_f32_32x32x16_bf16 v[56:71], v[176:179], v[164:167], v[56:71]
    v_mul_f32 v14, v18, v12
    v_mul_f32 v15, v19, v12
    v_fma_f32 v14, -v19, v13, v14
    v_fma_f32 v15, v18, v13, v15
    v_mov_b32 v18, v14
    v_mov_b32 v19, v15
    s_waitcnt lgkmcnt(4)
    v_mfma_f32_32x32x16_bf16 v[72:87], v[180:183], v[160:163], v[72:87]
    v_mov_b32 v14, v18
    v_mov_b32 v15, v19
    v_mul_f32 v16, v14, v8
    v_mul_f32 v17, v15, v8
    v_fma_f32 v16, -v15, v9, v16
    v_fma_f32 v17, v14, v9, v17
    v_mfma_f32_32x32x16_bf16 v[88:103], v[180:183], v[164:167], v[88:103]
    v_cvt_pk_bf16_f32 v244, v14, v16
    v_cvt_pk_bf16_f32 v252, v15, v17
    v_mul_f32 v14, v16, v8
    v_mul_f32 v15, v17, v8
    v_fma_f32 v14, -v17, v9, v14
    v_fma_f32 v15, v16, v9, v15
    s_add_u32 s56, s69, 47104
    buffer_load_dwordx4 v[160:163], v28, s[28:31], s56 offen sc1
    buffer_load_dwordx4 v[164:167], v29, s[28:31], s56 offen sc1
    ds_read_b64_tr_b16 v[176:177], v30 offset:2048
    ds_read_b64_tr_b16 v[178:179], v30 offset:3072
    ds_read_b64_tr_b16 v[180:181], v31 offset:2048
    ds_read_b64_tr_b16 v[182:183], v31 offset:3072
    s_waitcnt vmcnt(22)
    s_waitcnt lgkmcnt(6)
    v_mfma_f32_32x32x16_bf16 v[40:55], v[168:171], v[104:107], v[40:55]
    v_mul_f32 v16, v14, v8
    v_mul_f32 v17, v15, v8
    v_fma_f32 v16, -v15, v9, v16
    v_fma_f32 v17, v14, v9, v17
    v_cvt_pk_bf16_f32 v245, v14, v16
    v_cvt_pk_bf16_f32 v253, v15, v17
    v_mfma_f32_32x32x16_bf16 v[56:71], v[168:171], v[108:111], v[56:71]
    v_mul_f32 v14, v18, v10
    v_mul_f32 v15, v19, v10
    v_fma_f32 v14, -v19, v11, v14
    v_fma_f32 v15, v18, v11, v15
    v_mul_f32 v16, v14, v8
    v_mul_f32 v17, v15, v8
    s_waitcnt lgkmcnt(4)
    v_mfma_f32_32x32x16_bf16 v[72:87], v[172:175], v[104:107], v[72:87]
    v_fma_f32 v16, -v15, v9, v16
    v_fma_f32 v17, v14, v9, v17
    v_cvt_pk_bf16_f32 v246, v14, v16
    v_cvt_pk_bf16_f32 v254, v15, v17
    v_mul_f32 v14, v16, v8
    v_mul_f32 v15, v17, v8
    v_mfma_f32_32x32x16_bf16 v[88:103], v[172:175], v[108:111], v[88:103]
    v_fma_f32 v14, -v17, v9, v14
    v_fma_f32 v15, v16, v9, v15
    v_mul_f32 v16, v14, v8
    v_mul_f32 v17, v15, v8
    v_fma_f32 v16, -v15, v9, v16
    v_fma_f32 v17, v14, v9, v17
    s_add_u32 s56, s69, 49152
    buffer_load_dwordx4 v[104:107], v28, s[28:31], s56 offen sc1
    buffer_load_dwordx4 v[108:111], v29, s[28:31], s56 offen sc1
    ds_read_b64_tr_b16 v[168:169], v30 offset:4096
    ds_read_b64_tr_b16 v[170:171], v30 offset:5120
    ds_read_b64_tr_b16 v[172:173], v31 offset:4096
    ds_read_b64_tr_b16 v[174:175], v31 offset:5120
    s_waitcnt vmcnt(20)
    s_waitcnt lgkmcnt(6)
    v_mfma_f32_32x32x16_bf16 v[40:55], v[176:179], v[112:115], v[40:55]
    v_cvt_pk_bf16_f32 v247, v14, v16
    v_cvt_pk_bf16_f32 v255, v15, v17
    v_mfma_f32_32x32x16_bf16 v[56:71], v[176:179], v[116:119], v[56:71]
    s_waitcnt lgkmcnt(4)
    v_mfma_f32_32x32x16_bf16 v[72:87], v[180:183], v[112:115], v[72:87]
    v_mfma_f32_32x32x16_bf16 v[88:103], v[180:183], v[116:119], v[88:103]
    s_add_u32 s56, s69, 51200
    buffer_load_dwordx4 v[112:115], v28, s[28:31], s56 offen sc1
    buffer_load_dwordx4 v[116:119], v29, s[28:31], s56 offen sc1
    ds_read_b64_tr_b16 v[176:177], v30 offset:6144
    ds_read_b64_tr_b16 v[178:179], v30 offset:7168
    ds_read_b64_tr_b16 v[180:181], v31 offset:6144
    ds_read_b64_tr_b16 v[182:183], v31 offset:7168
    s_waitcnt vmcnt(18)
    s_waitcnt lgkmcnt(6)
    v_mfma_f32_32x32x16_bf16 v[40:55], v[168:171], v[120:123], v[40:55]
    v_mfma_f32_32x32x16_bf16 v[56:71], v[168:171], v[124:127], v[56:71]
    s_waitcnt lgkmcnt(4)
    v_mfma_f32_32x32x16_bf16 v[72:87], v[172:175], v[120:123], v[72:87]
    v_mfma_f32_32x32x16_bf16 v[88:103], v[172:175], v[124:127], v[88:103]
    s_add_u32 s56, s69, 53248
    buffer_load_dwordx4 v[120:123], v28, s[28:31], s56 offen sc1
    buffer_load_dwordx4 v[124:127], v29, s[28:31], s56 offen sc1
    ds_read_b64_tr_b16 v[168:169], v30 offset:8192
    ds_read_b64_tr_b16 v[170:171], v30 offset:9216
    ds_read_b64_tr_b16 v[172:173], v31 offset:8192
    ds_read_b64_tr_b16 v[174:175], v31 offset:9216
    s_waitcnt vmcnt(16)
    s_waitcnt lgkmcnt(6)
    v_mfma_f32_32x32x16_bf16 v[40:55], v[176:179], v[128:131], v[40:55]
    v_mfma_f32_32x32x16_bf16 v[56:71], v[176:179], v[132:135], v[56:71]
    s_waitcnt lgkmcnt(4)
    v_mfma_f32_32x32x16_bf16 v[72:87], v[180:183], v[128:131], v[72:87]
    v_mfma_f32_32x32x16_bf16 v[88:103], v[180:183], v[132:135], v[88:103]
    s_add_u32 s56, s69, 55296
    buffer_load_dwordx4 v[128:131], v28, s[28:31], s56 offen sc1
    buffer_load_dwordx4 v[132:135], v29, s[28:31], s56 offen sc1
    ds_read_b64_tr_b16 v[176:177], v30 offset:10240
    ds_read_b64_tr_b16 v[178:179], v30 offset:11264
    ds_read_b64_tr_b16 v[180:181], v31 offset:10240
    ds_read_b64_tr_b16 v[182:183], v31 offset:11264
    s_waitcnt vmcnt(14)
    s_waitcnt lgkmcnt(6)
    v_mfma_f32_32x32x16_bf16 v[40:55], v[168:171], v[136:139], v[40:55]
    v_mfma_f32_32x32x16_bf16 v[56:71], v[168:171], v[140:143], v[56:71]
    s_waitcnt lgkmcnt(4)
    v_mfma_f32_32x32x16_bf16 v[72:87], v[172:175], v[136:139], v[72:87]
    v_mfma_f32_32x32x16_bf16 v[88:103], v[172:175], v[140:143], v[88:103]
    ds_read_b64_tr_b16 v[168:169], v30 offset:12288
    ds_read_b64_tr_b16 v[170:171], v30 offset:13312
    ds_read_b64_tr_b16 v[172:173], v31 offset:12288
    ds_read_b64_tr_b16 v[174:175], v31 offset:13312
    s_waitcnt vmcnt(12)
    s_waitcnt lgkmcnt(6)
    v_mfma_f32_32x32x16_bf16 v[40:55], v[176:179], v[144:147], v[40:55]
    v_mfma_f32_32x32x16_bf16 v[56:71], v[176:179], v[148:151], v[56:71]
    s_waitcnt lgkmcnt(4)
    v_mfma_f32_32x32x16_bf16 v[72:87], v[180:183], v[144:147], v[72:87]
    v_mfma_f32_32x32x16_bf16 v[88:103], v[180:183], v[148:151], v[88:103]
    ds_read_b64_tr_b16 v[176:177], v30 offset:14336
    ds_read_b64_tr_b16 v[178:179], v30 offset:15360
    ds_read_b64_tr_b16 v[180:181], v31 offset:14336
    ds_read_b64_tr_b16 v[182:183], v31 offset:15360
    s_waitcnt vmcnt(10)
    s_waitcnt lgkmcnt(6)
    v_mfma_f32_32x32x16_bf16 v[40:55], v[168:171], v[152:155], v[40:55]
    v_mfma_f32_32x32x16_bf16 v[56:71], v[168:171], v[156:159], v[56:71]
    s_waitcnt lgkmcnt(4)
    v_mfma_f32_32x32x16_bf16 v[72:87], v[172:175], v[152:155], v[72:87]
    v_mfma_f32_32x32x16_bf16 v[88:103], v[172:175], v[156:159], v[88:103]
    ds_read_b64_tr_b16 v[168:169], v30 offset:16384
    ds_read_b64_tr_b16 v[170:171], v30 offset:17408
    ds_read_b64_tr_b16 v[172:173], v31 offset:16384
    ds_read_b64_tr_b16 v[174:175], v31 offset:17408
    s_waitcnt vmcnt(8)
    s_waitcnt lgkmcnt(6)
    v_mfma_f32_32x32x16_bf16 v[40:55], v[176:179], v[160:163], v[40:55]
    v_mfma_f32_32x32x16_bf16 v[56:71], v[176:179], v[164:167], v[56:71]
    s_waitcnt lgkmcnt(4)
    v_mfma_f32_32x32x16_bf16 v[72:87], v[180:183], v[160:163], v[72:87]
    v_mfma_f32_32x32x16_bf16 v[88:103], v[180:183], v[164:167], v[88:103]
    ds_read_b64_tr_b16 v[176:177], v30 offset:18432
    ds_read_b64_tr_b16 v[178:179], v30 offset:19456
    ds_read_b64_tr_b16 v[180:181], v31 offset:18432
    ds_read_b64_tr_b16 v[182:183], v31 offset:19456
    s_waitcnt vmcnt(6)
    s_waitcnt lgkmcnt(6)
    v_mfma_f32_32x32x16_bf16 v[40:55], v[168:171], v[104:107], v[40:55]
    v_mfma_f32_32x32x16_bf16 v[56:71], v[168:171], v[108:111], v[56:71]
    s_waitcnt lgkmcnt(4)
    v_mfma_f32_32x32x16_bf16 v[72:87], v[172:175], v[104:107], v[72:87]
    v_mfma_f32_32x32x16_bf16 v[88:103], v[172:175], v[108:111], v[88:103]
    v_lshlrev_b32 v187, 5, v1
    s_lshl_b32 s56, s39, 11
    s_add_u32 s56, s56, 14114816
    buffer_load_dword v188, v187, s[28:31], s56 offen sc0 sc1
    ds_read_b64_tr_b16 v[168:169], v30 offset:20480
    ds_read_b64_tr_b16 v[170:171], v30 offset:21504
    ds_read_b64_tr_b16 v[172:173], v31 offset:20480
    ds_read_b64_tr_b16 v[174:175], v31 offset:21504
    s_waitcnt vmcnt(5)
    s_waitcnt lgkmcnt(6)
    v_mfma_f32_32x32x16_bf16 v[40:55], v[176:179], v[112:115], v[40:55]
    v_mfma_f32_32x32x16_bf16 v[56:71], v[176:179], v[116:119], v[56:71]
    s_waitcnt lgkmcnt(4)
    v_mfma_f32_32x32x16_bf16 v[72:87], v[180:183], v[112:115], v[72:87]
    v_mfma_f32_32x32x16_bf16 v[88:103], v[180:183], v[116:119], v[88:103]
    ds_read_b64_tr_b16 v[176:177], v30 offset:22528
    ds_read_b64_tr_b16 v[178:179], v30 offset:23552
    ds_read_b64_tr_b16 v[180:181], v31 offset:22528
    ds_read_b64_tr_b16 v[182:183], v31 offset:23552
    s_waitcnt vmcnt(3)
    s_waitcnt lgkmcnt(6)
    v_mfma_f32_32x32x16_bf16 v[40:55], v[168:171], v[120:123], v[40:55]
    v_mfma_f32_32x32x16_bf16 v[56:71], v[168:171], v[124:127], v[56:71]
    s_waitcnt lgkmcnt(4)
    v_mfma_f32_32x32x16_bf16 v[72:87], v[172:175], v[120:123], v[72:87]
    v_mfma_f32_32x32x16_bf16 v[88:103], v[172:175], v[124:127], v[88:103]
    s_waitcnt vmcnt(1)
    s_waitcnt lgkmcnt(2)
    v_mfma_f32_32x32x16_bf16 v[40:55], v[176:179], v[128:131], v[40:55]
    v_mfma_f32_32x32x16_bf16 v[56:71], v[176:179], v[132:135], v[56:71]
    s_waitcnt lgkmcnt(0)
    v_mfma_f32_32x32x16_bf16 v[72:87], v[180:183], v[128:131], v[72:87]
    v_mfma_f32_32x32x16_bf16 v[88:103], v[180:183], v[132:135], v[88:103]
    s_waitcnt vmcnt(0)
    v_cmp_ne_u32 vcc, s49, v188
    s_nop 0
    s_cmp_eq_u64 vcc, 0
    s_cbranch_scc1 L_YOK
    v_lshlrev_b32 v19, 5, v1
    s_lshl_b32 s50, s39, 11
    s_add_u32 s50, s50, 14114816
    s_mov_b32 s57, 0
LP26:
    buffer_load_dword v21, v19, s[28:31], s50 offen sc0 sc1
    s_waitcnt vmcnt(0)
    v_cmp_ne_u32 vcc, s49, v21
    s_nop 0
    s_cmp_eq_u64 vcc, 0
    s_cbranch_scc1 LP26D
    s_add_u32 s57, s57, 1
    s_cmp_lt_u32 s57, 20000
    s_cbranch_scc0 LP26D
    s_sleep 2
    s_branch LP26
LP26D:
L_YOK:
    v_lshrrev_b32 v8, 3, v1
    s_movk_i32 s50, 8448
    v_mul_u32_u24 v8, s50, v8
    v_lshl_add_u32 v8, v27, 4, v8
    s_sub_u32 s50, s38, 4
    s_mul_i32 s50, s50, 540672
    s_lshl_b32 s51, s64, 7
    s_add_u32 s50, s50, s51
    s_add_u32 s50, s50, 11796480
    s_add_u32 m0, s67, 0
    s_add_u32 s51, s50, 0
    buffer_load_dwordx4 v8, s[28:31], s51 offen sc1 lds
    s_add_u32 m0, s67, 1024
    s_add_u32 s51, s50, 67584
    buffer_load_dwordx4 v8, s[28:31], s51 offen sc1 lds
    s_add_u32 m0, s67, 2048
    s_add_u32 s51, s50, 4096
    buffer_load_dwordx4 v8, s[28:31], s51 offen sc1 lds
    s_add_u32 m0, s67, 3072
    s_add_u32 s51, s50, 71680
    buffer_load_dwordx4 v8, s[28:31], s51 offen sc1 lds
    s_add_u32 m0, s67, 4096
    s_add_u32 s51, s50, 135168
    buffer_load_dwordx4 v8, s[28:31], s51 offen sc1 lds
    s_add_u32 m0, s67, 5120
    s_add_u32 s51, s50, 202752
    buffer_load_dwordx4 v8, s[28:31], s51 offen sc1 lds
    s_add_u32 m0, s67, 6144
    s_add_u32 s51, s50, 139264
    buffer_load_dwordx4 v8, s[28:31], s51 offen sc1 lds
    s_add_u32 m0, s67, 7168
    s_add_u32 s51, s50, 206848
    buffer_load_dwordx4 v8, s[28:31], s51 offen sc1 lds
    s_add_u32 m0, s67, 8192
    s_add_u32 s51, s50, 270336
    buffer_load_dwordx4 v8, s[28:31], s51 offen sc1 lds
    s_add_u32 m0, s67, 9216
    s_add_u32 s51, s50, 337920
    buffer_load_dwordx4 v8, s[28:31], s51 offen sc1 lds
    s_add_u32 m0, s67, 10240
    s_add_u32 s51, s50, 274432
    buffer_load_dwordx4 v8, s[28:31], s51 offen sc1 lds
    s_add_u32 m0, s67, 11264
    s_add_u32 s51, s50, 342016
    buffer_load_dwordx4 v8, s[28:31], s51 offen sc1 lds
    s_add_u32 m0, s67, 12288
    s_add_u32 s51, s50, 405504
    buffer_load_dwordx4 v8, s[28:31], s51 offen sc1 lds
    s_add_u32 m0, s67, 13312
    s_add_u32 s51, s50, 473088
    buffer_load_dwordx4 v8, s[28:31], s51 offen sc1 lds
    s_add_u32 m0, s67, 14336
    s_add_u32 s51, s50, 409600
    buffer_load_dwordx4 v8, s[28:31], s51 offen sc1 lds
    s_add_u32 m0, s67, 15360
    s_add_u32 s51, s50, 477184
    buffer_load_dwordx4 v8, s[28:31], s51 offen sc1 lds
    s_waitcnt vmcnt(14)
    ds_read_b64_tr_b16 v[168:169], v32 offset:0
    ds_read_b64_tr_b16 v[170:171], v32 offset:1024
    ds_read_b64_tr_b16 v[172:173], v33 offset:0
    ds_read_b64_tr_b16 v[174:175], v33 offset:1024
    s_waitcnt vmcnt(12)
    ds_read_b64_tr_b16 v[176:177], v32 offset:2048
    ds_read_b64_tr_b16 v[178:179], v32 offset:3072
    ds_read_b64_tr_b16 v[180:181], v33 offset:2048
    ds_read_b64_tr_b16 v[182:183], v33 offset:3072
    s_waitcnt lgkmcnt(4)
    v_mfma_f32_32x32x16_bf16 v[40:55], v[192:195], v[168:171], v[40:55]
    v_mfma_f32_32x32x16_bf16 v[56:71], v[192:195], v[172:175], v[56:71]
    v_mfma_f32_32x32x16_bf16 v[72:87], v[196:199], v[168:171], v[72:87]
    v_mfma_f32_32x32x16_bf16 v[88:103], v[196:199], v[172:175], v[88:103]
    s_waitcnt vmcnt(10)
    ds_read_b64_tr_b16 v[168:169], v32 offset:4096
    ds_read_b64_tr_b16 v[170:171], v32 offset:5120
    ds_read_b64_tr_b16 v[172:173], v33 offset:4096
    ds_read_b64_tr_b16 v[174:175], v33 offset:5120
    s_waitcnt lgkmcnt(4)
    v_mfma_f32_32x32x16_bf16 v[40:55], v[200:203], v[176:179], v[40:55]
    v_mfma_f32_32x32x16_bf16 v[56:71], v[200:203], v[180:183], v[56:71]
    v_mfma_f32_32x32x16_bf16 v[72:87], v[204:207], v[176:179], v[72:87]
    v_mfma_f32_32x32x16_bf16 v[88:103], v[204:207], v[180:183], v[88:103]
    s_waitcnt vmcnt(8)
    ds_read_b64_tr_b16 v[176:177], v32 offset:6144
    ds_read_b64_tr_b16 v[178:179], v32 offset:7168
    ds_read_b64_tr_b16 v[180:181], v33 offset:6144
    ds_read_b64_tr_b16 v[182:183], v33 offset:7168
    s_waitcnt lgkmcnt(4)
    v_mfma_f32_32x32x16_bf16 v[40:55], v[208:211], v[168:171], v[40:55]
    v_mfma_f32_32x32x16_bf16 v[56:71], v[208:211], v[172:175], v[56:71]
    v_mfma_f32_32x32x16_bf16 v[72:87], v[212:215], v[168:171], v[72:87]
    v_mfma_f32_32x32x16_bf16 v[88:103], v[212:215], v[172:175], v[88:103]
    s_waitcnt vmcnt(6)
    ds_read_b64_tr_b16 v[168:169], v32 offset:8192
    ds_read_b64_tr_b16 v[170:171], v32 offset:9216
    ds_read_b64_tr_b16 v[172:173], v33 offset:8192
    ds_read_b64_tr_b16 v[174:175], v33 offset:9216
    s_waitcnt lgkmcnt(4)
    v_mfma_f32_32x32x16_bf16 v[40:55], v[216:219], v[176:179], v[40:55]
    v_mfma_f32_32x32x16_bf16 v[56:71], v[216:219], v[180:183], v[56:71]
    v_mfma_f32_32x32x16_bf16 v[72:87], v[220:223], v[176:179], v[72:87]
    v_mfma_f32_32x32x16_bf16 v[88:103], v[220:223], v[180:183], v[88:103]
    s_waitcnt vmcnt(4)
    ds_read_b64_tr_b16 v[176:177], v32 offset:10240
    ds_read_b64_tr_b16 v[178:179], v32 offset:11264
    ds_read_b64_tr_b16 v[180:181], v33 offset:10240
    ds_read_b64_tr_b16 v[182:183], v33 offset:11264
    s_waitcnt lgkmcnt(4)
    v_mfma_f32_32x32x16_bf16 v[40:55], v[224:227], v[168:171], v[40:55]
    v_mfma_f32_32x32x16_bf16 v[56:71], v[224:227], v[172:175], v[56:71]
    v_mfma_f32_32x32x16_bf16 v[72:87], v[228:231], v[168:171], v[72:87]
    v_mfma_f32_32x32x16_bf16 v[88:103], v[228:231], v[172:175], v[88:103]
    s_waitcnt vmcnt(2)
    ds_read_b64_tr_b16 v[168:169], v32 offset:12288
    ds_read_b64_tr_b16 v[170:171], v32 offset:13312
    ds_read_b64_tr_b16 v[172:173], v33 offset:12288
    ds_read_b64_tr_b16 v[174:175], v33 offset:13312
    s_waitcnt lgkmcnt(4)
    v_mfma_f32_32x32x16_bf16 v[40:55], v[232:235], v[176:179], v[40:55]
    v_mfma_f32_32x32x16_bf16 v[56:71], v[232:235], v[180:183], v[56:71]
    v_mfma_f32_32x32x16_bf16 v[72:87], v[236:239], v[176:179], v[72:87]
    v_mfma_f32_32x32x16_bf16 v[88:103], v[236:239], v[180:183], v[88:103]
    s_waitcnt vmcnt(0)
    ds_read_b64_tr_b16 v[176:177], v32 offset:14336
    ds_read_b64_tr_b16 v[178:179], v32 offset:15360
    ds_read_b64_tr_b16 v[180:181], v33 offset:14336
    ds_read_b64_tr_b16 v[182:183], v33 offset:15360
    s_waitcnt lgkmcnt(4)
    v_mfma_f32_32x32x16_bf16 v[40:55], v[240:243], v[168:171], v[40:55]
    v_mfma_f32_32x32x16_bf16 v[56:71], v[240:243], v[172:175], v[56:71]
    v_mfma_f32_32x32x16_bf16 v[72:87], v[244:247], v[168:171], v[72:87]
    v_mfma_f32_32x32x16_bf16 v[88:103], v[244:247], v[172:175], v[88:103]
    s_waitcnt lgkmcnt(0)
    v_mfma_f32_32x32x16_bf16 v[40:55], v[248:251], v[176:179], v[40:55]
    v_mfma_f32_32x32x16_bf16 v[56:71], v[248:251], v[180:183], v[56:71]
    v_mfma_f32_32x32x16_bf16 v[72:87], v[252:255], v[176:179], v[72:87]
    v_mfma_f32_32x32x16_bf16 v[88:103], v[252:255], v[180:183], v[88:103]
L_RED:
    v_add_u32 v8, s67, v6
    s_nop 11
    ds_write_b128 v8, v[40:43] offset:0
    ds_write_b128 v8, v[44:47] offset:1024
    ds_write_b128 v8, v[48:51] offset:2048
    ds_write_b128 v8, v[52:55] offset:3072
    ds_write_b128 v8, v[56:59] offset:4096
    ds_write_b128 v8, v[60:63] offset:5120
    ds_write_b128 v8, v[64:67] offset:6144
    ds_write_b128 v8, v[68:71] offset:7168
    ds_write_b128 v8, v[72:75] offset:8192
    ds_write_b128 v8, v[76:79] offset:9216
    ds_write_b128 v8, v[80:83] offset:10240
    ds_write_b128 v8, v[84:87] offset:11264
    ds_write_b128 v8, v[88:91] offset:12288
    ds_write_b128 v8, v[92:95] offset:13312
    ds_write_b128 v8, v[96:99] offset:14336
    ds_write_b128 v8, v[100:103] offset:15360
    s_waitcnt lgkmcnt(0)
L_RED2:
    s_barrier
    s_xor_b32 s50, s38, 4
    s_lshl_b32 s50, s50, 11
    s_add_u32 s50, s50, 32768
    v_add_u32 v9, s50, v6
    ds_read_b128 v[104:107], v9
    ds_read_b128 v[108:111], v9 offset:1024
    s_xor_b32 s50, s38, 5
    s_lshl_b32 s50, s50, 11
    s_add_u32 s50, s50, 65536
    v_add_u32 v10, s50, v6
    ds_read_b128 v[112:115], v10
    ds_read_b128 v[116:119], v10 offset:1024
    s_xor_b32 s50, s38, 6
    s_lshl_b32 s50, s50, 11
    s_add_u32 s50, s50, 98304
    v_add_u32 v11, s50, v6
    ds_read_b128 v[120:123], v11
    ds_read_b128 v[124:127], v11 offset:1024
    s_xor_b32 s50, s38, 7
    s_lshl_b32 s50, s50, 11
    s_add_u32 s50, s50, 131072
    v_add_u32 v12, s50, v6
    ds_read_b128 v[128:131], v12
    ds_read_b128 v[132:135], v12 offset:1024
    s_waitcnt lgkmcnt(4)
    v_pk_add_f32 v[40:41], v[104:105], v[112:113]
    v_pk_add_f32 v[42:43], v[106:107], v[114:115]
    v_pk_add_f32 v[44:45], v[108:109], v[116:117]
    v_pk_add_f32 v[46:47], v[110:111], v[118:119]
    s_waitcnt lgkmcnt(2)
    v_pk_add_f32 v[40:41], v[40:41], v[120:121]
    v_pk_add_f32 v[42:43], v[42:43], v[122:123]
    v_pk_add_f32 v[44:45], v[44:45], v[124:125]
    v_pk_add_f32 v[46:47], v[46:47], v[126:127]
    s_waitcnt lgkmcnt(0)
    v_pk_add_f32 v[40:41], v[40:41], v[128:129]
    v_pk_add_f32 v[42:43], v[42:43], v[130:131]
    v_pk_add_f32 v[44:45], v[44:45], v[132:133]
    v_pk_add_f32 v[46:47], v[46:47], v[134:135]
    s_waitcnt vmcnt(0)
    v_lshlrev_b32 v16, 16, v34
    v_and_b32 v17, 0xffff0000, v34
    v_lshlrev_b32 v18, 16, v35
    v_and_b32 v19, 0xffff0000, v35
    v_pk_add_f32 v[40:41], v[40:41], v[16:17]
    v_pk_add_f32 v[42:43], v[42:43], v[18:19]
    v_lshlrev_b32 v16, 16, v36
    v_and_b32 v17, 0xffff0000, v36
    v_lshlrev_b32 v18, 16, v37
    v_and_b32 v19, 0xffff0000, v37
    v_pk_add_f32 v[44:45], v[44:45], v[16:17]
    v_pk_add_f32 v[46:47], v[46:47], v[18:19]
    v_cvt_pk_bf16_f32 v160, v40, v41
    v_cvt_pk_bf16_f32 v161, v42, v43
    v_cvt_pk_bf16_f32 v162, v44, v45
    v_cvt_pk_bf16_f32 v163, v46, v47
    s_nop 1
    v_permlane32_swap_b32 v160, v162
    v_permlane32_swap_b32 v161, v163
    buffer_store_dwordx4 v[160:163], v38, s[32:35], 0 offen
    s_cmp_eq_u32 s2, 0
    s_cbranch_scc0 L_FIN
    s_cmp_eq_u32 s38, 7
    s_cbranch_scc0 L_FIN
    s_mov_b32 s50, 14090240
    s_mov_b64 s[62:63], exec
    s_mov_b64 exec, 1
    buffer_store_dword v24, v25, s[28:31], s50 offen sc0 sc1
    s_mov_b64 exec, s[62:63]
L_FIN:
L_END:
    s_endpgm

.section .rodata,"a"
.p2align 6
.amdhsa_kernel parallel_sum__spectral_gfnet__glu_gated_geglu__prompt_kernel
  .amdhsa_next_free_vgpr 256
  .amdhsa_next_free_sgpr 102
  .amdhsa_accum_offset 256
  .amdhsa_group_segment_fixed_size 0
  .amdhsa_kernarg_size 80
  .amdhsa_user_sgpr_count 2
  .amdhsa_user_sgpr_kernarg_segment_ptr 1
  .amdhsa_system_sgpr_workgroup_id_x 1
.end_amdhsa_kernel
```
